```python
import torch

def _softmax(x, axis=-1):
    return torch.softmax(x, dim=axis)

def _gelu(x):
    return torch.nn.functional.gelu(x, approximate='tanh')

def _silu(x):
    return torch.nn.functional.silu(x)

def _sigmoid(x):
    return torch.sigmoid(x)

def _layernorm(x, axis=-1, eps=1e-05):
    m = x.mean(dim=axis, keepdim=True)
    v = x.var(dim=axis, keepdim=True, unbiased=False)
    return (x - m) / torch.sqrt(v + eps)

def _scatter_add(tgt, idx, src, axis=0):
    return tgt.clone().index_add_(axis, idx, src)

def _segment_sum(src, seg, n):
    out = torch.zeros((n,) + src.shape[1:], dtype=src.dtype)
    return out.index_add_(0, seg, src)

def _pad(x, pw):
    flat = tuple((v for pair in reversed(pw) for v in pair))
    return torch.nn.functional.pad(x, flat)
kernel_name = 'adaLN_cond__sliding_block_cached__glu_gated_reglu__prompt'

def setup_inputs():

    _w = lambda a: (lambda t: t.to(torch.bfloat16) if t.is_floating_point() else t)(torch.as_tensor(a))

    def _A_setup():
        B, Sq, D = (1, 2048, 640)
        Hq, Hkv, Sk, Dh = (32, 32, 2048, 192)
        assert Hq % Hkv == 0, (Hq, Hkv)
        return {'x': _w((lambda *s: torch.randn(*s, dtype=torch.bfloat16) * 0.05)(B, Sq, D)), 'k_cache': _w((lambda *s: torch.randn(*s, dtype=torch.bfloat16) * 1.6)(B, Hkv, Sk, Dh)), 'v_cache': _w((lambda *s: torch.randn(*s, dtype=torch.bfloat16) * 0.8)(B, Hkv, Sk, Dh)), 'wq': _w((lambda *s: torch.randn(*s, dtype=torch.bfloat16) * 1.6)(D, Hq * Dh) * D ** (-0.5)), 'wo': _w((lambda *s: torch.randn(*s, dtype=torch.bfloat16) * 0.8)(Hq * Dh, D) * (Hq * Dh) ** (-0.5))}
    _A_in = _A_setup()

    def _B_setup():
        B, S, D, F = (1, 2048, 640, 1536)
        return {'x': _w((lambda *s: torch.randn(*s, dtype=torch.bfloat16) * 0.05)(B, S, D)), 'W_gate': _w((lambda *s: torch.randn(*s, dtype=torch.bfloat16) * 0.4)(D, F) * (2.0 / D) ** 0.5), 'W_up': _w((lambda *s: torch.randn(*s, dtype=torch.bfloat16) * 0.4)(D, F) * (2.0 / D) ** 0.5), 'W_down': _w((lambda *s: torch.randn(*s, dtype=torch.bfloat16) * 0.4)(F, D) * (1.0 / F) ** 0.5)}
    _B_in = _B_setup()
    return {'A_x': _A_in['x'], 'A_k_cache': _A_in['k_cache'], 'A_v_cache': _A_in['v_cache'], 'A_wq': _A_in['wq'], 'A_wo': _A_in['wo'], 'B_x': _B_in['x'], 'B_W_gate': _B_in['W_gate'], 'B_W_up': _B_in['W_up'], 'B_W_down': _B_in['W_down'], 'c': _w((lambda *s: torch.randn(*s, dtype=torch.bfloat16) * 0.2)(1, 640) * 8.0), 'w_mod': _w((lambda *s: torch.randn(*s, dtype=torch.bfloat16) * 0.2)(640, 6 * 640) * 640 ** (-0.5) * 8.0)}

def reference(A_x, A_k_cache, A_v_cache, A_wq, A_wo, B_x, B_W_gate, B_W_up, B_W_down, c, w_mod):

    def _A_ref(x, k_cache, v_cache, wq, wo):
        B, Sq, D = x.shape
        Hq, Dh = (32, 192)
        Hkv, Sk = (k_cache.shape[1], k_cache.shape[2])
        W = min(4096, max(256, Sk // 4))
        rep = Hq // Hkv
        q = (lambda x, *d: x.permute(*d))((x @ wq).reshape(B, Sq, Hq, Dh), 0, 2, 1, 3)
        k = (lambda x, n, axis: torch.repeat_interleave(x, n, dim=axis))(k_cache[:, :, Sk - W:, :], rep, axis=1)
        v = (lambda x, n, axis: torch.repeat_interleave(x, n, dim=axis))(v_cache[:, :, Sk - W:, :], rep, axis=1)
        scores = torch.einsum('bhqd,bhkd->bhqk', q, k) * Dh ** (-0.5)
        p = _softmax(scores, axis=-1)
        o = torch.einsum('bhqk,bhkd->bhqd', p, v)
        return (lambda x, *d: x.permute(*d))(o, 0, 2, 1, 3).reshape(B, Sq, Hq * Dh) @ wo

    def _B_ref(x, W_gate, W_up, W_down):
        gate = torch.einsum('bsd,df->bsf', x, W_gate)
        up = torch.einsum('bsd,df->bsf', x, W_up)
        gate = gate * (lambda x, dt: x.to(dt))(gate > 0, gate.dtype)
        h = gate * up
        return torch.einsum('bsf,fd->bsd', h, W_down)
    x = A_x
    mod = (_silu(c) @ w_mod).reshape(c.shape[0], 6, 1, -1)
    sa, ca, ga, sb, cb, gb = (mod[:, 0].clone(), mod[:, 1].clone(), mod[:, 2].clone(), mod[:, 3].clone(), mod[:, 4].clone(), mod[:, 5].clone())
    h = _layernorm(x, axis=-1) * (1 + ca) + sa
    x = x + ga * _A_ref(h, A_k_cache, A_v_cache, A_wq, A_wo)
    h = _layernorm(x, axis=-1) * (1 + cb) + sb
    x = x + gb * _B_ref(h, B_W_gate, B_W_up, B_W_down)
    return x
```

```asm
; @launch kernel=k01_kernel grid=(248,1,1) block=(256,1,1) lds=16384
; @launch kernel=k2_kernel grid=(256,1,1) block=(256,1,1) lds=163840
.amdgcn_target "amdgcn-amd-amdhsa--gfx950"
.text

.macro xm d,a,b,c
v_mfma_f32_16x16x32_bf16 v[\d:\d+3], \a, \b, \c
.endm
.macro xaa d,a,b
v_mfma_f32_16x16x32_bf16 v[\d:\d+3], a[\a:\a+3], a[\b:\b+3], v[\d:\d+3]
.endm
.macro xav d,a,b
v_mfma_f32_16x16x32_bf16 v[\d:\d+3], a[\a:\a+3], v[\b:\b+3], v[\d:\d+3]
.endm
.macro xvv d,a,b
v_mfma_f32_16x16x32_bf16 v[\d:\d+3], v[\a:\a+3], v[\b:\b+3], v[\d:\d+3]
.endm
.macro xva d,a,b
v_mfma_f32_16x16x32_bf16 v[\d:\d+3], v[\a:\a+3], a[\b:\b+3], v[\d:\d+3]
.endm
.macro yav d,a,b
v_mfma_f32_32x32x16_bf16 v[\d:\d+15], a[\a:\a+3], v[\b:\b+3], v[\d:\d+15]
.endm
.macro yvv d,a,b
v_mfma_f32_32x32x16_bf16 v[\d:\d+15], v[\a:\a+3], v[\b:\b+3], v[\d:\d+15]
.endm
.macro ta d,a,o
ds_read_b64_tr_b16 a[\d:\d+1], v\a offset:\o
.endm
.macro tv d,a,o
ds_read_b64_tr_b16 v[\d:\d+1], v\a offset:\o
.endm
.macro ra d,a,o
ds_read_b128 a[\d:\d+3], v\a offset:\o
.endm
.macro ex r
v_exp_f32 v\r, v\r
.endm
.macro cv d,a,b
v_cvt_pk_bf16_f32 v\d, v\a, v\b
.endm
.macro aw d,a
v_accvgpr_write_b32 a\d, v\a
.endm
.macro sw a,b
v_permlane16_swap_b32 v\a, v\b
.endm
.macro wl n
s_waitcnt lgkmcnt(\n)
.endm
.macro wv n
s_waitcnt vmcnt(\n)
.endm
.macro dm v,s,t,o
buffer_load_dwordx4 v\v, s[\s:\s+3], s\t offen offset:\o lds
.endm
.globl k01_kernel
.p2align 8
.type k01_kernel,@function
k01_kernel:
s_load_dwordx4 s[4:7], s[0:1], 72
s_load_dwordx4 s[16:19], s[0:1], 96
s_load_dwordx2 s[38:39], s[0:1], 0
s_load_dwordx2 s[40:41], s[0:1], 24
s_cmp_lt_u32 s2, 40
wl 0
s_cbranch_scc1 K01_GA
s_cmp_lt_u32 s2, 168
wl 0
s_cbranch_scc1 K01_LN
s_cmp_ge_u32 s2, 248
wl 0
s_cbranch_scc1 K01_END
s_sub_u32 s3, s2, 168
s_mul_i32 s20, s3, 3277
s_lshr_b32 s20, s20, 16
s_mul_i32 s21, s20, 20
s_sub_u32 s21, s3, s21
s_add_u32 s21, s21, 10
wl 0
s_branch K01_G
wl 0
K01_GA:
s_and_b32 s20, s2, 3
s_lshr_b32 s21, s2, 2
wl 0
K01_G:
v_and_b32 v1, 15, v0
v_lshrrev_b32 v2, 4, v0
s_mul_i32 s3, s20, 160
v_add_u32 v3, s3, v2
v_lshlrev_b32 v4, 1, v3
s_mov_b32 s22, 7680
v_mul_lo_u32 v5, v3, s22
v_lshlrev_b32 v6, 4, v1
v_add_u32 v5, v5, v6
s_lshl_b32 s3, s21, 8
v_add_u32 v5, s3, v5
wl 0
wl 0
s_mov_b32 s8, s4
s_mov_b32 s9, s5
s_mov_b32 s10, 1280
s_mov_b32 s11, 0x20000
s_mov_b32 s12, s6
s_mov_b32 s13, s7
s_mov_b32 s14, 4915200
s_mov_b32 s15, 0x20000
s_mov_b32 s24, s18
s_mov_b32 s25, s19
s_mov_b32 s26, 268435456
s_mov_b32 s27, 0x20000
s_mov_b32 s28, s16
s_mov_b32 s29, s17
s_mov_b32 s30, 256
s_mov_b32 s31, 0x20000
s_mov_b32 s23, 0
buffer_load_dwordx4 v[24:27], v5, s[12:15], s23 offen
s_mov_b32 s23, 122880
buffer_load_dwordx4 v[28:31], v5, s[12:15], s23 offen
s_mov_b32 s23, 245760
buffer_load_dwordx4 v[32:35], v5, s[12:15], s23 offen
s_mov_b32 s23, 368640
buffer_load_dwordx4 v[36:39], v5, s[12:15], s23 offen
s_mov_b32 s23, 491520
buffer_load_dwordx4 v[40:43], v5, s[12:15], s23 offen
s_mov_b32 s23, 614400
buffer_load_dwordx4 v[44:47], v5, s[12:15], s23 offen
s_mov_b32 s23, 737280
buffer_load_dwordx4 v[48:51], v5, s[12:15], s23 offen
s_mov_b32 s23, 860160
buffer_load_dwordx4 v[52:55], v5, s[12:15], s23 offen
s_mov_b32 s23, 983040
buffer_load_dwordx4 v[56:59], v5, s[12:15], s23 offen
s_mov_b32 s23, 1105920
buffer_load_dwordx4 v[60:63], v5, s[12:15], s23 offen
buffer_load_ushort v10, v4, s[8:11], 0 offen offset:0
buffer_load_ushort v11, v4, s[8:11], 0 offen offset:32
buffer_load_ushort v12, v4, s[8:11], 0 offen offset:64
buffer_load_ushort v13, v4, s[8:11], 0 offen offset:96
buffer_load_ushort v14, v4, s[8:11], 0 offen offset:128
buffer_load_ushort v15, v4, s[8:11], 0 offen offset:160
buffer_load_ushort v16, v4, s[8:11], 0 offen offset:192
buffer_load_ushort v17, v4, s[8:11], 0 offen offset:224
buffer_load_ushort v18, v4, s[8:11], 0 offen offset:256
buffer_load_ushort v19, v4, s[8:11], 0 offen offset:288
wv 9
v_lshlrev_b32 v10, 16, v10
wv 8
v_lshlrev_b32 v11, 16, v11
wv 7
v_lshlrev_b32 v12, 16, v12
wv 6
v_lshlrev_b32 v13, 16, v13
wv 5
v_lshlrev_b32 v14, 16, v14
wv 4
v_lshlrev_b32 v15, 16, v15
wv 3
v_lshlrev_b32 v16, 16, v16
wv 2
v_lshlrev_b32 v17, 16, v17
wv 1
v_lshlrev_b32 v18, 16, v18
wv 0
v_lshlrev_b32 v19, 16, v19
v_mul_f32 v80, 3216550459, v10
v_mul_f32 v81, 3216550459, v11
v_mul_f32 v82, 3216550459, v12
v_mul_f32 v83, 3216550459, v13
v_mul_f32 v84, 3216550459, v14
v_mul_f32 v85, 3216550459, v15
v_mul_f32 v86, 3216550459, v16
v_mul_f32 v87, 3216550459, v17
v_mul_f32 v88, 3216550459, v18
v_mul_f32 v89, 3216550459, v19
ex 80
ex 81
ex 82
ex 83
ex 84
ex 85
ex 86
ex 87
ex 88
ex 89
v_add_f32 v80, 1.0, v80
v_add_f32 v81, 1.0, v81
v_add_f32 v82, 1.0, v82
v_add_f32 v83, 1.0, v83
v_add_f32 v84, 1.0, v84
v_add_f32 v85, 1.0, v85
v_add_f32 v86, 1.0, v86
v_add_f32 v87, 1.0, v87
v_add_f32 v88, 1.0, v88
v_add_f32 v89, 1.0, v89
v_rcp_f32 v80, v80
v_rcp_f32 v81, v81
v_rcp_f32 v82, v82
v_rcp_f32 v83, v83
v_rcp_f32 v84, v84
v_rcp_f32 v85, v85
v_rcp_f32 v86, v86
v_rcp_f32 v87, v87
v_rcp_f32 v88, v88
v_rcp_f32 v89, v89
v_mul_f32 v10, v10, v80
v_mul_f32 v11, v11, v81
v_mul_f32 v12, v12, v82
v_mul_f32 v13, v13, v83
v_mul_f32 v14, v14, v84
v_mul_f32 v15, v15, v85
v_mul_f32 v16, v16, v86
v_mul_f32 v17, v17, v87
v_mul_f32 v18, v18, v88
v_mul_f32 v19, v19, v89
cv 10,10,10
cv 11,11,11
cv 12,12,12
cv 13,13,13
cv 14,14,14
cv 15,15,15
cv 16,16,16
cv 17,17,17
cv 18,18,18
cv 19,19,19
v_lshrrev_b32 v80, 16, v10
v_lshrrev_b32 v81, 16, v11
v_lshrrev_b32 v82, 16, v12
v_lshrrev_b32 v83, 16, v13
v_lshrrev_b32 v84, 16, v14
v_lshrrev_b32 v85, 16, v15
v_lshrrev_b32 v86, 16, v16
v_lshrrev_b32 v87, 16, v17
v_lshrrev_b32 v88, 16, v18
v_lshrrev_b32 v89, 16, v19
v_and_b32 v10, 0xffff0000, v10
v_and_b32 v11, 0xffff0000, v11
v_and_b32 v12, 0xffff0000, v12
v_and_b32 v13, 0xffff0000, v13
v_and_b32 v14, 0xffff0000, v14
v_and_b32 v15, 0xffff0000, v15
v_and_b32 v16, 0xffff0000, v16
v_and_b32 v17, 0xffff0000, v17
v_and_b32 v18, 0xffff0000, v18
v_and_b32 v19, 0xffff0000, v19
v_mov_b32 v70, 0
v_mov_b32 v71, 0
v_mov_b32 v72, 0
v_mov_b32 v73, 0
v_mov_b32 v74, 0
v_mov_b32 v75, 0
v_mov_b32 v76, 0
v_mov_b32 v77, 0
v_dot2c_f32_bf16 v70, v24, v80
v_dot2c_f32_bf16 v71, v24, v10
v_dot2c_f32_bf16 v72, v25, v80
v_dot2c_f32_bf16 v73, v25, v10
v_dot2c_f32_bf16 v74, v26, v80
v_dot2c_f32_bf16 v75, v26, v10
v_dot2c_f32_bf16 v76, v27, v80
v_dot2c_f32_bf16 v77, v27, v10
v_dot2c_f32_bf16 v70, v28, v81
v_dot2c_f32_bf16 v71, v28, v11
v_dot2c_f32_bf16 v72, v29, v81
v_dot2c_f32_bf16 v73, v29, v11
v_dot2c_f32_bf16 v74, v30, v81
v_dot2c_f32_bf16 v75, v30, v11
v_dot2c_f32_bf16 v76, v31, v81
v_dot2c_f32_bf16 v77, v31, v11
v_dot2c_f32_bf16 v70, v32, v82
v_dot2c_f32_bf16 v71, v32, v12
v_dot2c_f32_bf16 v72, v33, v82
v_dot2c_f32_bf16 v73, v33, v12
v_dot2c_f32_bf16 v74, v34, v82
v_dot2c_f32_bf16 v75, v34, v12
v_dot2c_f32_bf16 v76, v35, v82
v_dot2c_f32_bf16 v77, v35, v12
v_dot2c_f32_bf16 v70, v36, v83
v_dot2c_f32_bf16 v71, v36, v13
v_dot2c_f32_bf16 v72, v37, v83
v_dot2c_f32_bf16 v73, v37, v13
v_dot2c_f32_bf16 v74, v38, v83
v_dot2c_f32_bf16 v75, v38, v13
v_dot2c_f32_bf16 v76, v39, v83
v_dot2c_f32_bf16 v77, v39, v13
v_dot2c_f32_bf16 v70, v40, v84
v_dot2c_f32_bf16 v71, v40, v14
v_dot2c_f32_bf16 v72, v41, v84
v_dot2c_f32_bf16 v73, v41, v14
v_dot2c_f32_bf16 v74, v42, v84
v_dot2c_f32_bf16 v75, v42, v14
v_dot2c_f32_bf16 v76, v43, v84
v_dot2c_f32_bf16 v77, v43, v14
v_dot2c_f32_bf16 v70, v44, v85
v_dot2c_f32_bf16 v71, v44, v15
v_dot2c_f32_bf16 v72, v45, v85
v_dot2c_f32_bf16 v73, v45, v15
v_dot2c_f32_bf16 v74, v46, v85
v_dot2c_f32_bf16 v75, v46, v15
v_dot2c_f32_bf16 v76, v47, v85
v_dot2c_f32_bf16 v77, v47, v15
v_dot2c_f32_bf16 v70, v48, v86
v_dot2c_f32_bf16 v71, v48, v16
v_dot2c_f32_bf16 v72, v49, v86
v_dot2c_f32_bf16 v73, v49, v16
v_dot2c_f32_bf16 v74, v50, v86
v_dot2c_f32_bf16 v75, v50, v16
v_dot2c_f32_bf16 v76, v51, v86
v_dot2c_f32_bf16 v77, v51, v16
v_dot2c_f32_bf16 v70, v52, v87
v_dot2c_f32_bf16 v71, v52, v17
v_dot2c_f32_bf16 v72, v53, v87
v_dot2c_f32_bf16 v73, v53, v17
v_dot2c_f32_bf16 v74, v54, v87
v_dot2c_f32_bf16 v75, v54, v17
v_dot2c_f32_bf16 v76, v55, v87
v_dot2c_f32_bf16 v77, v55, v17
v_dot2c_f32_bf16 v70, v56, v88
v_dot2c_f32_bf16 v71, v56, v18
v_dot2c_f32_bf16 v72, v57, v88
v_dot2c_f32_bf16 v73, v57, v18
v_dot2c_f32_bf16 v74, v58, v88
v_dot2c_f32_bf16 v75, v58, v18
v_dot2c_f32_bf16 v76, v59, v88
v_dot2c_f32_bf16 v77, v59, v18
v_dot2c_f32_bf16 v70, v60, v89
v_dot2c_f32_bf16 v71, v60, v19
v_dot2c_f32_bf16 v72, v61, v89
v_dot2c_f32_bf16 v73, v61, v19
v_dot2c_f32_bf16 v74, v62, v89
v_dot2c_f32_bf16 v75, v62, v19
v_dot2c_f32_bf16 v76, v63, v89
v_dot2c_f32_bf16 v77, v63, v19
v_lshlrev_b32 v6, 5, v1
v_lshlrev_b32 v7, 9, v2
v_add_u32 v6, v6, v7
ds_write_b128 v6, v[70:73]
ds_write_b128 v6, v[74:77] offset:16
wl 0
s_barrier
v_cmp_gt_u32 vcc, 64, v0
s_nop 3
s_and_saveexec_b64 s[32:33], vcc
s_cbranch_execz K01_PF
v_lshlrev_b32 v6, 3, v0
ds_read_b64 v[30:31], v6 offset:0
ds_read_b64 v[32:33], v6 offset:512
ds_read_b64 v[34:35], v6 offset:1024
ds_read_b64 v[36:37], v6 offset:1536
ds_read_b64 v[38:39], v6 offset:2048
ds_read_b64 v[40:41], v6 offset:2560
ds_read_b64 v[42:43], v6 offset:3072
ds_read_b64 v[44:45], v6 offset:3584
ds_read_b64 v[46:47], v6 offset:4096
ds_read_b64 v[48:49], v6 offset:4608
ds_read_b64 v[50:51], v6 offset:5120
ds_read_b64 v[52:53], v6 offset:5632
ds_read_b64 v[54:55], v6 offset:6144
ds_read_b64 v[56:57], v6 offset:6656
ds_read_b64 v[58:59], v6 offset:7168
ds_read_b64 v[60:61], v6 offset:7680
wl 7
v_pk_add_f32 v[30:31], v[30:31], v[46:47]
wl 6
v_pk_add_f32 v[32:33], v[32:33], v[48:49]
wl 5
v_pk_add_f32 v[34:35], v[34:35], v[50:51]
wl 4
v_pk_add_f32 v[36:37], v[36:37], v[52:53]
wl 3
v_pk_add_f32 v[38:39], v[38:39], v[54:55]
wl 2
v_pk_add_f32 v[40:41], v[40:41], v[56:57]
wl 1
v_pk_add_f32 v[42:43], v[42:43], v[58:59]
wl 0
v_pk_add_f32 v[44:45], v[44:45], v[60:61]
v_pk_add_f32 v[30:31], v[30:31], v[38:39]
v_pk_add_f32 v[32:33], v[32:33], v[40:41]
v_pk_add_f32 v[34:35], v[34:35], v[42:43]
v_pk_add_f32 v[36:37], v[36:37], v[44:45]
v_pk_add_f32 v[30:31], v[30:31], v[34:35]
v_pk_add_f32 v[32:33], v[32:33], v[36:37]
v_pk_add_f32 v[30:31], v[30:31], v[32:33]
s_mul_i32 s3, s20, 15360
s_lshl_b32 s23, s21, 9
s_add_u32 s3, s3, s23
s_add_u32 s3, s3, 0
v_add_u32 v6, s3, v6
buffer_store_dwordx2 v[30:31], v6, s[24:27], 0 offen sc1
wv 0
s_cmp_ge_u32 s21, 10
s_cbranch_scc1 K01_END
v_cmp_eq_u32 vcc, 0, v0
s_nop 3
s_and_saveexec_b64 s[32:33], vcc
s_cbranch_execz K01_END
v_mov_b32 v7, 1
v_mov_b32 v8, 0
buffer_atomic_add v7, v8, s[28:31], 0 offen sc0 sc1
wv 0
v_readfirstlane_b32 s22, v7
s_nop 3
s_cmp_lg_u32 s22, 39
s_cbranch_scc1 K01_END
v_mov_b32 v8, 128
v_mov_b32 v7, 1
buffer_store_dword v7, v8, s[28:31], 0 offen sc1
K01_END:
s_endpgm
K01_LN:
s_sub_u32 s2, s2, 40
v_lshrrev_b32 v1, 6, v0
v_and_b32 v10, 63, v0
v_readfirstlane_b32 s20, v1
v_and_b32 v2, 15, v10
v_lshrrev_b32 v3, 4, v10
s_lshl_b32 s3, s2, 4
v_add_u32 v9, s3, v2
v_mul_u32_u24 v9, 1280, v9
v_lshlrev_b32 v11, 3, v3
v_add_u32 v9, v9, v11
s_mul_i32 s3, s20, 320
v_add_u32 v9, s3, v9
wl 0
s_mov_b32 s8, s38
s_mov_b32 s9, s39
s_mov_b32 s10, 2621440
s_mov_b32 s11, 0x20000
s_mov_b32 s24, s18
s_mov_b32 s25, s19
s_mov_b32 s26, 268435456
s_mov_b32 s27, 0x20000
s_mov_b32 s28, s16
s_mov_b32 s29, s17
s_mov_b32 s30, 256
s_mov_b32 s31, 0x20000
buffer_load_dwordx2 v[60:61], v9, s[8:11], 0 offen offset:0
buffer_load_dwordx2 v[62:63], v9, s[8:11], 0 offen offset:32
buffer_load_dwordx2 v[64:65], v9, s[8:11], 0 offen offset:64
buffer_load_dwordx2 v[66:67], v9, s[8:11], 0 offen offset:96
buffer_load_dwordx2 v[68:69], v9, s[8:11], 0 offen offset:128
buffer_load_dwordx2 v[70:71], v9, s[8:11], 0 offen offset:160
buffer_load_dwordx2 v[72:73], v9, s[8:11], 0 offen offset:192
buffer_load_dwordx2 v[74:75], v9, s[8:11], 0 offen offset:224
buffer_load_dwordx2 v[76:77], v9, s[8:11], 0 offen offset:256
buffer_load_dwordx2 v[78:79], v9, s[8:11], 0 offen offset:288
s_cmp_lg_u32 s2, 0
wv 0
s_cbranch_scc1 K01_NOZ
v_min_u32 v12, 63, v0
v_lshlrev_b32 v12, 7, v12
v_mov_b32 v13, 0
s_mov_b32 s21, 196608
buffer_store_dword v13, v12, s[24:27], s21 offen sc1
s_mov_b32 s21, 204800
buffer_store_dword v13, v12, s[24:27], s21 offen sc1
K01_NOZ:
v_lshlrev_b32 v100, 16, v60
v_and_b32 v101, 0xffff0000, v60
v_lshlrev_b32 v102, 16, v61
v_and_b32 v103, 0xffff0000, v61
v_lshlrev_b32 v104, 16, v62
v_and_b32 v105, 0xffff0000, v62
v_lshlrev_b32 v106, 16, v63
v_and_b32 v107, 0xffff0000, v63
v_lshlrev_b32 v108, 16, v64
v_and_b32 v109, 0xffff0000, v64
v_lshlrev_b32 v110, 16, v65
v_and_b32 v111, 0xffff0000, v65
v_lshlrev_b32 v112, 16, v66
v_and_b32 v113, 0xffff0000, v66
v_lshlrev_b32 v114, 16, v67
v_and_b32 v115, 0xffff0000, v67
v_lshlrev_b32 v116, 16, v68
v_and_b32 v117, 0xffff0000, v68
v_lshlrev_b32 v118, 16, v69
v_and_b32 v119, 0xffff0000, v69
v_lshlrev_b32 v120, 16, v70
v_and_b32 v121, 0xffff0000, v70
v_lshlrev_b32 v122, 16, v71
v_and_b32 v123, 0xffff0000, v71
v_lshlrev_b32 v124, 16, v72
v_and_b32 v125, 0xffff0000, v72
v_lshlrev_b32 v126, 16, v73
v_and_b32 v127, 0xffff0000, v73
v_lshlrev_b32 v128, 16, v74
v_and_b32 v129, 0xffff0000, v74
v_lshlrev_b32 v130, 16, v75
v_and_b32 v131, 0xffff0000, v75
v_lshlrev_b32 v132, 16, v76
v_and_b32 v133, 0xffff0000, v76
v_lshlrev_b32 v134, 16, v77
v_and_b32 v135, 0xffff0000, v77
v_lshlrev_b32 v136, 16, v78
v_and_b32 v137, 0xffff0000, v78
v_lshlrev_b32 v138, 16, v79
v_and_b32 v139, 0xffff0000, v79
v_lshlrev_b32 v4, 6, v2
v_lshlrev_b32 v5, 2, v3
v_add_u32 v5, v4, v5
s_lshl_b32 s3, s20, 4
v_add_u32 v5, s3, v5
v_add_f32 v6, v100, v101
v_add_f32 v6, v6, v102
v_add_f32 v6, v6, v103
v_add_f32 v6, v6, v104
v_add_f32 v6, v6, v105
v_add_f32 v6, v6, v106
v_add_f32 v6, v6, v107
v_add_f32 v6, v6, v108
v_add_f32 v6, v6, v109
v_add_f32 v6, v6, v110
v_add_f32 v6, v6, v111
v_add_f32 v6, v6, v112
v_add_f32 v6, v6, v113
v_add_f32 v6, v6, v114
v_add_f32 v6, v6, v115
v_add_f32 v6, v6, v116
v_add_f32 v6, v6, v117
v_add_f32 v6, v6, v118
v_add_f32 v6, v6, v119
v_add_f32 v6, v6, v120
v_add_f32 v6, v6, v121
v_add_f32 v6, v6, v122
v_add_f32 v6, v6, v123
v_add_f32 v6, v6, v124
v_add_f32 v6, v6, v125
v_add_f32 v6, v6, v126
v_add_f32 v6, v6, v127
v_add_f32 v6, v6, v128
v_add_f32 v6, v6, v129
v_add_f32 v6, v6, v130
v_add_f32 v6, v6, v131
v_add_f32 v6, v6, v132
v_add_f32 v6, v6, v133
v_add_f32 v6, v6, v134
v_add_f32 v6, v6, v135
v_add_f32 v6, v6, v136
v_add_f32 v6, v6, v137
v_add_f32 v6, v6, v138
v_add_f32 v6, v6, v139
ds_write_b32 v5, v6 offset:12288
wl 0
s_barrier
ds_read_b128 v[200:203], v4 offset:12288
ds_read_b128 v[204:207], v4 offset:12304
ds_read_b128 v[208:211], v4 offset:12320
ds_read_b128 v[212:215], v4 offset:12336
wl 3
v_add_f32 v6, v200, v201
v_add_f32 v6, v6, v202
v_add_f32 v6, v6, v203
wl 2
v_add_f32 v6, v6, v204
v_add_f32 v6, v6, v205
v_add_f32 v6, v6, v206
v_add_f32 v6, v6, v207
wl 1
v_add_f32 v6, v6, v208
v_add_f32 v6, v6, v209
v_add_f32 v6, v6, v210
v_add_f32 v6, v6, v211
wl 0
v_add_f32 v6, v6, v212
v_add_f32 v6, v6, v213
v_add_f32 v6, v6, v214
v_add_f32 v6, v6, v215
v_mul_f32 v6, 986500301, v6
v_sub_f32 v100, v100, v6
v_sub_f32 v101, v101, v6
v_sub_f32 v102, v102, v6
v_sub_f32 v103, v103, v6
v_sub_f32 v104, v104, v6
v_sub_f32 v105, v105, v6
v_sub_f32 v106, v106, v6
v_sub_f32 v107, v107, v6
v_sub_f32 v108, v108, v6
v_sub_f32 v109, v109, v6
v_sub_f32 v110, v110, v6
v_sub_f32 v111, v111, v6
v_sub_f32 v112, v112, v6
v_sub_f32 v113, v113, v6
v_sub_f32 v114, v114, v6
v_sub_f32 v115, v115, v6
v_sub_f32 v116, v116, v6
v_sub_f32 v117, v117, v6
v_sub_f32 v118, v118, v6
v_sub_f32 v119, v119, v6
v_sub_f32 v120, v120, v6
v_sub_f32 v121, v121, v6
v_sub_f32 v122, v122, v6
v_sub_f32 v123, v123, v6
v_sub_f32 v124, v124, v6
v_sub_f32 v125, v125, v6
v_sub_f32 v126, v126, v6
v_sub_f32 v127, v127, v6
v_sub_f32 v128, v128, v6
v_sub_f32 v129, v129, v6
v_sub_f32 v130, v130, v6
v_sub_f32 v131, v131, v6
v_sub_f32 v132, v132, v6
v_sub_f32 v133, v133, v6
v_sub_f32 v134, v134, v6
v_sub_f32 v135, v135, v6
v_sub_f32 v136, v136, v6
v_sub_f32 v137, v137, v6
v_sub_f32 v138, v138, v6
v_sub_f32 v139, v139, v6
v_mul_f32 v7, v100, v100
v_fmac_f32 v7, v101, v101
v_fmac_f32 v7, v102, v102
v_fmac_f32 v7, v103, v103
v_fmac_f32 v7, v104, v104
v_fmac_f32 v7, v105, v105
v_fmac_f32 v7, v106, v106
v_fmac_f32 v7, v107, v107
v_fmac_f32 v7, v108, v108
v_fmac_f32 v7, v109, v109
v_fmac_f32 v7, v110, v110
v_fmac_f32 v7, v111, v111
v_fmac_f32 v7, v112, v112
v_fmac_f32 v7, v113, v113
v_fmac_f32 v7, v114, v114
v_fmac_f32 v7, v115, v115
v_fmac_f32 v7, v116, v116
v_fmac_f32 v7, v117, v117
v_fmac_f32 v7, v118, v118
v_fmac_f32 v7, v119, v119
v_fmac_f32 v7, v120, v120
v_fmac_f32 v7, v121, v121
v_fmac_f32 v7, v122, v122
v_fmac_f32 v7, v123, v123
v_fmac_f32 v7, v124, v124
v_fmac_f32 v7, v125, v125
v_fmac_f32 v7, v126, v126
v_fmac_f32 v7, v127, v127
v_fmac_f32 v7, v128, v128
v_fmac_f32 v7, v129, v129
v_fmac_f32 v7, v130, v130
v_fmac_f32 v7, v131, v131
v_fmac_f32 v7, v132, v132
v_fmac_f32 v7, v133, v133
v_fmac_f32 v7, v134, v134
v_fmac_f32 v7, v135, v135
v_fmac_f32 v7, v136, v136
v_fmac_f32 v7, v137, v137
v_fmac_f32 v7, v138, v138
v_fmac_f32 v7, v139, v139
ds_write_b32 v5, v7 offset:13312
wl 0
s_barrier
ds_read_b128 v[200:203], v4 offset:13312
ds_read_b128 v[204:207], v4 offset:13328
ds_read_b128 v[208:211], v4 offset:13344
ds_read_b128 v[212:215], v4 offset:13360
wl 3
v_add_f32 v7, v200, v201
v_add_f32 v7, v7, v202
v_add_f32 v7, v7, v203
wl 2
v_add_f32 v7, v7, v204
v_add_f32 v7, v7, v205
v_add_f32 v7, v7, v206
v_add_f32 v7, v7, v207
wl 1
v_add_f32 v7, v7, v208
v_add_f32 v7, v7, v209
v_add_f32 v7, v7, v210
v_add_f32 v7, v7, v211
wl 0
v_add_f32 v7, v7, v212
v_add_f32 v7, v7, v213
v_add_f32 v7, v7, v214
v_add_f32 v7, v7, v215
v_mul_f32 v7, 986500301, v7
v_add_f32 v7, 925353388, v7
v_rsq_f32 v7, v7
s_nop 0
v_mul_f32 v100, v100, v7
v_mul_f32 v101, v101, v7
v_mul_f32 v102, v102, v7
v_mul_f32 v103, v103, v7
v_mul_f32 v104, v104, v7
v_mul_f32 v105, v105, v7
v_mul_f32 v106, v106, v7
v_mul_f32 v107, v107, v7
v_mul_f32 v108, v108, v7
v_mul_f32 v109, v109, v7
v_mul_f32 v110, v110, v7
v_mul_f32 v111, v111, v7
v_mul_f32 v112, v112, v7
v_mul_f32 v113, v113, v7
v_mul_f32 v114, v114, v7
v_mul_f32 v115, v115, v7
v_mul_f32 v116, v116, v7
v_mul_f32 v117, v117, v7
v_mul_f32 v118, v118, v7
v_mul_f32 v119, v119, v7
v_mul_f32 v120, v120, v7
v_mul_f32 v121, v121, v7
v_mul_f32 v122, v122, v7
v_mul_f32 v123, v123, v7
v_mul_f32 v124, v124, v7
v_mul_f32 v125, v125, v7
v_mul_f32 v126, v126, v7
v_mul_f32 v127, v127, v7
v_mul_f32 v128, v128, v7
v_mul_f32 v129, v129, v7
v_mul_f32 v130, v130, v7
v_mul_f32 v131, v131, v7
v_mul_f32 v132, v132, v7
v_mul_f32 v133, v133, v7
v_mul_f32 v134, v134, v7
v_mul_f32 v135, v135, v7
v_mul_f32 v136, v136, v7
v_mul_f32 v137, v137, v7
v_mul_f32 v138, v138, v7
v_mul_f32 v139, v139, v7
s_cmp_lg_u32 s20, 0
s_cbranch_scc1 K01_GO
s_mov_b32 s35, 1
v_mov_b32 v12, 128
s_mov_b32 s21, 0
K01_POLL:
buffer_load_dword v13, v12, s[28:31], 0 offen sc1
wv 0
v_readfirstlane_b32 s22, v13
s_add_u32 s21, s21, 1
s_nop 2
s_cmp_ge_u32 s22, s35
s_cbranch_scc1 K01_GO
s_sleep 6
s_cmp_lt_u32 s21, 0x4000
s_cbranch_scc1 K01_POLL
K01_GO:
s_barrier
v_lshlrev_b32 v20, 4, v0
v_min_u32 v22, 2544, v20
s_mov_b32 s34, 0
buffer_load_dwordx4 v[24:27], v22, s[24:27], s34 offen sc1
s_mov_b32 s34, 15360
buffer_load_dwordx4 v[28:31], v22, s[24:27], s34 offen sc1
s_mov_b32 s34, 30720
buffer_load_dwordx4 v[32:35], v22, s[24:27], s34 offen sc1
s_mov_b32 s34, 46080
buffer_load_dwordx4 v[36:39], v22, s[24:27], s34 offen sc1
s_mov_b32 s34, 2560
buffer_load_dwordx4 v[40:43], v22, s[24:27], s34 offen sc1
s_mov_b32 s34, 17920
buffer_load_dwordx4 v[44:47], v22, s[24:27], s34 offen sc1
s_mov_b32 s34, 33280
buffer_load_dwordx4 v[48:51], v22, s[24:27], s34 offen sc1
s_mov_b32 s34, 48640
buffer_load_dwordx4 v[52:55], v22, s[24:27], s34 offen sc1
wv 6
v_add_f32 v24, v24, v28
v_add_f32 v25, v25, v29
v_add_f32 v26, v26, v30
v_add_f32 v27, v27, v31
wv 5
v_add_f32 v24, v24, v32
v_add_f32 v25, v25, v33
v_add_f32 v26, v26, v34
v_add_f32 v27, v27, v35
wv 4
v_add_f32 v24, v24, v36
v_add_f32 v25, v25, v37
v_add_f32 v26, v26, v38
v_add_f32 v27, v27, v39
cv 24,24,24
v_and_b32 v24, 0xffff0000, v24
v_mul_f32 v24, 1037384597, v24
cv 25,25,25
v_and_b32 v25, 0xffff0000, v25
v_mul_f32 v25, 1037384597, v25
cv 26,26,26
v_and_b32 v26, 0xffff0000, v26
v_mul_f32 v26, 1037384597, v26
cv 27,27,27
v_and_b32 v27, 0xffff0000, v27
v_mul_f32 v27, 1037384597, v27
ds_write_b128 v20, v[24:27] offset:0
wv 2
v_add_f32 v40, v40, v44
v_add_f32 v41, v41, v45
v_add_f32 v42, v42, v46
v_add_f32 v43, v43, v47
wv 1
v_add_f32 v40, v40, v48
v_add_f32 v41, v41, v49
v_add_f32 v42, v42, v50
v_add_f32 v43, v43, v51
wv 0
v_add_f32 v40, v40, v52
v_add_f32 v41, v41, v53
v_add_f32 v42, v42, v54
v_add_f32 v43, v43, v55
cv 40,40,40
v_and_b32 v40, 0xffff0000, v40
v_add_f32 v40, 1.0, v40
v_mul_f32 v40, 1037384597, v40
cv 41,41,41
v_and_b32 v41, 0xffff0000, v41
v_add_f32 v41, 1.0, v41
v_mul_f32 v41, 1037384597, v41
cv 42,42,42
v_and_b32 v42, 0xffff0000, v42
v_add_f32 v42, 1.0, v42
v_mul_f32 v42, 1037384597, v42
cv 43,43,43
v_and_b32 v43, 0xffff0000, v43
v_add_f32 v43, 1.0, v43
v_mul_f32 v43, 1037384597, v43
ds_write_b128 v20, v[40:43] offset:4096
wl 0
s_barrier
s_mul_i32 s3, s20, 640
v_lshlrev_b32 v8, 4, v3
v_add_u32 v8, s3, v8
ds_read_b128 v[200:203], v8 offset:4096
ds_read_b128 v[204:207], v8 offset:0
wl 0
v_fma_f32 v100, v100, v200, v204
v_fma_f32 v101, v101, v201, v205
v_fma_f32 v102, v102, v202, v206
v_fma_f32 v103, v103, v203, v207
cv 160,100,101
cv 161,102,103
ds_read_b128 v[208:211], v8 offset:4160
ds_read_b128 v[212:215], v8 offset:64
wl 0
v_fma_f32 v104, v104, v208, v212
v_fma_f32 v105, v105, v209, v213
v_fma_f32 v106, v106, v210, v214
v_fma_f32 v107, v107, v211, v215
cv 162,104,105
cv 163,106,107
ds_read_b128 v[200:203], v8 offset:4224
ds_read_b128 v[204:207], v8 offset:128
wl 0
v_fma_f32 v108, v108, v200, v204
v_fma_f32 v109, v109, v201, v205
v_fma_f32 v110, v110, v202, v206
v_fma_f32 v111, v111, v203, v207
cv 164,108,109
cv 165,110,111
ds_read_b128 v[208:211], v8 offset:4288
ds_read_b128 v[212:215], v8 offset:192
wl 0
v_fma_f32 v112, v112, v208, v212
v_fma_f32 v113, v113, v209, v213
v_fma_f32 v114, v114, v210, v214
v_fma_f32 v115, v115, v211, v215
cv 166,112,113
cv 167,114,115
ds_read_b128 v[200:203], v8 offset:4352
ds_read_b128 v[204:207], v8 offset:256
wl 0
v_fma_f32 v116, v116, v200, v204
v_fma_f32 v117, v117, v201, v205
v_fma_f32 v118, v118, v202, v206
v_fma_f32 v119, v119, v203, v207
cv 168,116,117
cv 169,118,119
ds_read_b128 v[208:211], v8 offset:4416
ds_read_b128 v[212:215], v8 offset:320
wl 0
v_fma_f32 v120, v120, v208, v212
v_fma_f32 v121, v121, v209, v213
v_fma_f32 v122, v122, v210, v214
v_fma_f32 v123, v123, v211, v215
cv 170,120,121
cv 171,122,123
ds_read_b128 v[200:203], v8 offset:4480
ds_read_b128 v[204:207], v8 offset:384
wl 0
v_fma_f32 v124, v124, v200, v204
v_fma_f32 v125, v125, v201, v205
v_fma_f32 v126, v126, v202, v206
v_fma_f32 v127, v127, v203, v207
cv 172,124,125
cv 173,126,127
ds_read_b128 v[208:211], v8 offset:4544
ds_read_b128 v[212:215], v8 offset:448
wl 0
v_fma_f32 v128, v128, v208, v212
v_fma_f32 v129, v129, v209, v213
v_fma_f32 v130, v130, v210, v214
v_fma_f32 v131, v131, v211, v215
cv 174,128,129
cv 175,130,131
ds_read_b128 v[200:203], v8 offset:4608
ds_read_b128 v[204:207], v8 offset:512
wl 0
v_fma_f32 v132, v132, v200, v204
v_fma_f32 v133, v133, v201, v205
v_fma_f32 v134, v134, v202, v206
v_fma_f32 v135, v135, v203, v207
cv 176,132,133
cv 177,134,135
ds_read_b128 v[208:211], v8 offset:4672
ds_read_b128 v[212:215], v8 offset:576
wl 0
v_fma_f32 v136, v136, v208, v212
v_fma_f32 v137, v137, v209, v213
v_fma_f32 v138, v138, v210, v214
v_fma_f32 v139, v139, v211, v215
cv 178,136,137
cv 179,138,139
s_mul_i32 s3, s2, 20480
s_mul_i32 s21, s20, 5120
s_add_u32 s3, s3, s21
s_add_u32 s3, s3, 262144
v_lshlrev_b32 v11, 4, v10
v_add_u32 v11, s3, v11
s_mov_b32 s21, 0
buffer_store_dwordx4 v[160:163], v11, s[24:27], s21 offen sc1
s_mov_b32 s21, 1024
buffer_store_dwordx4 v[164:167], v11, s[24:27], s21 offen sc1
s_mov_b32 s21, 2048
buffer_store_dwordx4 v[168:171], v11, s[24:27], s21 offen sc1
s_mov_b32 s21, 3072
buffer_store_dwordx4 v[172:175], v11, s[24:27], s21 offen sc1
s_mov_b32 s21, 4096
buffer_store_dwordx4 v[176:179], v11, s[24:27], s21 offen sc1
s_endpgm
K01_PF:
s_mov_b64 exec, -1
s_and_b32 s21, s2, 7
s_lshr_b32 s22, s2, 3
s_cmp_lt_u32 s2, 40
s_cselect_b32 s3, 0, 16
s_sub_u32 s22, s22, s3
v_subrev_u32 v1, 64, v0
s_getpc_b64 s[4:5]
K01_PC:
s_add_u32 s4, s4, k2_kernel-K01_PC
s_addc_u32 s5, s5, 0
s_mul_i32 s3, s22, 9216
v_lshlrev_b32 v2, 4, v1
v_add_u32 v2, s3, v2
s_mov_b32 s23, K_TEXT_END-k2_kernel-16
v_min_u32 v3, s23, v2
global_load_dwordx4 v[4:7], v3, s[4:5]
v_add_u32 v2, 3072, v2
v_min_u32 v3, s23, v2
global_load_dwordx4 v[4:7], v3, s[4:5]
v_add_u32 v2, 3072, v2
v_min_u32 v3, s23, v2
global_load_dwordx4 v[4:7], v3, s[4:5]
v_add_u32 v2, 3072, v2
s_mov_b32 s8, s40
s_mov_b32 s9, s41
s_mov_b32 s10, 7864320
s_mov_b32 s11, 0x20000
s_mul_i32 s3, s22, 4224
v_add_u32 v1, s3, v1
s_mul_i32 s23, s21, 1536
s_mov_b32 s24, 22
K01_PFL:
v_mul_u32_u24 v2, 682, v1
v_lshrrev_b32 v2, 16, v2
v_mul_u32_u24 v3, 96, v2
v_sub_u32 v3, v1, v3
v_cmp_le_i32 vcc, 96, v3
s_nop 1
v_addc_co_u32 v2, vcc, 0, v2, vcc
v_mul_u32_u24 v3, 96, v2
v_sub_u32 v3, v1, v3
v_lshlrev_b32 v3, 4, v3
v_mul_u32_u24 v2, 12288, v2
v_add_u32 v2, v2, v3
buffer_load_dwordx4 v[4:7], v2, s[8:11], s23 offen
v_add_u32 v1, 192, v1
s_sub_u32 s24, s24, 1
s_cmp_lg_u32 s24, 0
s_cbranch_scc1 K01_PFL
s_endpgm
.globl k2_kernel
.p2align 8
.type k2_kernel,@function
k2_kernel:
s_cmp_ge_u32 s2, 256
s_cbranch_scc1 KT_END
s_load_dwordx2 s[4:5], s[0:1], 24
s_load_dwordx2 s[6:7], s[0:1], 104
s_load_dwordx4 s[44:47], s[0:1], 8
s_load_dwordx2 s[68:69], s[0:1], 32
s_load_dwordx4 s[72:75], s[0:1], 48
s_load_dwordx2 s[70:71], s[0:1], 64
v_lshrrev_b32 v2, 6, v0
v_and_b32 v0, 63, v0
v_readfirstlane_b32 s26, v2
s_and_b32 s24, s2, 7
s_lshl_b32 s24, s24, 2
s_lshr_b32 s3, s2, 3
s_and_b32 s3, s3, 3
s_add_u32 s24, s24, s3
s_lshr_b32 s25, s2, 5
v_lshrrev_b32 v60, 3, v0
v_and_b32 v61, 7, v0
v_lshrrev_b32 v62, 4, v0
v_lshlrev_b32 v63, 1, v62
v_xor_b32 v63, v63, v61
v_lshlrev_b32 v63, 4, v63
s_lshl_b32 s3, s26, 3
v_add_u32 v1, s3, v60
s_mov_b32 s37, 12288
v_mul_lo_u32 v1, v1, s37
v_add_u32 v1, v1, v63
v_add_u32 v1, 4096, v1
v_add_u32 v2, -896, v1
v_add_u32 v3, -1792, v1
s_lshl_b32 s3, s25, 4
s_lshl_b32 s37, s26, 2
s_add_u32 s38, s3, s37
s_mul_i32 s3, s38, 20480
s_add_u32 s3, s3, 262144
v_lshlrev_b32 v23, 4, v0
v_add_u32 v23, s3, v23
v_add_u32 v24, 20480, v23
v_add_u32 v25, 40960, v23
v_add_u32 v26, 61440, v23
s_mul_i32 s27, s26, 3072
s_mul_i32 s3, s24, 384
wl 0
wl 0
s_add_u32 s8, s4, s3
s_addc_u32 s9, s5, 0
s_sub_u32 s8, s8, 4096
s_subb_u32 s9, s9, 0
s_sub_u32 s10, 7868416, s3
s_mov_b32 s11, 0x20000
s_mov_b32 s20, s6
s_mov_b32 s21, s7
s_mov_b32 s22, 268435456
s_mov_b32 s23, 0x20000
s_mov_b32 s31, 0
buffer_load_dwordx4 a[0:3], v23, s[20:23], s31 offen
buffer_load_dwordx4 a[4:7], v24, s[20:23], s31 offen
buffer_load_dwordx4 a[8:11], v25, s[20:23], s31 offen
buffer_load_dwordx4 a[12:15], v26, s[20:23], s31 offen
s_add_u32 m0, s27, 0
s_mov_b32 s30, 0
dm 1,8,30,0
dm 2,8,30,1024
dm 3,8,30,2048
v_lshrrev_b32 v60, 2, v0
v_and_b32 v60, 3, v60
v_and_b32 v61, 3, v0
v_lshlrev_b32 v61, 3, v61
v_and_b32 v11, 1, v62
v_lshlrev_b32 v11, 2, v11
v_add_u32 v11, v11, v60
v_lshrrev_b32 v12, 1, v11
v_lshlrev_b32 v11, 7, v11
v_lshrrev_b32 v13, 1, v62
v_mul_u32_u24 v13, 3072, v13
v_add_u32 v11, v11, v13
v_add_u32 v11, v11, v61
v_lshlrev_b32 v12, 5, v12
v_xor_b32 v63, 96, v12
v_add_u32 v14, v11, v63
v_xor_b32 v63, 64, v12
v_add_u32 v13, v11, v63
v_xor_b32 v63, 32, v12
v_add_u32 v63, v11, v63
v_add_u32 v11, v11, v12
v_mov_b32 v12, v63
v_lshrrev_b32 v19, 1, v62
v_lshlrev_b32 v19, 2, v19
v_add_u32 v19, v19, v60
v_lshrrev_b32 v20, 1, v19
v_and_b32 v20, 1, v20
v_and_b32 v21, 1, v62
v_lshlrev_b32 v22, 1, v21
v_or_b32 v20, v20, v22
v_lshlrev_b32 v20, 5, v20
v_lshlrev_b32 v19, 7, v19
v_lshlrev_b32 v21, 10, v21
v_add_u32 v19, v19, v21
v_add_u32 v19, v19, v61
v_add_u32 v19, 98304, v19
v_xor_b32 v63, 96, v20
v_add_u32 v22, v19, v63
v_xor_b32 v63, 64, v20
v_add_u32 v21, v19, v63
v_xor_b32 v63, 32, v20
v_add_u32 v63, v19, v63
v_add_u32 v19, v19, v20
v_mov_b32 v20, v63
s_add_u32 s28, s27, 36864
s_lshl_b32 s29, s26, 12
s_add_u32 s29, s29, 98304
s_mul_i32 s3, s24, 786432
s_add_u32 s3, s3, 585728
s_add_u32 s12, s44, s3
s_addc_u32 s13, s45, 0
s_mov_b32 s14, 200704
s_mov_b32 s15, 0x20000
s_add_u32 s16, s46, s3
s_addc_u32 s17, s47, 0
s_mov_b32 s18, 200704
s_mov_b32 s19, 0x20000
s_mov_b32 s52, s68
s_mov_b32 s53, s69
s_mov_b32 s54, 7864320
s_mov_b32 s55, 0x20000
s_mov_b32 s56, s72
s_mov_b32 s57, s73
s_mov_b32 s58, 1966080
s_mov_b32 s59, 0x20000
s_mov_b32 s60, s74
s_mov_b32 s61, s75
s_mov_b32 s62, 1966080
s_mov_b32 s63, 0x20000
s_mov_b32 s64, s70
s_mov_b32 s65, s71
s_mov_b32 s66, 1966080
s_mov_b32 s67, 0x20000
s_add_u32 m0, s27, 12288
s_mov_b32 s30, 393216
dm 1,8,30,0
dm 2,8,30,1024
dm 3,8,30,2048
s_mov_b32 s31, 1024
buffer_load_dwordx4 a[16:19], v23, s[20:23], s31 offen
buffer_load_dwordx4 a[20:23], v24, s[20:23], s31 offen
buffer_load_dwordx4 a[24:27], v25, s[20:23], s31 offen
buffer_load_dwordx4 a[28:31], v26, s[20:23], s31 offen
s_add_u32 m0, s27, 24576
s_mov_b32 s30, 786432
dm 1,8,30,0
dm 2,8,30,1024
dm 3,8,30,2048
s_add_u32 m0, s27, 36864
s_mov_b32 s30, 1179648
dm 1,8,30,0
dm 2,8,30,1024
dm 3,8,30,2048
s_getpc_b64 s[48:49]
v_lshlrev_b32 v60, 2, v0
s_lshl_b32 s3, s26, 8
v_add_u32 v60, s3, v60
v_lshlrev_b32 v60, 4, v60
global_load_dword v61, v60, s[48:49]
v_add_u32 v60, 16384, v60
global_load_dword v61, v60, s[48:49]
v_add_u32 v60, 16384, v60
global_load_dword v61, v60, s[48:49]
v_add_u32 v60, 16384, v60
wv 16
s_barrier
ta 192,11,0
ta 194,11,6144
ta 196,12,0
ta 198,12,6144
ta 200,13,0
ta 202,13,6144
ta 204,14,0
ta 206,14,6144
wl 6
v_mfma_f32_16x16x32_bf16 v[64:67], a[192:195], a[0:3], 0
s_mov_b32 s31, 2048
ta 208,11,1024
v_lshrrev_b32 v56, 3, v0
v_mfma_f32_16x16x32_bf16 v[68:71], a[192:195], a[4:7], 0
ta 210,11,7168
v_and_b32 v57, 7, v0
v_mfma_f32_16x16x32_bf16 v[72:75], a[192:195], a[8:11], 0
buffer_load_dwordx4 a[32:35], v23, s[20:23], s31 offen
v_lshrrev_b32 v58, 4, v0
v_mfma_f32_16x16x32_bf16 v[76:79], a[192:195], a[12:15], 0
wl 6
s_lshl_b32 s3, s26, 3
v_add_u32 v4, s3, v56
v_mfma_f32_16x16x32_bf16 v[80:83], a[196:199], a[0:3], 0
ta 212,12,1024
v_lshrrev_b32 v59, 1, v4
v_mfma_f32_16x16x32_bf16 v[84:87], a[196:199], a[4:7], 0
ta 214,12,7168
v_and_b32 v59, 7, v59
v_mfma_f32_16x16x32_bf16 v[88:91], a[196:199], a[8:11], 0
buffer_load_dwordx4 a[36:39], v24, s[20:23], s31 offen
v_xor_b32 v59, v59, v57
v_mfma_f32_16x16x32_bf16 v[92:95], a[196:199], a[12:15], 0
wl 6
v_lshlrev_b32 v59, 4, v59
v_mul_u32_u24 v4, 384, v4
v_mfma_f32_16x16x32_bf16 v[96:99], a[200:203], a[0:3], 0
ta 216,13,1024
v_add_u32 v4, v4, v59
v_mfma_f32_16x16x32_bf16 v[100:103], a[200:203], a[4:7], 0
ta 218,13,7168
v_add_u32 v4, 4096, v4
v_mfma_f32_16x16x32_bf16 v[104:107], a[200:203], a[8:11], 0
buffer_load_dwordx4 a[40:43], v25, s[20:23], s31 offen
v_add_u32 v5, -896, v4
v_mfma_f32_16x16x32_bf16 v[108:111], a[200:203], a[12:15], 0
wl 6
v_add_u32 v6, -1792, v4
v_and_b32 v59, 1, v58
v_mfma_f32_16x16x32_bf16 v[112:115], a[204:207], a[0:3], 0
ta 220,14,1024
v_lshlrev_b32 v59, 1, v59
v_mfma_f32_16x16x32_bf16 v[116:119], a[204:207], a[4:7], 0
ta 222,14,7168
v_xor_b32 v59, v59, v57
v_mfma_f32_16x16x32_bf16 v[120:123], a[204:207], a[8:11], 0
buffer_load_dwordx4 a[44:47], v26, s[20:23], s31 offen
s_lshl_b32 s3, s26, 5
v_mfma_f32_16x16x32_bf16 v[124:127], a[204:207], a[12:15], 0
wl 6
v_add_u32 v7, s3, v56
v_mul_u32_u24 v7, 384, v7
v_mfma_f32_16x16x32_bf16 v[128:131], a[208:211], a[0:3], 0
ta 224,11,2048
v_add_u32 v7, 4096, v7
v_mfma_f32_16x16x32_bf16 v[132:135], a[208:211], a[4:7], 0
ta 226,11,8192
v_xor_b32 v8, 4, v59
v_mfma_f32_16x16x32_bf16 v[136:139], a[208:211], a[8:11], 0
v_lshlrev_b32 v8, 4, v8
v_lshlrev_b32 v59, 4, v59
v_mfma_f32_16x16x32_bf16 v[140:143], a[208:211], a[12:15], 0
wl 6
v_add_u32 v8, v8, v7
v_add_u32 v7, v7, v59
v_mfma_f32_16x16x32_bf16 v[144:147], a[212:215], a[0:3], 0
ta 228,12,2048
v_add_u32 v9, 4096, v7
v_mfma_f32_16x16x32_bf16 v[148:151], a[212:215], a[4:7], 0
ta 230,12,8192
v_add_u32 v10, 6144, v8
v_mfma_f32_16x16x32_bf16 v[152:155], a[212:215], a[8:11], 0
v_add_u32 v8, 2048, v8
v_and_b32 v56, 31, v0
v_mfma_f32_16x16x32_bf16 v[156:159], a[212:215], a[12:15], 0
wl 6
v_lshrrev_b32 v57, 3, v56
v_mul_u32_u24 v57, 3072, v57
v_mfma_f32_16x16x32_bf16 v[160:163], a[216:219], a[0:3], 0
ta 232,13,2048
v_and_b32 v59, 7, v56
v_mfma_f32_16x16x32_bf16 v[164:167], a[216:219], a[4:7], 0
ta 234,13,8192
v_lshlrev_b32 v59, 7, v59
v_mfma_f32_16x16x32_bf16 v[168:171], a[216:219], a[8:11], 0
v_add_u32 v57, v57, v59
v_add_u32 v57, 36864, v57
v_mfma_f32_16x16x32_bf16 v[172:175], a[216:219], a[12:15], 0
wl 6
v_lshrrev_b32 v56, 1, v56
v_and_b32 v56, 7, v56
v_mfma_f32_16x16x32_bf16 v[176:179], a[220:223], a[0:3], 0
ta 236,14,2048
v_lshrrev_b32 v59, 5, v0
v_mfma_f32_16x16x32_bf16 v[180:183], a[220:223], a[4:7], 0
ta 238,14,8192
s_add_u32 m0, s27, 49152
v_mfma_f32_16x16x32_bf16 v[184:187], a[220:223], a[8:11], 0
s_mov_b32 s30, 1572864
v_xor_b32 v56, v56, v59
v_xor_b32 v59, 0, v56
v_mfma_f32_16x16x32_bf16 v[188:191], a[220:223], a[12:15], 0
wl 6
wv 17
s_barrier
v_mfma_f32_16x16x32_bf16 v[192:195], a[224:227], a[0:3], 0
ta 240,11,12288
v_lshlrev_b32 v59, 4, v59
v_mfma_f32_16x16x32_bf16 v[196:199], a[224:227], a[4:7], 0
ta 242,11,18432
v_add_u32 v15, v57, v59
v_mfma_f32_16x16x32_bf16 v[200:203], a[224:227], a[8:11], 0
dm 1,8,30,0
v_xor_b32 v59, 2, v56
v_mfma_f32_16x16x32_bf16 v[204:207], a[224:227], a[12:15], 0
wl 6
v_lshlrev_b32 v59, 4, v59
v_add_u32 v16, v57, v59
v_mfma_f32_16x16x32_bf16 v[208:211], a[228:231], a[0:3], 0
ta 244,12,12288
v_xor_b32 v59, 4, v56
v_mfma_f32_16x16x32_bf16 v[212:215], a[228:231], a[4:7], 0
ta 246,12,18432
v_lshlrev_b32 v59, 4, v59
v_mfma_f32_16x16x32_bf16 v[216:219], a[228:231], a[8:11], 0
dm 2,8,30,1024
v_add_u32 v17, v57, v59
v_mfma_f32_16x16x32_bf16 v[220:223], a[228:231], a[12:15], 0
wl 6
v_xor_b32 v59, 6, v56
v_lshlrev_b32 v59, 4, v59
v_mfma_f32_16x16x32_bf16 v[224:227], a[232:235], a[0:3], 0
ta 248,13,12288
v_add_u32 v18, v57, v59
v_mfma_f32_16x16x32_bf16 v[228:231], a[232:235], a[4:7], 0
ta 250,13,18432
v_lshlrev_b32 v27, 7, v0
v_mfma_f32_16x16x32_bf16 v[232:235], a[232:235], a[8:11], 0
dm 3,8,30,2048
v_mov_b32 v59, 0x7ff00000
v_mfma_f32_16x16x32_bf16 v[236:239], a[232:235], a[12:15], 0
wl 6
v_cmp_gt_u32 vcc, 16, v0
v_mfma_f32_16x16x32_bf16 v[240:243], a[236:239], a[0:3], 0
ta 252,14,12288
v_mfma_f32_16x16x32_bf16 v[244:247], a[236:239], a[4:7], 0
ta 254,14,18432
s_mov_b32 s31, 3072
v_mfma_f32_16x16x32_bf16 v[248:251], a[236:239], a[8:11], 0
s_nop 1
v_cndmask_b32 v27, v59, v27, vcc
v_mfma_f32_16x16x32_bf16 v[252:255], a[236:239], a[12:15], 0
wl 6
wv 16
s_mul_i32 s96, s25, 24576
xaa 64,240,16
ta 192,11,13312
s_mul_i32 s99, s26, 6144
xaa 68,240,20
ta 194,11,19456
s_add_u32 s96, s96, s99
xaa 72,240,24
buffer_load_dwordx4 a[0:3], v23, s[20:23], s31 offen
s_add_u32 s96, s96, 4096
xaa 76,240,28
wl 6
s_lshl_b32 s99, s2, 2
s_add_u32 s99, s99, s26
xaa 80,244,16
ta 196,12,13312
s_mul_i32 s98, s99, 1920
xaa 84,244,20
ta 198,12,19456
s_and_b32 s97, s2, 3
xaa 88,244,24
buffer_load_dwordx4 a[4:7], v24, s[20:23], s31 offen
s_mul_i32 s97, s97, 1966080
xaa 92,244,28
wl 6
s_lshr_b32 s99, s2, 3
s_lshl_b32 s99, s99, 2
xaa 96,248,16
ta 200,13,13312
s_add_u32 s99, s99, s26
xaa 100,248,20
ta 202,13,19456
s_mul_i32 s99, s99, 15360
xaa 104,248,24
buffer_load_dwordx4 a[8:11], v25, s[20:23], s31 offen
s_add_u32 s97, s97, s99
xaa 108,248,28
wl 6
xaa 112,252,16
ta 204,14,13312
xaa 116,252,20
ta 206,14,19456
xaa 120,252,24
buffer_load_dwordx4 a[12:15], v26, s[20:23], s31 offen
xaa 124,252,28
wl 6
xaa 128,192,16
ta 208,11,14336
xaa 132,192,20
ta 210,11,20480
xaa 136,192,24
xaa 140,192,28
wl 6
xaa 144,196,16
ta 212,12,14336
xaa 148,196,20
ta 214,12,20480
xaa 152,196,24
xaa 156,196,28
wl 6
xaa 160,200,16
ta 216,13,14336
xaa 164,200,20
ta 218,13,20480
xaa 168,200,24
xaa 172,200,28
wl 6
xaa 176,204,16
ta 220,14,14336
xaa 180,204,20
ta 222,14,20480
s_add_u32 m0, s27, 0
xaa 184,204,24
s_mov_b32 s30, 1966080
xaa 188,204,28
wl 6
wv 17
s_barrier
xaa 192,208,16
ta 224,11,24576
xaa 196,208,20
ta 226,11,30720
xaa 200,208,24
dm 1,8,30,0
xaa 204,208,28
wl 6
xaa 208,212,16
ta 228,12,24576
xaa 212,212,20
ta 230,12,30720
xaa 216,212,24
dm 2,8,30,1024
xaa 220,212,28
wl 6
xaa 224,216,16
ta 232,13,24576
xaa 228,216,20
ta 234,13,30720
xaa 232,216,24
dm 3,8,30,2048
xaa 236,216,28
wl 6
xaa 240,220,16
ta 236,14,24576
xaa 244,220,20
ta 238,14,30720
s_mov_b32 s31, 4096
xaa 248,220,24
xaa 252,220,28
wl 6
wv 10
xaa 64,224,32
ta 240,11,25600
xaa 68,224,36
ta 242,11,31744
xaa 72,224,40
buffer_load_dwordx4 a[16:19], v23, s[20:23], s31 offen
xaa 76,224,44
wl 6
xaa 80,228,32
ta 244,12,25600
xaa 84,228,36
ta 246,12,31744
xaa 88,228,40
buffer_load_dwordx4 a[20:23], v24, s[20:23], s31 offen
xaa 92,228,44
wl 6
xaa 96,232,32
ta 248,13,25600
xaa 100,232,36
ta 250,13,31744
xaa 104,232,40
buffer_load_dwordx4 a[24:27], v25, s[20:23], s31 offen
xaa 108,232,44
wl 6
xaa 112,236,32
ta 252,14,25600
xaa 116,236,36
ta 254,14,31744
xaa 120,236,40
buffer_load_dwordx4 a[28:31], v26, s[20:23], s31 offen
xaa 124,236,44
wl 6
xaa 128,240,32
ta 192,11,26624
xaa 132,240,36
ta 194,11,32768
xaa 136,240,40
xaa 140,240,44
wl 6
xaa 144,244,32
ta 196,12,26624
s_add_u32 s99, s96, 0
xaa 148,244,36
ta 198,12,32768
xaa 152,244,40
buffer_load_dword a191, v27, s[12:15], s99 offen
xaa 156,244,44
wl 6
xaa 160,248,32
ta 200,13,26624
xaa 164,248,36
ta 202,13,32768
xaa 168,248,40
xaa 172,248,44
wl 6
xaa 176,252,32
ta 204,14,26624
xaa 180,252,36
ta 206,14,32768
s_add_u32 m0, s27, 12288
xaa 184,252,40
s_mov_b32 s30, 2359296
xaa 188,252,44
wl 6
s_barrier
xaa 192,192,32
ta 208,11,36864
xaa 196,192,36
ta 210,11,43008
xaa 200,192,40
dm 1,8,30,0
xaa 204,192,44
wl 6
xaa 208,196,32
ta 212,12,36864
xaa 212,196,36
ta 214,12,43008
xaa 216,196,40
dm 2,8,30,1024
xaa 220,196,44
wl 6
xaa 224,200,32
ta 216,13,36864
xaa 228,200,36
ta 218,13,43008
xaa 232,200,40
dm 3,8,30,2048
xaa 236,200,44
wl 6
xaa 240,204,32
ta 220,14,36864
xaa 244,204,36
ta 222,14,43008
s_mov_b32 s31, 5120
xaa 248,204,40
xaa 252,204,44
wl 6
wv 11
xaa 64,208,0
ta 224,11,37888
xaa 68,208,4
ta 226,11,44032
xaa 72,208,8
buffer_load_dwordx4 a[32:35], v23, s[20:23], s31 offen
xaa 76,208,12
wl 6
xaa 80,212,0
ta 228,12,37888
xaa 84,212,4
ta 230,12,44032
xaa 88,212,8
buffer_load_dwordx4 a[36:39], v24, s[20:23], s31 offen
xaa 92,212,12
wl 6
xaa 96,216,0
ta 232,13,37888
xaa 100,216,4
ta 234,13,44032
xaa 104,216,8
buffer_load_dwordx4 a[40:43], v25, s[20:23], s31 offen
xaa 108,216,12
wl 6
xaa 112,220,0
ta 236,14,37888
xaa 116,220,4
ta 238,14,44032
xaa 120,220,8
buffer_load_dwordx4 a[44:47], v26, s[20:23], s31 offen
xaa 124,220,12
wl 6
xaa 128,224,0
ta 240,11,38912
xaa 132,224,4
ta 242,11,45056
xaa 136,224,8
xaa 140,224,12
wl 6
xaa 144,228,0
ta 244,12,38912
xaa 148,228,4
ta 246,12,45056
xaa 152,228,8
xaa 156,228,12
wl 6
xaa 160,232,0
ta 248,13,38912
xaa 164,232,4
ta 250,13,45056
xaa 168,232,8
xaa 172,232,12
wl 6
xaa 176,236,0
ta 252,14,38912
xaa 180,236,4
ta 254,14,45056
s_add_u32 m0, s27, 24576
xaa 184,236,8
s_mov_b32 s30, 2752512
xaa 188,236,12
wl 6
s_barrier
xaa 192,240,0
ta 192,11,49152
xaa 196,240,4
ta 194,11,55296
xaa 200,240,8
dm 1,8,30,0
xaa 204,240,12
wl 6
xaa 208,244,0
ta 196,12,49152
xaa 212,244,4
ta 198,12,55296
xaa 216,244,8
dm 2,8,30,1024
xaa 220,244,12
wl 6
xaa 224,248,0
ta 200,13,49152
xaa 228,248,4
ta 202,13,55296
xaa 232,248,8
dm 3,8,30,2048
xaa 236,248,12
wl 6
xaa 240,252,0
ta 204,14,49152
xaa 244,252,4
ta 206,14,55296
s_mov_b32 s31, 6144
xaa 248,252,8
xaa 252,252,12
wl 6
wv 11
xaa 64,192,16
ta 208,11,50176
xaa 68,192,20
ta 210,11,56320
xaa 72,192,24
buffer_load_dwordx4 a[0:3], v23, s[20:23], s31 offen
xaa 76,192,28
wl 6
xaa 80,196,16
ta 212,12,50176
xaa 84,196,20
ta 214,12,56320
xaa 88,196,24
buffer_load_dwordx4 a[4:7], v24, s[20:23], s31 offen
xaa 92,196,28
wl 6
xaa 96,200,16
ta 216,13,50176
xaa 100,200,20
ta 218,13,56320
xaa 104,200,24
buffer_load_dwordx4 a[8:11], v25, s[20:23], s31 offen
xaa 108,200,28
wl 6
xaa 112,204,16
ta 220,14,50176
xaa 116,204,20
ta 222,14,56320
xaa 120,204,24
buffer_load_dwordx4 a[12:15], v26, s[20:23], s31 offen
xaa 124,204,28
wl 6
xaa 128,208,16
ta 224,11,51200
xaa 132,208,20
ta 226,11,57344
xaa 136,208,24
xaa 140,208,28
wl 6
xaa 144,212,16
ta 228,12,51200
s_add_u32 s99, s96, 2048
xaa 148,212,20
ta 230,12,57344
xaa 152,212,24
buffer_load_dword a191, v27, s[12:15], s99 offen
xaa 156,212,28
wl 6
xaa 160,216,16
ta 232,13,51200
xaa 164,216,20
ta 234,13,57344
xaa 168,216,24
xaa 172,216,28
wl 6
xaa 176,220,16
ta 236,14,51200
xaa 180,220,20
ta 238,14,57344
s_add_u32 m0, s27, 36864
xaa 184,220,24
s_mov_b32 s30, 3145728
xaa 188,220,28
wl 6
s_barrier
xaa 192,224,16
ta 240,11,0
xaa 196,224,20
ta 242,11,6144
xaa 200,224,24
dm 1,8,30,0
xaa 204,224,28
wl 6
xaa 208,228,16
ta 244,12,0
xaa 212,228,20
ta 246,12,6144
xaa 216,228,24
dm 2,8,30,1024
xaa 220,228,28
wl 6
xaa 224,232,16
ta 248,13,0
xaa 228,232,20
ta 250,13,6144
xaa 232,232,24
dm 3,8,30,2048
xaa 236,232,28
wl 6
xaa 240,236,16
ta 252,14,0
xaa 244,236,20
ta 254,14,6144
s_mov_b32 s31, 7168
xaa 248,236,24
xaa 252,236,28
wl 6
wv 11
xaa 64,240,32
ta 192,11,1024
xaa 68,240,36
ta 194,11,7168
xaa 72,240,40
buffer_load_dwordx4 a[16:19], v23, s[20:23], s31 offen
xaa 76,240,44
wl 6
xaa 80,244,32
ta 196,12,1024
xaa 84,244,36
ta 198,12,7168
xaa 88,244,40
buffer_load_dwordx4 a[20:23], v24, s[20:23], s31 offen
xaa 92,244,44
wl 6
xaa 96,248,32
ta 200,13,1024
xaa 100,248,36
ta 202,13,7168
xaa 104,248,40
buffer_load_dwordx4 a[24:27], v25, s[20:23], s31 offen
xaa 108,248,44
wl 6
xaa 112,252,32
ta 204,14,1024
xaa 116,252,36
ta 206,14,7168
xaa 120,252,40
buffer_load_dwordx4 a[28:31], v26, s[20:23], s31 offen
xaa 124,252,44
wl 6
xaa 128,192,32
ta 208,11,2048
xaa 132,192,36
ta 210,11,8192
xaa 136,192,40
xaa 140,192,44
wl 6
xaa 144,196,32
ta 212,12,2048
xaa 148,196,36
ta 214,12,8192
xaa 152,196,40
xaa 156,196,44
wl 6
xaa 160,200,32
ta 216,13,2048
xaa 164,200,36
ta 218,13,8192
xaa 168,200,40
xaa 172,200,44
wl 6
xaa 176,204,32
ta 220,14,2048
xaa 180,204,36
ta 222,14,8192
s_add_u32 m0, s27, 49152
xaa 184,204,40
s_mov_b32 s30, 3538944
xaa 188,204,44
wl 6
s_barrier
xaa 192,208,32
ta 224,11,12288
xaa 196,208,36
ta 226,11,18432
xaa 200,208,40
dm 1,8,30,0
xaa 204,208,44
wl 6
xaa 208,212,32
ta 228,12,12288
xaa 212,212,36
ta 230,12,18432
xaa 216,212,40
dm 2,8,30,1024
xaa 220,212,44
wl 6
xaa 224,216,32
ta 232,13,12288
xaa 228,216,36
ta 234,13,18432
xaa 232,216,40
dm 3,8,30,2048
xaa 236,216,44
wl 6
xaa 240,220,32
ta 236,14,12288
xaa 244,220,36
ta 238,14,18432
s_mov_b32 s31, 8192
xaa 248,220,40
xaa 252,220,44
wl 6
wv 11
xaa 64,224,0
ta 240,11,13312
xaa 68,224,4
ta 242,11,19456
xaa 72,224,8
buffer_load_dwordx4 a[32:35], v23, s[20:23], s31 offen
xaa 76,224,12
wl 6
xaa 80,228,0
ta 244,12,13312
xaa 84,228,4
ta 246,12,19456
xaa 88,228,8
buffer_load_dwordx4 a[36:39], v24, s[20:23], s31 offen
xaa 92,228,12
wl 6
xaa 96,232,0
ta 248,13,13312
xaa 100,232,4
ta 250,13,19456
xaa 104,232,8
buffer_load_dwordx4 a[40:43], v25, s[20:23], s31 offen
xaa 108,232,12
wl 6
xaa 112,236,0
ta 252,14,13312
xaa 116,236,4
ta 254,14,19456
xaa 120,236,8
buffer_load_dwordx4 a[44:47], v26, s[20:23], s31 offen
xaa 124,236,12
wl 6
xaa 128,240,0
ta 192,11,14336
xaa 132,240,4
ta 194,11,20480
xaa 136,240,8
xaa 140,240,12
wl 6
xaa 144,244,0
ta 196,12,14336
s_add_u32 s99, s96, 4096
xaa 148,244,4
ta 198,12,20480
xaa 152,244,8
buffer_load_dword a191, v27, s[12:15], s99 offen
xaa 156,244,12
wl 6
xaa 160,248,0
ta 200,13,14336
xaa 164,248,4
ta 202,13,20480
xaa 168,248,8
xaa 172,248,12
wl 6
xaa 176,252,0
ta 204,14,14336
xaa 180,252,4
ta 206,14,20480
s_add_u32 m0, s27, 0
xaa 184,252,8
s_mov_b32 s30, 3932160
xaa 188,252,12
wl 6
s_barrier
xaa 192,192,0
ta 208,11,24576
xaa 196,192,4
ta 210,11,30720
xaa 200,192,8
dm 1,8,30,0
xaa 204,192,12
wl 6
xaa 208,196,0
ta 212,12,24576
xaa 212,196,4
ta 214,12,30720
xaa 216,196,8
dm 2,8,30,1024
xaa 220,196,12
wl 6
xaa 224,200,0
ta 216,13,24576
xaa 228,200,4
ta 218,13,30720
xaa 232,200,8
dm 3,8,30,2048
xaa 236,200,12
wl 6
xaa 240,204,0
ta 220,14,24576
xaa 244,204,4
ta 222,14,30720
s_mov_b32 s31, 9216
xaa 248,204,8
xaa 252,204,12
wl 6
wv 11
xaa 64,208,16
ta 224,11,25600
xaa 68,208,20
ta 226,11,31744
xaa 72,208,24
buffer_load_dwordx4 a[0:3], v23, s[20:23], s31 offen
xaa 76,208,28
wl 6
xaa 80,212,16
ta 228,12,25600
xaa 84,212,20
ta 230,12,31744
xaa 88,212,24
buffer_load_dwordx4 a[4:7], v24, s[20:23], s31 offen
xaa 92,212,28
wl 6
xaa 96,216,16
ta 232,13,25600
xaa 100,216,20
ta 234,13,31744
xaa 104,216,24
buffer_load_dwordx4 a[8:11], v25, s[20:23], s31 offen
xaa 108,216,28
wl 6
xaa 112,220,16
ta 236,14,25600
xaa 116,220,20
ta 238,14,31744
xaa 120,220,24
buffer_load_dwordx4 a[12:15], v26, s[20:23], s31 offen
xaa 124,220,28
wl 6
xaa 128,224,16
ta 240,11,26624
xaa 132,224,20
ta 242,11,32768
xaa 136,224,24
xaa 140,224,28
wl 6
xaa 144,228,16
ta 244,12,26624
xaa 148,228,20
ta 246,12,32768
xaa 152,228,24
xaa 156,228,28
wl 6
xaa 160,232,16
ta 248,13,26624
xaa 164,232,20
ta 250,13,32768
xaa 168,232,24
xaa 172,232,28
wl 6
xaa 176,236,16
ta 252,14,26624
xaa 180,236,20
ta 254,14,32768
s_add_u32 m0, s27, 12288
xaa 184,236,24
s_mov_b32 s30, 4325376
xaa 188,236,28
wl 6
s_barrier
xaa 192,240,16
ta 192,11,36864
xaa 196,240,20
ta 194,11,43008
xaa 200,240,24
dm 1,8,30,0
xaa 204,240,28
wl 6
xaa 208,244,16
ta 196,12,36864
xaa 212,244,20
ta 198,12,43008
xaa 216,244,24
dm 2,8,30,1024
xaa 220,244,28
wl 6
xaa 224,248,16
ta 200,13,36864
xaa 228,248,20
ta 202,13,43008
xaa 232,248,24
dm 3,8,30,2048
xaa 236,248,28
wl 6
xaa 240,252,16
ta 204,14,36864
xaa 244,252,20
ta 206,14,43008
s_mov_b32 s31, 10240
xaa 248,252,24
xaa 252,252,28
wl 6
wv 11
xaa 64,192,32
ta 208,11,37888
xaa 68,192,36
ta 210,11,44032
xaa 72,192,40
buffer_load_dwordx4 a[16:19], v23, s[20:23], s31 offen
xaa 76,192,44
wl 6
xaa 80,196,32
ta 212,12,37888
xaa 84,196,36
ta 214,12,44032
xaa 88,196,40
buffer_load_dwordx4 a[20:23], v24, s[20:23], s31 offen
xaa 92,196,44
wl 6
xaa 96,200,32
ta 216,13,37888
xaa 100,200,36
ta 218,13,44032
xaa 104,200,40
buffer_load_dwordx4 a[24:27], v25, s[20:23], s31 offen
xaa 108,200,44
wl 6
xaa 112,204,32
ta 220,14,37888
xaa 116,204,36
ta 222,14,44032
xaa 120,204,40
buffer_load_dwordx4 a[28:31], v26, s[20:23], s31 offen
xaa 124,204,44
wl 6
xaa 128,208,32
ta 224,11,38912
xaa 132,208,36
ta 226,11,45056
xaa 136,208,40
xaa 140,208,44
wl 6
xaa 144,212,32
ta 228,12,38912
s_add_u32 s99, s96, 0
xaa 148,212,36
ta 230,12,45056
xaa 152,212,40
buffer_load_dword a191, v27, s[16:19], s99 offen
xaa 156,212,44
wl 6
xaa 160,216,32
ta 232,13,38912
xaa 164,216,36
ta 234,13,45056
xaa 168,216,40
xaa 172,216,44
wl 6
xaa 176,220,32
ta 236,14,38912
xaa 180,220,36
ta 238,14,45056
s_add_u32 m0, s27, 24576
xaa 184,220,40
s_mov_b32 s30, 4718592
xaa 188,220,44
wl 6
s_barrier
xaa 192,224,32
ta 240,11,49152
xaa 196,224,36
ta 242,11,55296
xaa 200,224,40
dm 1,8,30,0
xaa 204,224,44
wl 6
xaa 208,228,32
ta 244,12,49152
xaa 212,228,36
ta 246,12,55296
xaa 216,228,40
dm 2,8,30,1024
xaa 220,228,44
wl 6
xaa 224,232,32
ta 248,13,49152
xaa 228,232,36
ta 250,13,55296
xaa 232,232,40
dm 3,8,30,2048
xaa 236,232,44
wl 6
xaa 240,236,32
ta 252,14,49152
xaa 244,236,36
ta 254,14,55296
s_mov_b32 s31, 11264
xaa 248,236,40
xaa 252,236,44
wl 6
wv 11
xaa 64,240,0
ta 192,11,50176
xaa 68,240,4
ta 194,11,56320
xaa 72,240,8
buffer_load_dwordx4 a[32:35], v23, s[20:23], s31 offen
xaa 76,240,12
wl 6
xaa 80,244,0
ta 196,12,50176
xaa 84,244,4
ta 198,12,56320
xaa 88,244,8
buffer_load_dwordx4 a[36:39], v24, s[20:23], s31 offen
xaa 92,244,12
wl 6
xaa 96,248,0
ta 200,13,50176
xaa 100,248,4
ta 202,13,56320
xaa 104,248,8
buffer_load_dwordx4 a[40:43], v25, s[20:23], s31 offen
xaa 108,248,12
wl 6
xaa 112,252,0
ta 204,14,50176
xaa 116,252,4
ta 206,14,56320
xaa 120,252,8
buffer_load_dwordx4 a[44:47], v26, s[20:23], s31 offen
xaa 124,252,12
wl 6
xaa 128,192,0
ta 208,11,51200
xaa 132,192,4
ta 210,11,57344
xaa 136,192,8
xaa 140,192,12
wl 6
xaa 144,196,0
ta 212,12,51200
xaa 148,196,4
ta 214,12,57344
xaa 152,196,8
xaa 156,196,12
wl 6
xaa 160,200,0
ta 216,13,51200
xaa 164,200,4
ta 218,13,57344
xaa 168,200,8
xaa 172,200,12
wl 6
xaa 176,204,0
ta 220,14,51200
xaa 180,204,4
ta 222,14,57344
s_add_u32 m0, s27, 36864
xaa 184,204,8
s_mov_b32 s30, 5111808
xaa 188,204,12
wl 6
s_barrier
xaa 192,208,0
ta 224,11,0
xaa 196,208,4
ta 226,11,6144
xaa 200,208,8
dm 1,8,30,0
xaa 204,208,12
wl 6
xaa 208,212,0
ta 228,12,0
xaa 212,212,4
ta 230,12,6144
xaa 216,212,8
dm 2,8,30,1024
xaa 220,212,12
wl 6
xaa 224,216,0
ta 232,13,0
xaa 228,216,4
ta 234,13,6144
xaa 232,216,8
dm 3,8,30,2048
xaa 236,216,12
wl 6
xaa 240,220,0
ta 236,14,0
xaa 244,220,4
ta 238,14,6144
s_mov_b32 s31, 12288
xaa 248,220,8
xaa 252,220,12
wl 6
wv 11
xaa 64,224,16
ta 240,11,1024
xaa 68,224,20
ta 242,11,7168
xaa 72,224,24
buffer_load_dwordx4 a[0:3], v23, s[20:23], s31 offen
xaa 76,224,28
wl 6
xaa 80,228,16
ta 244,12,1024
xaa 84,228,20
ta 246,12,7168
xaa 88,228,24
buffer_load_dwordx4 a[4:7], v24, s[20:23], s31 offen
xaa 92,228,28
wl 6
xaa 96,232,16
ta 248,13,1024
xaa 100,232,20
ta 250,13,7168
xaa 104,232,24
buffer_load_dwordx4 a[8:11], v25, s[20:23], s31 offen
xaa 108,232,28
wl 6
xaa 112,236,16
ta 252,14,1024
xaa 116,236,20
ta 254,14,7168
xaa 120,236,24
buffer_load_dwordx4 a[12:15], v26, s[20:23], s31 offen
xaa 124,236,28
wl 6
xaa 128,240,16
ta 192,11,2048
xaa 132,240,20
ta 194,11,8192
xaa 136,240,24
xaa 140,240,28
wl 6
xaa 144,244,16
ta 196,12,2048
s_add_u32 s99, s96, 2048
xaa 148,244,20
ta 198,12,8192
xaa 152,244,24
buffer_load_dword a191, v27, s[16:19], s99 offen
xaa 156,244,28
wl 6
xaa 160,248,16
ta 200,13,2048
xaa 164,248,20
ta 202,13,8192
xaa 168,248,24
xaa 172,248,28
wl 6
xaa 176,252,16
ta 204,14,2048
xaa 180,252,20
ta 206,14,8192
s_add_u32 m0, s27, 49152
xaa 184,252,24
s_mov_b32 s30, 5505024
xaa 188,252,28
wl 6
s_barrier
xaa 192,192,16
ta 208,11,12288
xaa 196,192,20
ta 210,11,18432
xaa 200,192,24
dm 1,8,30,0
xaa 204,192,28
wl 6
xaa 208,196,16
ta 212,12,12288
xaa 212,196,20
ta 214,12,18432
xaa 216,196,24
dm 2,8,30,1024
xaa 220,196,28
wl 6
xaa 224,200,16
ta 216,13,12288
xaa 228,200,20
ta 218,13,18432
xaa 232,200,24
dm 3,8,30,2048
xaa 236,200,28
wl 6
xaa 240,204,16
ta 220,14,12288
xaa 244,204,20
ta 222,14,18432
s_mov_b32 s31, 13312
xaa 248,204,24
xaa 252,204,28
wl 6
wv 11
xaa 64,208,32
ta 224,11,13312
xaa 68,208,36
ta 226,11,19456
xaa 72,208,40
buffer_load_dwordx4 a[16:19], v23, s[20:23], s31 offen
xaa 76,208,44
wl 6
xaa 80,212,32
ta 228,12,13312
xaa 84,212,36
ta 230,12,19456
xaa 88,212,40
buffer_load_dwordx4 a[20:23], v24, s[20:23], s31 offen
xaa 92,212,44
wl 6
xaa 96,216,32
ta 232,13,13312
xaa 100,216,36
ta 234,13,19456
xaa 104,216,40
buffer_load_dwordx4 a[24:27], v25, s[20:23], s31 offen
xaa 108,216,44
wl 6
xaa 112,220,32
ta 236,14,13312
xaa 116,220,36
ta 238,14,19456
xaa 120,220,40
buffer_load_dwordx4 a[28:31], v26, s[20:23], s31 offen
xaa 124,220,44
wl 6
xaa 128,224,32
ta 240,11,14336
xaa 132,224,36
ta 242,11,20480
xaa 136,224,40
xaa 140,224,44
wl 6
xaa 144,228,32
ta 244,12,14336
xaa 148,228,36
ta 246,12,20480
xaa 152,228,40
xaa 156,228,44
wl 6
xaa 160,232,32
ta 248,13,14336
xaa 164,232,36
ta 250,13,20480
xaa 168,232,40
xaa 172,232,44
wl 6
xaa 176,236,32
ta 252,14,14336
xaa 180,236,36
ta 254,14,20480
s_add_u32 m0, s27, 0
xaa 184,236,40
s_mov_b32 s30, 5898240
xaa 188,236,44
wl 6
s_barrier
xaa 192,240,32
ta 192,11,24576
xaa 196,240,36
ta 194,11,30720
xaa 200,240,40
dm 1,8,30,0
xaa 204,240,44
wl 6
xaa 208,244,32
ta 196,12,24576
xaa 212,244,36
ta 198,12,30720
xaa 216,244,40
dm 2,8,30,1024
xaa 220,244,44
wl 6
xaa 224,248,32
ta 200,13,24576
xaa 228,248,36
ta 202,13,30720
xaa 232,248,40
dm 3,8,30,2048
xaa 236,248,44
wl 6
xaa 240,252,32
ta 204,14,24576
xaa 244,252,36
ta 206,14,30720
s_mov_b32 s31, 14336
xaa 248,252,40
xaa 252,252,44
wl 6
wv 11
xaa 64,192,0
ta 208,11,25600
xaa 68,192,4
ta 210,11,31744
xaa 72,192,8
buffer_load_dwordx4 a[32:35], v23, s[20:23], s31 offen
xaa 76,192,12
wl 6
xaa 80,196,0
ta 212,12,25600
xaa 84,196,4
ta 214,12,31744
xaa 88,196,8
buffer_load_dwordx4 a[36:39], v24, s[20:23], s31 offen
xaa 92,196,12
wl 6
xaa 96,200,0
ta 216,13,25600
xaa 100,200,4
ta 218,13,31744
xaa 104,200,8
buffer_load_dwordx4 a[40:43], v25, s[20:23], s31 offen
xaa 108,200,12
wl 6
xaa 112,204,0
ta 220,14,25600
xaa 116,204,4
ta 222,14,31744
xaa 120,204,8
buffer_load_dwordx4 a[44:47], v26, s[20:23], s31 offen
xaa 124,204,12
wl 6
xaa 128,208,0
ta 224,11,26624
xaa 132,208,4
ta 226,11,32768
xaa 136,208,8
xaa 140,208,12
wl 6
xaa 144,212,0
ta 228,12,26624
s_add_u32 s99, s96, 4096
xaa 148,212,4
ta 230,12,32768
xaa 152,212,8
buffer_load_dword a191, v27, s[16:19], s99 offen
xaa 156,212,12
wl 6
xaa 160,216,0
ta 232,13,26624
xaa 164,216,4
ta 234,13,32768
xaa 168,216,8
xaa 172,216,12
wl 6
xaa 176,220,0
ta 236,14,26624
xaa 180,220,4
ta 238,14,32768
s_add_u32 m0, s27, 12288
xaa 184,220,8
s_mov_b32 s30, 6291456
xaa 188,220,12
wl 6
s_barrier
xaa 192,224,0
ta 240,11,36864
xaa 196,224,4
ta 242,11,43008
xaa 200,224,8
dm 1,8,30,0
xaa 204,224,12
wl 6
xaa 208,228,0
ta 244,12,36864
xaa 212,228,4
ta 246,12,43008
xaa 216,228,8
dm 2,8,30,1024
xaa 220,228,12
wl 6
xaa 224,232,0
ta 248,13,36864
xaa 228,232,4
ta 250,13,43008
xaa 232,232,8
dm 3,8,30,2048
xaa 236,232,12
wl 6
xaa 240,236,0
ta 252,14,36864
xaa 244,236,4
ta 254,14,43008
s_mov_b32 s31, 15360
xaa 248,236,8
xaa 252,236,12
wl 6
wv 11
xaa 64,240,16
ta 192,11,37888
xaa 68,240,20
ta 194,11,44032
xaa 72,240,24
buffer_load_dwordx4 a[0:3], v23, s[20:23], s31 offen
xaa 76,240,28
wl 6
xaa 80,244,16
ta 196,12,37888
xaa 84,244,20
ta 198,12,44032
xaa 88,244,24
buffer_load_dwordx4 a[4:7], v24, s[20:23], s31 offen
xaa 92,244,28
wl 6
xaa 96,248,16
ta 200,13,37888
xaa 100,248,20
ta 202,13,44032
xaa 104,248,24
buffer_load_dwordx4 a[8:11], v25, s[20:23], s31 offen
xaa 108,248,28
wl 6
xaa 112,252,16
ta 204,14,37888
xaa 116,252,20
ta 206,14,44032
xaa 120,252,24
buffer_load_dwordx4 a[12:15], v26, s[20:23], s31 offen
xaa 124,252,28
wl 6
xaa 128,192,16
ta 208,11,38912
xaa 132,192,20
ta 210,11,45056
xaa 136,192,24
xaa 140,192,28
wl 6
xaa 144,196,16
ta 212,12,38912
xaa 148,196,20
ta 214,12,45056
xaa 152,196,24
xaa 156,196,28
wl 6
xaa 160,200,16
ta 216,13,38912
xaa 164,200,20
ta 218,13,45056
xaa 168,200,24
xaa 172,200,28
wl 6
xaa 176,204,16
ta 220,14,38912
xaa 180,204,20
ta 222,14,45056
s_add_u32 m0, s27, 24576
xaa 184,204,24
s_mov_b32 s30, 6684672
xaa 188,204,28
wl 6
s_barrier
xaa 192,208,16
ta 224,11,49152
xaa 196,208,20
ta 226,11,55296
xaa 200,208,24
dm 1,8,30,0
xaa 204,208,28
wl 6
xaa 208,212,16
ta 228,12,49152
xaa 212,212,20
ta 230,12,55296
xaa 216,212,24
dm 2,8,30,1024
xaa 220,212,28
wl 6
xaa 224,216,16
ta 232,13,49152
xaa 228,216,20
ta 234,13,55296
xaa 232,216,24
dm 3,8,30,2048
xaa 236,216,28
wl 6
xaa 240,220,16
ta 236,14,49152
xaa 244,220,20
ta 238,14,55296
s_mov_b32 s31, 16384
xaa 248,220,24
xaa 252,220,28
wl 6
wv 11
xaa 64,224,32
ta 240,11,50176
xaa 68,224,36
ta 242,11,56320
xaa 72,224,40
buffer_load_dwordx4 a[16:19], v23, s[20:23], s31 offen
xaa 76,224,44
wl 6
xaa 80,228,32
ta 244,12,50176
xaa 84,228,36
ta 246,12,56320
xaa 88,228,40
buffer_load_dwordx4 a[20:23], v24, s[20:23], s31 offen
xaa 92,228,44
wl 6
xaa 96,232,32
ta 248,13,50176
xaa 100,232,36
ta 250,13,56320
xaa 104,232,40
buffer_load_dwordx4 a[24:27], v25, s[20:23], s31 offen
xaa 108,232,44
wl 6
xaa 112,236,32
ta 252,14,50176
xaa 116,236,36
ta 254,14,56320
xaa 120,236,40
buffer_load_dwordx4 a[28:31], v26, s[20:23], s31 offen
xaa 124,236,44
wl 6
xaa 128,240,32
ta 192,11,51200
xaa 132,240,36
ta 194,11,57344
xaa 136,240,40
xaa 140,240,44
wl 6
xaa 144,244,32
ta 196,12,51200
s_add_u32 s99, s98, 0
xaa 148,244,36
ta 198,12,57344
xaa 152,244,40
buffer_load_dword a191, v27, s[56:59], s99 offen
xaa 156,244,44
wl 6
xaa 160,248,32
ta 200,13,51200
xaa 164,248,36
ta 202,13,57344
xaa 168,248,40
xaa 172,248,44
wl 6
xaa 176,252,32
ta 204,14,51200
xaa 180,252,36
ta 206,14,57344
s_add_u32 m0, s27, 36864
xaa 184,252,40
s_mov_b32 s30, 7077888
xaa 188,252,44
wl 6
s_barrier
xaa 192,192,32
ta 208,11,0
xaa 196,192,36
ta 210,11,6144
xaa 200,192,40
dm 1,8,30,0
xaa 204,192,44
wl 6
xaa 208,196,32
ta 212,12,0
xaa 212,196,36
ta 214,12,6144
xaa 216,196,40
dm 2,8,30,1024
xaa 220,196,44
wl 6
xaa 224,200,32
ta 216,13,0
xaa 228,200,36
ta 218,13,6144
xaa 232,200,40
dm 3,8,30,2048
xaa 236,200,44
wl 6
xaa 240,204,32
ta 220,14,0
xaa 244,204,36
ta 222,14,6144
s_mov_b32 s31, 17408
xaa 248,204,40
xaa 252,204,44
wl 6
wv 11
xaa 64,208,0
ta 224,11,1024
xaa 68,208,4
ta 226,11,7168
xaa 72,208,8
buffer_load_dwordx4 a[32:35], v23, s[20:23], s31 offen
xaa 76,208,12
wl 6
xaa 80,212,0
ta 228,12,1024
xaa 84,212,4
ta 230,12,7168
xaa 88,212,8
buffer_load_dwordx4 a[36:39], v24, s[20:23], s31 offen
xaa 92,212,12
wl 6
xaa 96,216,0
ta 232,13,1024
xaa 100,216,4
ta 234,13,7168
xaa 104,216,8
buffer_load_dwordx4 a[40:43], v25, s[20:23], s31 offen
xaa 108,216,12
wl 6
xaa 112,220,0
ta 236,14,1024
xaa 116,220,4
ta 238,14,7168
xaa 120,220,8
buffer_load_dwordx4 a[44:47], v26, s[20:23], s31 offen
xaa 124,220,12
wl 6
xaa 128,224,0
ta 240,11,2048
xaa 132,224,4
ta 242,11,8192
xaa 136,224,8
xaa 140,224,12
wl 6
xaa 144,228,0
ta 244,12,2048
xaa 148,228,4
ta 246,12,8192
xaa 152,228,8
xaa 156,228,12
wl 6
xaa 160,232,0
ta 248,13,2048
xaa 164,232,4
ta 250,13,8192
xaa 168,232,8
xaa 172,232,12
wl 6
xaa 176,236,0
ta 252,14,2048
xaa 180,236,4
ta 254,14,8192
s_add_u32 m0, s27, 49152
xaa 184,236,8
s_mov_b32 s30, 7471104
xaa 188,236,12
wl 6
s_barrier
xaa 192,240,0
ta 192,11,12288
xaa 196,240,4
ta 194,11,18432
xaa 200,240,8
dm 1,8,30,0
xaa 204,240,12
wl 6
xaa 208,244,0
ta 196,12,12288
xaa 212,244,4
ta 198,12,18432
xaa 216,244,8
dm 2,8,30,1024
xaa 220,244,12
wl 6
xaa 224,248,0
ta 200,13,12288
xaa 228,248,4
ta 202,13,18432
xaa 232,248,8
dm 3,8,30,2048
xaa 236,248,12
wl 6
xaa 240,252,0
ta 204,14,12288
xaa 244,252,4
ta 206,14,18432
s_mov_b32 s31, 18432
xaa 248,252,8
xaa 252,252,12
wl 6
wv 11
xaa 64,192,16
ta 208,11,13312
xaa 68,192,20
ta 210,11,19456
xaa 72,192,24
buffer_load_dwordx4 a[0:3], v23, s[20:23], s31 offen
xaa 76,192,28
wl 6
xaa 80,196,16
ta 212,12,13312
xaa 84,196,20
ta 214,12,19456
xaa 88,196,24
buffer_load_dwordx4 a[4:7], v24, s[20:23], s31 offen
xaa 92,196,28
wl 6
xaa 96,200,16
ta 216,13,13312
xaa 100,200,20
ta 218,13,19456
xaa 104,200,24
buffer_load_dwordx4 a[8:11], v25, s[20:23], s31 offen
xaa 108,200,28
wl 6
xaa 112,204,16
ta 220,14,13312
xaa 116,204,20
ta 222,14,19456
s_add_u32 m0, s28, 24576
xaa 120,204,24
buffer_load_dwordx4 a[12:15], v26, s[20:23], s31 offen
s_mov_b32 s30, 0
xaa 124,204,28
wl 6
xaa 128,208,16
ta 224,11,14336
xaa 132,208,20
ta 226,11,20480
xaa 136,208,24
dm 4,12,30,0
xaa 140,208,28
wl 6
xaa 144,212,16
ta 228,12,14336
s_add_u32 s99, s98, 0
xaa 148,212,20
ta 230,12,20480
xaa 152,212,24
dm 5,12,30,1024
xaa 156,212,28
wl 6
buffer_load_dword a191, v27, s[60:63], s99 offen
xaa 160,216,16
ta 232,13,14336
xaa 164,216,20
ta 234,13,20480
xaa 168,216,24
dm 6,12,30,2048
xaa 172,216,28
wl 6
xaa 176,220,16
ta 236,14,14336
xaa 180,220,20
ta 238,14,20480
xaa 184,220,24
xaa 188,220,28
wl 6
s_barrier
xaa 192,224,16
ta 240,11,24576
xaa 196,224,20
ta 242,11,30720
xaa 200,224,24
xaa 204,224,28
wl 6
xaa 208,228,16
ta 244,12,24576
xaa 212,228,20
ta 246,12,30720
xaa 216,228,24
xaa 220,228,28
wl 6
xaa 224,232,16
ta 248,13,24576
xaa 228,232,20
ta 250,13,30720
xaa 232,232,24
xaa 236,232,28
wl 6
xaa 240,236,16
ta 252,14,24576
xaa 244,236,20
ta 254,14,30720
s_mov_b32 s31, 19456
xaa 248,236,24
xaa 252,236,28
wl 6
wv 11
xaa 64,240,32
ta 192,11,25600
xaa 68,240,36
ta 194,11,31744
xaa 72,240,40
buffer_load_dwordx4 a[16:19], v23, s[20:23], s31 offen
xaa 76,240,44
wl 6
xaa 80,244,32
ta 196,12,25600
xaa 84,244,36
ta 198,12,31744
xaa 88,244,40
buffer_load_dwordx4 a[20:23], v24, s[20:23], s31 offen
xaa 92,244,44
wl 6
xaa 96,248,32
ta 200,13,25600
xaa 100,248,36
ta 202,13,31744
xaa 104,248,40
buffer_load_dwordx4 a[24:27], v25, s[20:23], s31 offen
xaa 108,248,44
wl 6
xaa 112,252,32
ta 204,14,25600
xaa 116,252,36
ta 206,14,31744
s_add_u32 m0, s28, 36864
xaa 120,252,40
buffer_load_dwordx4 a[28:31], v26, s[20:23], s31 offen
s_mov_b32 s30, 12288
xaa 124,252,44
wl 6
xaa 128,192,32
ta 208,11,26624
xaa 132,192,36
ta 210,11,32768
xaa 136,192,40
dm 4,12,30,0
xaa 140,192,44
wl 6
xaa 144,196,32
ta 212,12,26624
xaa 148,196,36
ta 214,12,32768
xaa 152,196,40
dm 5,12,30,1024
xaa 156,196,44
wl 6
xaa 160,200,32
ta 216,13,26624
xaa 164,200,36
ta 218,13,32768
xaa 168,200,40
dm 6,12,30,2048
xaa 172,200,44
wl 6
xaa 176,204,32
ta 220,14,26624
xaa 180,204,36
ta 222,14,32768
xaa 184,204,40
xaa 188,204,44
wl 6
s_barrier
xaa 192,208,32
ta 224,11,36864
xaa 196,208,36
ta 226,11,43008
xaa 200,208,40
xaa 204,208,44
wl 6
xaa 208,212,32
ta 228,12,36864
xaa 212,212,36
ta 230,12,43008
xaa 216,212,40
xaa 220,212,44
wl 6
xaa 224,216,32
ta 232,13,36864
xaa 228,216,36
ta 234,13,43008
xaa 232,216,40
xaa 236,216,44
wl 6
xaa 240,220,32
ta 236,14,36864
xaa 244,220,36
ta 238,14,43008
xaa 248,220,40
xaa 252,220,44
wl 6
wv 11
xaa 64,224,0
ta 240,11,37888
xaa 68,224,4
ta 242,11,44032
xaa 72,224,8
xaa 76,224,12
wl 6
xaa 80,228,0
ta 244,12,37888
xaa 84,228,4
ta 246,12,44032
s_add_u32 m0, s28, 49152
xaa 88,228,8
s_mov_b32 s30, 24576
xaa 92,228,12
wl 6
xaa 96,232,0
ta 248,13,37888
xaa 100,232,4
ta 250,13,44032
xaa 104,232,8
dm 4,12,30,0
xaa 108,232,12
wl 6
xaa 112,236,0
ta 252,14,37888
xaa 116,236,4
ta 254,14,44032
xaa 120,236,8
dm 5,12,30,1024
xaa 124,236,12
wl 6
xaa 128,240,0
ta 192,11,38912
xaa 132,240,4
ta 194,11,45056
xaa 136,240,8
dm 6,12,30,2048
xaa 140,240,12
wl 6
xaa 144,244,0
ta 196,12,38912
xaa 148,244,4
ta 198,12,45056
xaa 152,244,8
xaa 156,244,12
wl 6
xaa 160,248,0
ta 200,13,38912
xaa 164,248,4
ta 202,13,45056
xaa 168,248,8
xaa 172,248,12
wl 6
xaa 176,252,0
ta 204,14,38912
xaa 180,252,4
ta 206,14,45056
xaa 184,252,8
xaa 188,252,12
wl 6
s_barrier
xaa 192,192,0
ta 208,11,49152
xaa 196,192,4
ta 210,11,55296
xaa 200,192,8
xaa 204,192,12
wl 6
xaa 208,196,0
ta 212,12,49152
xaa 212,196,4
ta 214,12,55296
xaa 216,196,8
xaa 220,196,12
wl 6
xaa 224,200,0
ta 216,13,49152
xaa 228,200,4
ta 218,13,55296
xaa 232,200,8
xaa 236,200,12
wl 6
xaa 240,204,0
ta 220,14,49152
xaa 244,204,4
ta 222,14,55296
xaa 248,204,8
xaa 252,204,12
wl 6
wv 6
xaa 64,208,16
ta 224,11,50176
xaa 68,208,20
ta 226,11,56320
xaa 72,208,24
xaa 76,208,28
wl 6
xaa 80,212,16
ta 228,12,50176
xaa 84,212,20
ta 230,12,56320
cv 64,64,65
xaa 88,212,24
cv 65,66,67
cv 66,68,69
xaa 92,212,28
wl 6
cv 67,70,71
cv 68,72,73
xaa 96,216,16
ta 232,13,50176
cv 69,74,75
xaa 100,216,20
ta 234,13,56320
cv 70,76,77
xaa 104,216,24
cv 71,78,79
xaa 108,216,28
wl 6
sw 64,66
xaa 112,220,16
ta 236,14,50176
xaa 116,220,20
ta 238,14,56320
xaa 120,220,24
sw 65,67
xaa 124,220,28
wl 6
sw 68,70
xaa 128,224,16
ta 240,11,51200
xaa 132,224,20
ta 242,11,57344
xaa 136,224,24
sw 69,71
xaa 140,224,28
wl 6
cv 72,80,81
cv 73,82,83
xaa 144,228,16
ta 244,12,51200
cv 74,84,85
xaa 148,228,20
ta 246,12,57344
cv 75,86,87
xaa 152,228,24
cv 76,88,89
cv 77,90,91
xaa 156,228,28
wl 6
cv 78,92,93
cv 79,94,95
xaa 160,232,16
ta 248,13,51200
xaa 164,232,20
ta 250,13,57344
xaa 168,232,24
sw 72,74
xaa 172,232,28
wl 6
sw 73,75
xaa 176,236,16
ta 252,14,51200
xaa 180,236,20
ta 254,14,57344
s_add_u32 m0, s28, 0
xaa 184,236,24
s_mov_b32 s30, 36864
sw 76,78
xaa 188,236,28
wl 6
s_barrier
xaa 192,240,16
ra 192,15,24576
xaa 196,240,20
dm 4,12,30,0
xaa 200,240,24
sw 77,79
xaa 204,240,28
wl 5
cv 80,96,97
cv 81,98,99
xaa 208,244,16
ra 196,16,24576
cv 82,100,101
xaa 212,244,20
dm 5,12,30,1024
cv 83,102,103
xaa 216,244,24
cv 84,104,105
cv 85,106,107
xaa 220,244,28
wl 4
cv 86,108,109
cv 87,110,111
xaa 224,248,16
ra 200,17,24576
xaa 228,248,20
dm 6,12,30,2048
xaa 232,248,24
sw 80,82
xaa 236,248,28
wl 3
sw 81,83
xaa 240,252,16
ra 204,18,24576
xaa 244,252,20
sw 84,86
xaa 248,252,24
sw 85,87
xaa 252,252,28
wl 3
cv 88,112,113
cv 89,114,115
v_mfma_f32_32x32x16_bf16 v[28:43], a[192:195], v[64:67], 0
ra 208,15,25600
cv 90,116,117
cv 91,118,119
cv 92,120,121
cv 93,122,123
cv 94,124,125
v_mfma_f32_32x32x16_bf16 v[44:59], a[192:195], v[68:71], 0
wl 3
cv 95,126,127
sw 88,90
sw 89,91
yav 28,196,72
ra 212,16,25600
sw 92,94
sw 93,95
cv 96,128,129
yav 44,196,76
wl 3
cv 97,130,131
cv 98,132,133
cv 99,134,135
cv 100,136,137
cv 101,138,139
cv 102,140,141
yav 28,200,80
ra 216,17,25600
cv 103,142,143
sw 96,98
sw 97,99
yav 44,200,84
wl 3
sw 100,102
sw 101,103
cv 104,144,145
cv 105,146,147
yav 28,204,88
ra 220,18,25600
cv 106,148,149
cv 107,150,151
cv 108,152,153
cv 109,154,155
cv 110,156,157
yav 44,204,92
wl 3
cv 111,158,159
sw 104,106
sw 105,107
yav 28,208,96
ra 224,15,26624
sw 108,110
sw 109,111
cv 112,160,161
yav 44,208,100
wl 3
cv 113,162,163
cv 114,164,165
cv 115,166,167
cv 116,168,169
cv 117,170,171
cv 118,172,173
yav 28,212,104
ra 228,16,26624
cv 119,174,175
sw 112,114
sw 113,115
sw 116,118
sw 117,119
yav 44,212,108
wl 3
cv 120,176,177
cv 121,178,179
cv 122,180,181
cv 123,182,183
cv 124,184,185
cv 125,186,187
yav 28,216,112
ra 232,17,26624
cv 126,188,189
cv 127,190,191
sw 120,122
sw 121,123
sw 124,126
sw 125,127
yav 44,216,116
wl 3
s_add_u32 m0, s28, 12288
s_mov_b32 s30, 49152
cv 128,192,193
cv 129,194,195
cv 130,196,197
cv 131,198,199
yav 28,220,120
ra 236,18,26624
cv 132,200,201
cv 133,202,203
cv 134,204,205
cv 135,206,207
sw 128,130
sw 129,131
sw 132,134
sw 133,135
yav 44,220,124
wl 3
wv 6
s_barrier
cv 136,208,209
cv 137,210,211
cv 138,212,213
cv 139,214,215
yav 28,224,128
ra 240,15,36864
dm 4,12,30,0
cv 140,216,217
cv 141,218,219
cv 142,220,221
cv 143,222,223
sw 136,138
sw 137,139
sw 140,142
sw 141,143
yav 44,224,132
wl 3
cv 144,224,225
cv 145,226,227
cv 146,228,229
cv 147,230,231
cv 148,232,233
cv 149,234,235
yav 28,228,136
ra 244,16,36864
cv 150,236,237
cv 151,238,239
sw 144,146
sw 145,147
sw 148,150
sw 149,151
yav 44,228,140
wl 3
cv 152,240,241
cv 153,242,243
cv 154,244,245
cv 155,246,247
cv 156,248,249
cv 157,250,251
yav 28,232,144
ra 248,17,36864
dm 5,12,30,1024
s_add_u32 s99, s98, 0
cv 158,252,253
cv 159,254,255
sw 152,154
sw 153,155
sw 156,158
sw 157,159
v_mov_b32 v60, 0x3f803f80
v_mov_b32 v61, 0x3f803f80
v_mov_b32 v62, 0x3f803f80
v_mov_b32 v63, 0x3f803f80
s_mul_i32 s32, s38, 176128
s_mul_i32 s33, s24, 6144
s_add_u32 s32, s32, s33
s_add_u32 s32, s32, 3932160
v_add_u32 v23, s32, v23
v_add_u32 v24, s32, v24
v_add_u32 v24, 176128, v24
v_add_u32 v25, s32, v25
v_add_u32 v25, 352256, v25
v_add_u32 v26, s32, v26
v_add_u32 v26, 528384, v26
yav 44,232,148
wl 3
buffer_load_dword v1, v27, s[64:67], s99 offen
yav 28,236,152
ra 252,18,36864
yav 44,236,156
wl 3
v_mfma_f32_32x32x16_bf16 v[192:207], a[240:243], v[64:67], 0
ra 192,15,37888
dm 6,12,30,2048
v_mfma_f32_32x32x16_bf16 v[208:223], a[240:243], v[68:71], 0
wl 3
s_nop 3
ex 28
ex 29
ex 30
yav 192,244,72
ra 196,16,37888
ex 31
ex 32
yav 208,244,76
wl 3
ex 33
cv 28,28,29
cv 30,30,31
ex 34
yav 192,248,80
ra 200,17,37888
ex 35
cv 32,32,33
ex 36
yav 208,248,84
wl 3
ex 37
cv 34,34,35
ex 38
yav 192,252,88
ra 204,18,37888
ex 39
cv 36,36,37
sw 28,32
yav 208,252,92
wl 3
ex 40
ex 41
sw 30,34
yav 192,192,96
ra 208,15,38912
cv 38,38,39
ex 42
ex 43
yav 208,192,100
wl 3
aw 0,28
aw 4,32
cv 40,40,41
cv 42,42,43
aw 1,30
aw 5,34
yav 192,196,104
ra 212,16,38912
sw 36,40
sw 38,42
aw 2,36
yav 208,196,108
wl 3
aw 6,40
aw 3,38
aw 7,42
ex 44
yav 192,200,112
ra 216,17,38912
ex 45
ex 46
yav 208,200,116
wl 3
s_add_u32 m0, s28, 24576
s_mov_b32 s30, 61440
ex 47
ex 48
yav 192,204,120
ra 220,18,38912
ex 49
cv 44,44,45
cv 46,46,47
yav 208,204,124
wl 3
wv 7
s_barrier
ex 50
ex 51
yav 192,208,128
ra 224,15,49152
dm 4,12,30,0
cv 48,48,49
ex 52
yav 208,208,132
wl 3
ex 53
cv 50,50,51
ex 54
yav 192,212,136
ra 228,16,49152
ex 55
cv 52,52,53
sw 44,48
yav 208,212,140
wl 3
ex 56
ex 57
sw 46,50
yav 192,216,144
ra 232,17,49152
dm 5,12,30,1024
s_add_u32 s99, s97, 0
cv 54,54,55
ex 58
yav 208,216,148
wl 3
buffer_load_dword v1, v27, s[52:55], s99 offen
ex 59
aw 8,44
aw 12,48
cv 56,56,57
yav 192,220,152
ra 236,18,49152
cv 58,58,59
aw 9,46
aw 13,50
sw 52,56
yav 208,220,156
wl 3
sw 54,58
aw 10,52
aw 14,56
aw 11,54
aw 15,58
v_mfma_f32_32x32x16_bf16 v[160:175], a[224:227], v[64:67], 0
ra 240,15,50176
dm 6,12,30,2048
v_mfma_f32_32x32x16_bf16 v[176:191], a[224:227], v[68:71], 0
wl 3
ex 192
ex 193
ex 194
yav 160,228,72
ra 244,16,50176
ex 195
ex 196
yav 176,228,76
wl 3
ex 197
cv 192,192,193
cv 194,194,195
ex 198
yav 160,232,80
ra 248,17,50176
ex 199
cv 196,196,197
ex 200
yav 176,232,84
wl 3
ex 201
cv 198,198,199
ex 202
yav 160,236,88
ra 252,18,50176
ex 203
cv 200,200,201
sw 192,196
yav 176,236,92
wl 3
ex 204
ex 205
sw 194,198
yav 160,240,96
ra 192,15,51200
cv 202,202,203
ex 206
ex 207
yav 176,240,100
wl 3
aw 16,192
aw 20,196
cv 204,204,205
cv 206,206,207
aw 17,194
aw 21,198
yav 160,244,104
ra 196,16,51200
sw 200,204
sw 202,206
aw 18,200
yav 176,244,108
wl 3
aw 22,204
aw 19,202
aw 23,206
ex 208
yav 160,248,112
ra 200,17,51200
ex 209
ex 210
yav 176,248,116
wl 3
s_add_u32 m0, s28, 36864
s_mov_b32 s30, 73728
ex 211
ex 212
yav 160,252,120
ra 204,18,51200
ex 213
cv 208,208,209
cv 210,210,211
yav 176,252,124
wl 3
wv 8
s_barrier
ex 214
ex 215
yav 160,192,128
ra 208,15,0
dm 4,12,30,0
cv 212,212,213
ex 216
yav 176,192,132
wl 3
ex 217
cv 214,214,215
ex 218
yav 160,196,136
ra 212,16,0
ex 219
cv 216,216,217
sw 208,212
yav 176,196,140
wl 3
ex 220
ex 221
sw 210,214
yav 160,200,144
ra 216,17,0
dm 5,12,30,1024
s_add_u32 s99, s97, 2048
cv 218,218,219
ex 222
yav 176,200,148
wl 3
buffer_load_dword v1, v27, s[52:55], s99 offen
ex 223
aw 24,208
aw 28,212
cv 220,220,221
yav 160,204,152
ra 220,18,0
cv 222,222,223
aw 25,210
aw 29,214
sw 216,220
yav 176,204,156
wl 3
sw 218,222
aw 26,216
aw 30,220
aw 27,218
aw 31,222
v_mfma_f32_32x32x16_bf16 v[192:207], a[208:211], v[64:67], 0
ra 224,15,1024
dm 6,12,30,2048
v_mfma_f32_32x32x16_bf16 v[208:223], a[208:211], v[68:71], 0
wl 3
ex 160
ex 161
ex 162
yav 192,212,72
ra 228,16,1024
ex 163
ex 164
yav 208,212,76
wl 3
ex 165
cv 160,160,161
cv 162,162,163
ex 166
yav 192,216,80
ra 232,17,1024
ex 167
cv 164,164,165
ex 168
yav 208,216,84
wl 3
ex 169
cv 166,166,167
ex 170
yav 192,220,88
ra 236,18,1024
ex 171
cv 168,168,169
sw 160,164
yav 208,220,92
wl 3
ex 172
ex 173
sw 162,166
yav 192,224,96
ra 240,15,2048
cv 170,170,171
ex 174
ex 175
yav 208,224,100
wl 3
aw 32,160
aw 36,164
cv 172,172,173
cv 174,174,175
aw 33,162
aw 37,166
yav 192,228,104
ra 244,16,2048
sw 168,172
sw 170,174
aw 34,168
yav 208,228,108
wl 3
aw 38,172
aw 35,170
aw 39,174
ex 176
yav 192,232,112
ra 248,17,2048
ex 177
ex 178
yav 208,232,116
wl 3
s_add_u32 m0, s28, 49152
s_mov_b32 s30, 86016
ex 179
ex 180
yav 192,236,120
ra 252,18,2048
ex 181
cv 176,176,177
cv 178,178,179
yav 208,236,124
wl 3
wv 8
s_barrier
ex 182
ex 183
yav 192,240,128
ra 192,15,12288
dm 4,12,30,0
cv 180,180,181
ex 184
yav 208,240,132
wl 3
ex 185
cv 182,182,183
ex 186
yav 192,244,136
ra 196,16,12288
ex 187
cv 184,184,185
sw 176,180
yav 208,244,140
wl 3
ex 188
ex 189
sw 178,182
yav 192,248,144
ra 200,17,12288
dm 5,12,30,1024
s_add_u32 s99, s97, 4096
cv 186,186,187
ex 190
yav 208,248,148
wl 3
buffer_load_dword v1, v27, s[52:55], s99 offen
ex 191
aw 40,176
aw 44,180
cv 188,188,189
yav 192,252,152
ra 204,18,12288
cv 190,190,191
aw 41,178
aw 45,182
sw 184,188
yav 208,252,156
wl 3
sw 186,190
aw 42,184
aw 46,188
aw 43,186
aw 47,190
v_mfma_f32_32x32x16_bf16 v[160:175], a[192:195], v[64:67], 0
ra 208,15,13312
dm 6,12,30,2048
v_mfma_f32_32x32x16_bf16 v[176:191], a[192:195], v[68:71], 0
wl 3
ex 192
ex 193
ex 194
yav 160,196,72
ra 212,16,13312
ex 195
ex 196
yav 176,196,76
wl 3
ex 197
cv 192,192,193
cv 194,194,195
ex 198
yav 160,200,80
ra 216,17,13312
ex 199
cv 196,196,197
ex 200
yav 176,200,84
wl 3
ex 201
cv 198,198,199
ex 202
yav 160,204,88
ra 220,18,13312
ex 203
cv 200,200,201
sw 192,196
yav 176,204,92
wl 3
ex 204
ex 205
sw 194,198
yav 160,208,96
ra 224,15,14336
cv 202,202,203
ex 206
ex 207
yav 176,208,100
wl 3
aw 48,192
aw 52,196
cv 204,204,205
cv 206,206,207
aw 49,194
aw 53,198
yav 160,212,104
ra 228,16,14336
sw 200,204
sw 202,206
aw 50,200
yav 176,212,108
wl 3
aw 54,204
aw 51,202
aw 55,206
ex 208
yav 160,216,112
ra 232,17,14336
ex 209
ex 210
yav 176,216,116
wl 3
s_add_u32 m0, s28, 0
s_mov_b32 s30, 98304
ex 211
ex 212
yav 160,220,120
ra 236,18,14336
ex 213
cv 208,208,209
cv 210,210,211
yav 176,220,124
wl 3
wv 8
s_barrier
ex 214
ex 215
yav 160,224,128
ra 240,15,24576
dm 4,12,30,0
cv 212,212,213
ex 216
yav 176,224,132
wl 3
ex 217
cv 214,214,215
ex 218
yav 160,228,136
ra 244,16,24576
ex 219
cv 216,216,217
sw 208,212
yav 176,228,140
wl 3
ex 220
ex 221
sw 210,214
yav 160,232,144
ra 248,17,24576
dm 5,12,30,1024
s_add_u32 s99, s97, 6144
cv 218,218,219
ex 222
yav 176,232,148
wl 3
buffer_load_dword v1, v27, s[52:55], s99 offen
ex 223
aw 56,208
aw 60,212
cv 220,220,221
yav 160,236,152
ra 252,18,24576
cv 222,222,223
aw 57,210
aw 61,214
sw 216,220
yav 176,236,156
wl 3
sw 218,222
aw 58,216
aw 62,220
aw 59,218
aw 63,222
v_mfma_f32_32x32x16_bf16 v[192:207], a[240:243], v[64:67], 0
ra 192,15,25600
dm 6,12,30,2048
v_mfma_f32_32x32x16_bf16 v[208:223], a[240:243], v[68:71], 0
wl 3
ex 160
ex 161
ex 162
yav 192,244,72
ra 196,16,25600
ex 163
ex 164
yav 208,244,76
wl 3
ex 165
cv 160,160,161
cv 162,162,163
ex 166
yav 192,248,80
ra 200,17,25600
ex 167
cv 164,164,165
ex 168
yav 208,248,84
wl 3
ex 169
cv 166,166,167
ex 170
yav 192,252,88
ra 204,18,25600
ex 171
cv 168,168,169
sw 160,164
yav 208,252,92
wl 3
ex 172
ex 173
sw 162,166
yav 192,192,96
ra 208,15,26624
cv 170,170,171
ex 174
ex 175
yav 208,192,100
wl 3
aw 64,160
aw 68,164
cv 172,172,173
cv 174,174,175
aw 65,162
aw 69,166
yav 192,196,104
ra 212,16,26624
sw 168,172
sw 170,174
aw 66,168
yav 208,196,108
wl 3
aw 70,172
aw 67,170
aw 71,174
ex 176
yav 192,200,112
ra 216,17,26624
ex 177
ex 178
yav 208,200,116
wl 3
s_add_u32 m0, s28, 12288
s_mov_b32 s30, 110592
ex 179
ex 180
yav 192,204,120
ra 220,18,26624
ex 181
cv 176,176,177
cv 178,178,179
yav 208,204,124
wl 3
wv 8
s_barrier
ex 182
ex 183
yav 192,208,128
ra 224,15,36864
dm 4,12,30,0
cv 180,180,181
ex 184
yav 208,208,132
wl 3
ex 185
cv 182,182,183
ex 186
yav 192,212,136
ra 228,16,36864
ex 187
cv 184,184,185
sw 176,180
yav 208,212,140
wl 3
ex 188
ex 189
sw 178,182
yav 192,216,144
ra 232,17,36864
dm 5,12,30,1024
s_add_u32 s99, s97, 8192
cv 186,186,187
ex 190
yav 208,216,148
wl 3
buffer_load_dword v1, v27, s[52:55], s99 offen
ex 191
aw 72,176
aw 76,180
cv 188,188,189
yav 192,220,152
ra 236,18,36864
cv 190,190,191
aw 73,178
aw 77,182
sw 184,188
yav 208,220,156
wl 3
sw 186,190
aw 74,184
aw 78,188
aw 75,186
aw 79,190
v_mfma_f32_32x32x16_bf16 v[160:175], a[224:227], v[64:67], 0
ra 240,15,37888
dm 6,12,30,2048
v_mfma_f32_32x32x16_bf16 v[176:191], a[224:227], v[68:71], 0
wl 3
ex 192
ex 193
ex 194
yav 160,228,72
ra 244,16,37888
ex 195
ex 196
yav 176,228,76
wl 3
ex 197
cv 192,192,193
cv 194,194,195
ex 198
yav 160,232,80
ra 248,17,37888
ex 199
cv 196,196,197
ex 200
yav 176,232,84
wl 3
ex 201
cv 198,198,199
ex 202
yav 160,236,88
ra 252,18,37888
ex 203
cv 200,200,201
sw 192,196
yav 176,236,92
wl 3
ex 204
ex 205
sw 194,198
yav 160,240,96
ra 192,15,38912
cv 202,202,203
ex 206
ex 207
yav 176,240,100
wl 3
aw 80,192
aw 84,196
cv 204,204,205
cv 206,206,207
aw 81,194
aw 85,198
yav 160,244,104
ra 196,16,38912
sw 200,204
sw 202,206
aw 82,200
yav 176,244,108
wl 3
aw 86,204
aw 83,202
aw 87,206
ex 208
yav 160,248,112
ra 200,17,38912
ex 209
ex 210
yav 176,248,116
wl 3
s_add_u32 m0, s28, 24576
s_mov_b32 s30, 122880
ex 211
ex 212
yav 160,252,120
ra 204,18,38912
ex 213
cv 208,208,209
cv 210,210,211
yav 176,252,124
wl 3
wv 8
s_barrier
ex 214
ex 215
yav 160,192,128
ra 208,15,49152
dm 4,12,30,0
cv 212,212,213
ex 216
yav 176,192,132
wl 3
ex 217
cv 214,214,215
ex 218
yav 160,196,136
ra 212,16,49152
ex 219
cv 216,216,217
sw 208,212
yav 176,196,140
wl 3
ex 220
ex 221
sw 210,214
yav 160,200,144
ra 216,17,49152
dm 5,12,30,1024
s_add_u32 s99, s97, 10240
cv 218,218,219
ex 222
yav 176,200,148
wl 3
buffer_load_dword v1, v27, s[52:55], s99 offen
ex 223
aw 88,208
aw 92,212
cv 220,220,221
yav 160,204,152
ra 220,18,49152
cv 222,222,223
aw 89,210
aw 93,214
sw 216,220
yav 176,204,156
wl 3
sw 218,222
aw 90,216
aw 94,220
aw 91,218
aw 95,222
v_mfma_f32_32x32x16_bf16 v[192:207], a[208:211], v[64:67], 0
ra 224,15,50176
dm 6,12,30,2048
v_mfma_f32_32x32x16_bf16 v[208:223], a[208:211], v[68:71], 0
wl 3
ex 160
ex 161
ex 162
yav 192,212,72
ra 228,16,50176
ex 163
ex 164
yav 208,212,76
wl 3
ex 165
cv 160,160,161
cv 162,162,163
ex 166
yav 192,216,80
ra 232,17,50176
ex 167
cv 164,164,165
ex 168
yav 208,216,84
wl 3
ex 169
cv 166,166,167
ex 170
yav 192,220,88
ra 236,18,50176
ex 171
cv 168,168,169
sw 160,164
yav 208,220,92
wl 3
ex 172
ex 173
sw 162,166
yav 192,224,96
ra 240,15,51200
cv 170,170,171
ex 174
ex 175
yav 208,224,100
wl 3
aw 96,160
aw 100,164
cv 172,172,173
cv 174,174,175
aw 97,162
aw 101,166
yav 192,228,104
ra 244,16,51200
sw 168,172
sw 170,174
aw 98,168
yav 208,228,108
wl 3
aw 102,172
aw 99,170
aw 103,174
ex 176
yav 192,232,112
ra 248,17,51200
ex 177
ex 178
yav 208,232,116
wl 3
s_add_u32 m0, s28, 36864
s_mov_b32 s30, 135168
ex 179
ex 180
yav 192,236,120
ra 252,18,51200
ex 181
cv 176,176,177
cv 178,178,179
yav 208,236,124
wl 3
wv 8
s_barrier
ex 182
ex 183
yav 192,240,128
ra 192,15,0
dm 4,12,30,0
cv 180,180,181
ex 184
yav 208,240,132
wl 3
ex 185
cv 182,182,183
ex 186
yav 192,244,136
ra 196,16,0
ex 187
cv 184,184,185
sw 176,180
yav 208,244,140
wl 3
ex 188
ex 189
sw 178,182
yav 192,248,144
ra 200,17,0
dm 5,12,30,1024
s_add_u32 s99, s97, 12288
cv 186,186,187
ex 190
yav 208,248,148
wl 3
buffer_load_dword v1, v27, s[52:55], s99 offen
ex 191
aw 104,176
aw 108,180
cv 188,188,189
yav 192,252,152
ra 204,18,0
cv 190,190,191
aw 105,178
aw 109,182
sw 184,188
yav 208,252,156
wl 3
sw 186,190
aw 106,184
aw 110,188
aw 107,186
aw 111,190
v_mfma_f32_32x32x16_bf16 v[160:175], a[192:195], v[64:67], 0
ra 208,15,1024
dm 6,12,30,2048
v_mfma_f32_32x32x16_bf16 v[176:191], a[192:195], v[68:71], 0
wl 3
ex 192
ex 193
ex 194
yav 160,196,72
ra 212,16,1024
ex 195
ex 196
yav 176,196,76
wl 3
ex 197
cv 192,192,193
cv 194,194,195
ex 198
yav 160,200,80
ra 216,17,1024
ex 199
cv 196,196,197
ex 200
yav 176,200,84
wl 3
ex 201
cv 198,198,199
ex 202
yav 160,204,88
ra 220,18,1024
ex 203
cv 200,200,201
sw 192,196
yav 176,204,92
wl 3
ex 204
ex 205
sw 194,198
yav 160,208,96
ra 224,15,2048
cv 202,202,203
ex 206
ex 207
yav 176,208,100
wl 3
aw 112,192
aw 116,196
cv 204,204,205
cv 206,206,207
aw 113,194
aw 117,198
yav 160,212,104
ra 228,16,2048
sw 200,204
sw 202,206
aw 114,200
yav 176,212,108
wl 3
aw 118,204
aw 115,202
aw 119,206
ex 208
yav 160,216,112
ra 232,17,2048
ex 209
ex 210
yav 176,216,116
wl 3
s_add_u32 m0, s28, 49152
s_mov_b32 s30, 147456
ex 211
ex 212
yav 160,220,120
ra 236,18,2048
ex 213
cv 208,208,209
cv 210,210,211
yav 176,220,124
wl 3
wv 8
s_barrier
ex 214
ex 215
yav 160,224,128
ra 240,15,12288
dm 4,12,30,0
cv 212,212,213
ex 216
yav 176,224,132
wl 3
ex 217
cv 214,214,215
ex 218
yav 160,228,136
ra 244,16,12288
ex 219
cv 216,216,217
sw 208,212
yav 176,228,140
wl 3
ex 220
ex 221
sw 210,214
yav 160,232,144
ra 248,17,12288
dm 5,12,30,1024
s_add_u32 s99, s97, 14336
cv 218,218,219
ex 222
yav 176,232,148
wl 3
buffer_load_dword v1, v27, s[52:55], s99 offen
ex 223
aw 120,208
aw 124,212
cv 220,220,221
yav 160,236,152
ra 252,18,12288
cv 222,222,223
aw 121,210
aw 125,214
sw 216,220
yav 176,236,156
wl 3
sw 218,222
aw 122,216
aw 126,220
aw 123,218
aw 127,222
v_mfma_f32_32x32x16_bf16 v[192:207], a[240:243], v[64:67], 0
ra 192,15,13312
dm 6,12,30,2048
v_mfma_f32_32x32x16_bf16 v[208:223], a[240:243], v[68:71], 0
wl 3
ex 160
ex 161
ex 162
yav 192,244,72
ra 196,16,13312
ex 163
ex 164
yav 208,244,76
wl 3
ex 165
cv 160,160,161
cv 162,162,163
ex 166
yav 192,248,80
ra 200,17,13312
ex 167
cv 164,164,165
ex 168
yav 208,248,84
wl 3
ex 169
cv 166,166,167
ex 170
yav 192,252,88
ra 204,18,13312
ex 171
cv 168,168,169
sw 160,164
yav 208,252,92
wl 3
ex 172
ex 173
sw 162,166
yav 192,192,96
ra 208,15,14336
cv 170,170,171
ex 174
ex 175
yav 208,192,100
wl 3
aw 128,160
aw 132,164
cv 172,172,173
cv 174,174,175
aw 129,162
aw 133,166
yav 192,196,104
ra 212,16,14336
sw 168,172
sw 170,174
aw 130,168
yav 208,196,108
wl 3
aw 134,172
aw 131,170
aw 135,174
ex 176
yav 192,200,112
ra 216,17,14336
ex 177
ex 178
yav 208,200,116
wl 3
s_add_u32 m0, s28, 0
s_mov_b32 s30, 159744
ex 179
ex 180
yav 192,204,120
ra 220,18,14336
ex 181
cv 176,176,177
cv 178,178,179
yav 208,204,124
wl 3
wv 8
s_barrier
ex 182
ex 183
yav 192,208,128
ra 224,15,24576
dm 4,12,30,0
cv 180,180,181
ex 184
yav 208,208,132
wl 3
ex 185
cv 182,182,183
ex 186
yav 192,212,136
ra 228,16,24576
ex 187
cv 184,184,185
sw 176,180
yav 208,212,140
wl 3
ex 188
ex 189
sw 178,182
yav 192,216,144
ra 232,17,24576
dm 5,12,30,1024
cv 186,186,187
ex 190
yav 208,216,148
wl 3
ex 191
aw 136,176
aw 140,180
cv 188,188,189
cv 190,190,191
yav 192,220,152
ra 236,18,24576
aw 137,178
aw 141,182
sw 184,188
yav 208,220,156
wl 3
sw 186,190
aw 138,184
aw 142,188
aw 139,186
aw 143,190
v_mfma_f32_32x32x16_bf16 v[160:175], a[224:227], v[64:67], 0
ra 240,15,25600
dm 6,12,30,2048
v_mfma_f32_32x32x16_bf16 v[176:191], a[224:227], v[68:71], 0
wl 3
ex 192
ex 193
ex 194
yav 160,228,72
ra 244,16,25600
ex 195
ex 196
yav 176,228,76
wl 3
ex 197
cv 192,192,193
cv 194,194,195
ex 198
yav 160,232,80
ra 248,17,25600
ex 199
cv 196,196,197
ex 200
yav 176,232,84
wl 3
ex 201
cv 198,198,199
ex 202
yav 160,236,88
ra 252,18,25600
ex 203
cv 200,200,201
sw 192,196
yav 176,236,92
wl 3
ex 204
ex 205
sw 194,198
yav 160,240,96
ra 192,15,26624
cv 202,202,203
ex 206
ex 207
yav 176,240,100
wl 3
aw 144,192
aw 148,196
cv 204,204,205
cv 206,206,207
aw 145,194
aw 149,198
yav 160,244,104
ra 196,16,26624
sw 200,204
sw 202,206
aw 146,200
yav 176,244,108
wl 3
aw 150,204
aw 147,202
aw 151,206
ex 208
yav 160,248,112
ra 200,17,26624
ex 209
ex 210
yav 176,248,116
wl 3
s_add_u32 m0, s28, 12288
s_mov_b32 s30, 172032
ex 211
ex 212
yav 160,252,120
ra 204,18,26624
ex 213
cv 208,208,209
cv 210,210,211
yav 176,252,124
wl 3
wv 7
s_barrier
ex 214
ex 215
yav 160,192,128
ra 208,15,36864
dm 4,12,30,0
cv 212,212,213
ex 216
yav 176,192,132
wl 3
ex 217
cv 214,214,215
ex 218
yav 160,196,136
ra 212,16,36864
ex 219
cv 216,216,217
sw 208,212
yav 176,196,140
wl 3
ex 220
ex 221
sw 210,214
yav 160,200,144
ra 216,17,36864
dm 5,12,30,1024
cv 218,218,219
ex 222
yav 176,200,148
wl 3
ex 223
aw 152,208
aw 156,212
cv 220,220,221
cv 222,222,223
yav 160,204,152
ra 220,18,36864
aw 153,210
aw 157,214
sw 216,220
yav 176,204,156
wl 3
sw 218,222
aw 154,216
aw 158,220
aw 155,218
aw 159,222
v_mfma_f32_32x32x16_bf16 v[192:207], a[208:211], v[64:67], 0
ra 224,15,37888
dm 6,12,30,2048
v_mfma_f32_32x32x16_bf16 v[208:223], a[208:211], v[68:71], 0
wl 3
ex 160
ex 161
ex 162
yav 192,212,72
ra 228,16,37888
ex 163
ex 164
yav 208,212,76
wl 3
ex 165
cv 160,160,161
cv 162,162,163
ex 166
yav 192,216,80
ra 232,17,37888
ex 167
cv 164,164,165
ex 168
yav 208,216,84
wl 3
ex 169
cv 166,166,167
ex 170
yav 192,220,88
ra 236,18,37888
ex 171
cv 168,168,169
sw 160,164
yav 208,220,92
wl 3
ex 172
ex 173
sw 162,166
yav 192,224,96
ra 240,15,38912
cv 170,170,171
ex 174
ex 175
yav 208,224,100
wl 3
aw 160,160
aw 164,164
cv 172,172,173
cv 174,174,175
aw 161,162
aw 165,166
yav 192,228,104
ra 244,16,38912
sw 168,172
sw 170,174
aw 162,168
yav 208,228,108
wl 3
aw 166,172
aw 163,170
aw 167,174
ex 176
yav 192,232,112
ra 248,17,38912
ex 177
ex 178
yav 208,232,116
wl 3
s_add_u32 m0, s28, 24576
s_mov_b32 s30, 184320
ex 179
ex 180
yav 192,236,120
ra 252,18,38912
ex 181
cv 176,176,177
cv 178,178,179
yav 208,236,124
wl 3
wv 6
s_barrier
ex 182
ex 183
yav 192,240,128
ra 192,15,49152
dm 4,12,30,0
cv 180,180,181
ex 184
yav 208,240,132
wl 3
ex 185
cv 182,182,183
ex 186
yav 192,244,136
ra 196,16,49152
ex 187
cv 184,184,185
sw 176,180
yav 208,244,140
wl 3
ex 188
ex 189
sw 178,182
yav 192,248,144
ra 200,17,49152
dm 5,12,30,1024
cv 186,186,187
ex 190
yav 208,248,148
wl 3
ex 191
aw 168,176
aw 172,180
cv 188,188,189
cv 190,190,191
yav 192,252,152
ra 204,18,49152
aw 169,178
aw 173,182
sw 184,188
yav 208,252,156
wl 3
sw 186,190
aw 170,184
aw 174,188
aw 171,186
aw 175,190
v_mfma_f32_32x32x16_bf16 v[160:175], a[192:195], v[64:67], 0
ra 208,15,50176
dm 6,12,30,2048
v_mfma_f32_32x32x16_bf16 v[176:191], a[192:195], v[68:71], 0
wl 3
s_add_u32 m0, s29, 0
s_mov_b32 s30, 0
ex 192
ex 193
yav 160,196,72
ra 212,16,50176
ex 194
ex 195
yav 176,196,76
wl 3
ex 196
ex 197
cv 192,192,193
cv 194,194,195
yav 160,200,80
ra 216,17,50176
dm 7,16,30,0
ex 198
ex 199
yav 176,200,84
wl 3
cv 196,196,197
ex 200
ex 201
cv 198,198,199
yav 160,204,88
ra 220,18,50176
ex 202
ex 203
cv 200,200,201
yav 176,204,92
wl 3
sw 192,196
ex 204
ex 205
yav 160,208,96
ra 224,15,51200
dm 8,16,30,1024
sw 194,198
cv 202,202,203
yav 176,208,100
wl 3
ex 206
ex 207
aw 176,192
aw 180,196
yav 160,212,104
ra 228,16,51200
cv 204,204,205
cv 206,206,207
aw 177,194
aw 181,198
yav 176,212,108
wl 3
sw 200,204
sw 202,206
aw 178,200
aw 182,204
yav 160,216,112
ra 232,17,51200
dm 9,16,30,2048
aw 179,202
aw 183,206
ex 208
yav 176,216,116
wl 3
ex 209
ex 210
ex 211
yav 160,220,120
ra 236,18,51200
ex 212
ex 213
cv 208,208,209
yav 176,220,124
wl 3
wv 9
s_barrier
cv 210,210,211
ex 214
yav 160,224,128
ra 240,15,0
dm 10,16,30,3072
ex 215
cv 212,212,213
yav 176,224,132
wl 3
ex 216
ex 217
cv 214,214,215
yav 160,228,136
ra 244,16,0
ex 218
ex 219
cv 216,216,217
yav 176,228,140
wl 3
sw 208,212
ex 220
ex 221
yav 160,232,144
ra 248,17,0
sw 210,214
cv 218,218,219
ex 222
yav 176,232,148
wl 3
ex 223
aw 184,208
aw 188,212
cv 220,220,221
cv 222,222,223
yav 160,236,152
ra 252,18,0
s_add_u32 m0, s29, 16384
s_mov_b32 s30, 49152
aw 185,210
aw 189,214
yav 176,236,156
wl 3
sw 216,220
sw 218,222
aw 186,216
aw 190,220
aw 187,218
aw 191,222
v_mfma_f32_32x32x16_bf16 v[192:207], a[240:243], v[64:67], 0
ra 192,15,1024
v_mfma_f32_32x32x16_bf16 v[208:223], a[240:243], v[68:71], 0
wl 3
dm 7,16,30,0
ex 160
ex 161
yav 192,244,72
ra 196,16,1024
ex 162
ex 163
yav 208,244,76
wl 3
ex 164
ex 165
cv 28,160,161
cv 29,162,163
yav 192,248,80
ra 200,17,1024
ex 166
ex 167
cv 32,164,165
yav 208,248,84
wl 3
dm 8,16,30,1024
ex 168
ex 169
cv 33,166,167
yav 192,252,88
ra 204,18,1024
ex 170
ex 171
cv 30,168,169
yav 208,252,92
wl 3
sw 28,32
ex 172
ex 173
yav 192,192,96
ra 208,15,2048
sw 29,33
cv 31,170,171
ex 174
yav 208,192,100
wl 3
dm 9,16,30,2048
ex 175
cv 34,172,173
cv 35,174,175
yav 192,196,104
ra 212,16,2048
sw 30,34
sw 31,35
yav 208,196,108
wl 3
ex 176
ex 177
ex 178
yav 192,200,112
ra 216,17,2048
ex 179
ex 180
yav 208,200,116
wl 3
dm 10,16,30,3072
ex 181
cv 36,176,177
cv 37,178,179
yav 192,204,120
ra 220,18,2048
ex 182
ex 183
cv 40,180,181
yav 208,204,124
wl 3
wv 11
s_barrier
ex 184
ex 185
yav 192,208,128
ra 224,15,12288
cv 41,182,183
ex 186
ex 187
yav 208,208,132
wl 3
cv 38,184,185
sw 36,40
ex 188
yav 192,212,136
ra 228,16,12288
ex 189
sw 37,41
cv 39,186,187
yav 208,212,140
wl 3
ex 190
ex 191
cv 42,188,189
cv 43,190,191
yav 192,216,144
ra 232,17,12288
sw 38,42
sw 39,43
yav 208,216,148
wl 3
yav 192,220,152
ra 236,18,12288
s_add_u32 m0, s29, 32768
s_mov_b32 s30, 98304
yav 208,220,156
wl 3
v_mfma_f32_32x32x16_bf16 v[160:175], a[224:227], v[64:67], 0
ra 240,15,13312
v_mfma_f32_32x32x16_bf16 v[176:191], a[224:227], v[68:71], 0
wl 3
dm 7,16,30,0
s_nop 1
ex 192
ex 193
yav 160,228,72
ra 244,16,13312
ex 194
ex 195
yav 176,228,76
wl 3
ex 196
ex 197
cv 44,192,193
cv 45,194,195
yav 160,232,80
ra 248,17,13312
ex 198
ex 199
cv 48,196,197
yav 176,232,84
wl 3
dm 8,16,30,1024
ex 200
ex 201
cv 49,198,199
yav 160,236,88
ra 252,18,13312
ex 202
ex 203
cv 46,200,201
yav 176,236,92
wl 3
sw 44,48
ex 204
ex 205
yav 160,240,96
ra 192,15,14336
sw 45,49
cv 47,202,203
ex 206
yav 176,240,100
wl 3
dm 9,16,30,2048
ex 207
cv 50,204,205
cv 51,206,207
yav 160,244,104
ra 196,16,14336
sw 46,50
sw 47,51
yav 176,244,108
wl 3
ex 208
ex 209
ex 210
yav 160,248,112
ra 200,17,14336
ex 211
ex 212
yav 176,248,116
wl 3
dm 10,16,30,3072
ex 213
cv 52,208,209
cv 53,210,211
yav 160,252,120
ra 204,18,14336
ex 214
ex 215
cv 56,212,213
yav 176,252,124
wl 3
wv 12
s_barrier
ex 216
ex 217
yav 160,192,128
ra 208,15,24576
cv 57,214,215
ex 218
ex 219
yav 176,192,132
wl 3
cv 54,216,217
sw 52,56
ex 220
yav 160,196,136
ra 212,16,24576
ex 221
sw 53,57
cv 55,218,219
yav 176,196,140
wl 3
ex 222
ex 223
cv 58,220,221
cv 59,222,223
yav 160,200,144
ra 216,17,24576
sw 54,58
sw 55,59
yav 176,200,148
wl 3
yav 160,204,152
ra 220,18,24576
yav 176,204,156
wl 3
v_mfma_f32_32x32x16_bf16 v[192:207], a[208:211], v[64:67], 0
ra 224,15,25600
v_mfma_f32_32x32x16_bf16 v[208:223], a[208:211], v[68:71], 0
wl 3
s_nop 4
ex 160
ex 161
ex 162
yav 192,212,72
ra 228,16,25600
ex 163
ex 164
yav 208,212,76
wl 3
ex 165
cv 224,160,161
cv 225,162,163
ex 166
yav 192,216,80
ra 232,17,25600
ex 167
cv 228,164,165
ex 168
yav 208,216,84
wl 3
ex 169
cv 229,166,167
ex 170
yav 192,220,88
ra 236,18,25600
ex 171
cv 226,168,169
sw 224,228
yav 208,220,92
wl 3
ex 172
ex 173
sw 225,229
yav 192,224,96
ra 240,15,26624
cv 227,170,171
ex 174
ex 175
yav 208,224,100
wl 3
cv 230,172,173
cv 231,174,175
s_nop 0
sw 226,230
sw 227,231
yav 192,228,104
ra 244,16,26624
ex 176
ex 177
yav 208,228,108
wl 3
ex 178
ex 179
ex 180
yav 192,232,112
ra 248,17,26624
ex 181
cv 232,176,177
cv 233,178,179
yav 208,232,116
wl 3
ex 182
ex 183
cv 236,180,181
yav 192,236,120
ra 252,18,26624
ex 184
ex 185
cv 237,182,183
yav 208,236,124
wl 3
wv 8
s_barrier
ex 186
ex 187
yav 192,240,128
ta 192,19,0
cv 234,184,185
sw 232,236
ex 188
yav 208,240,132
wl 3
ta 194,19,2048
ex 189
sw 233,237
cv 235,186,187
yav 192,244,136
ta 196,20,0
ex 190
ex 191
cv 238,188,189
yav 208,244,140
wl 4
ta 198,20,2048
cv 239,190,191
sw 234,238
s_nop 0
sw 235,239
yav 192,248,144
ta 200,21,0
yav 208,248,148
wl 5
ta 202,21,2048
yav 192,252,152
ta 204,22,0
yav 208,252,156
wl 5
ta 206,22,2048
v_mfma_f32_16x16x32_bf16 v[64:67], a[192:195], a[0:3], 0
ta 208,19,4096
v_mfma_f32_16x16x32_bf16 v[68:71], a[192:195], a[4:7], 0
ta 210,19,6144
v_mfma_f32_16x16x32_bf16 v[72:75], a[192:195], a[8:11], 0
s_nop 2
ex 192
v_mfma_f32_16x16x32_bf16 v[76:79], a[192:195], a[12:15], 0
wl 6
ex 193
v_mfma_f32_16x16x32_bf16 v[80:83], a[196:199], a[0:3], 0
ta 212,20,4096
v_mfma_f32_16x16x32_bf16 v[84:87], a[196:199], a[4:7], 0
ta 214,20,6144
v_mfma_f32_16x16x32_bf16 v[88:91], a[196:199], a[8:11], 0
ex 194
v_mfma_f32_16x16x32_bf16 v[92:95], a[196:199], a[12:15], 0
wl 6
ex 195
v_mfma_f32_16x16x32_bf16 v[96:99], a[200:203], a[0:3], 0
ta 216,21,4096
v_mfma_f32_16x16x32_bf16 v[100:103], a[200:203], a[4:7], 0
ta 218,21,6144
v_mfma_f32_16x16x32_bf16 v[104:107], a[200:203], a[8:11], 0
ex 196
v_mfma_f32_16x16x32_bf16 v[108:111], a[200:203], a[12:15], 0
wl 6
ex 197
v_mfma_f32_16x16x32_bf16 v[112:115], a[204:207], a[0:3], 0
ta 220,22,4096
cv 240,192,193
v_mfma_f32_16x16x32_bf16 v[116:119], a[204:207], a[4:7], 0
ta 222,22,6144
cv 241,194,195
v_mfma_f32_16x16x32_bf16 v[120:123], a[204:207], a[8:11], 0
ex 198
v_mfma_f32_16x16x32_bf16 v[124:127], a[204:207], a[12:15], 0
ex 199
v_mfma_f32_16x16x32_bf16 v[128:131], v[60:63], a[0:3], 0
cv 244,196,197
v_mfma_f32_16x16x32_bf16 v[132:135], v[60:63], a[4:7], 0
ex 200
v_mfma_f32_16x16x32_bf16 v[136:139], v[60:63], a[8:11], 0
ex 201
v_mfma_f32_16x16x32_bf16 v[140:143], v[60:63], a[12:15], 0
wl 6
cv 245,198,199
xaa 64,208,16
ta 224,19,8192
xaa 68,208,20
ta 226,19,10240
xaa 72,208,24
ex 202
xaa 76,208,28
wl 6
ex 203
xaa 80,212,16
ta 228,20,8192
cv 242,200,201
xaa 84,212,20
ta 230,20,10240
xaa 88,212,24
sw 240,244
xaa 92,212,28
wl 6
ex 204
xaa 96,216,16
ta 232,21,8192
xaa 100,216,20
ta 234,21,10240
xaa 104,216,24
ex 205
xaa 108,216,28
wl 6
sw 241,245
xaa 112,220,16
ta 236,22,8192
cv 243,202,203
xaa 116,220,20
ta 238,22,10240
xaa 120,220,24
ex 206
xaa 124,220,28
ex 207
xva 128,60,16
cv 246,204,205
cv 247,206,207
xva 132,60,20
sw 242,246
xva 136,60,24
sw 243,247
xva 140,60,28
wl 6
ex 208
xaa 64,224,32
ta 240,19,12288
ex 209
ex 210
ex 211
ex 212
ex 213
cv 248,208,209
cv 249,210,211
ex 214
ex 215
cv 252,212,213
ex 216
ex 217
cv 253,214,215
ex 218
ex 219
cv 250,216,217
sw 248,252
ex 220
ex 221
sw 249,253
cv 251,218,219
ex 222
ex 223
cv 254,220,221
cv 255,222,223
s_nop 0
sw 250,254
sw 251,255
xaa 68,224,36
ta 242,19,14336
xaa 72,224,40
xaa 76,224,44
wl 6
xaa 80,228,32
ta 244,20,12288
xaa 84,228,36
ta 246,20,14336
xaa 88,228,40
xaa 92,228,44
wl 6
xaa 96,232,32
ta 248,21,12288
xaa 100,232,36
ta 250,21,14336
xaa 104,232,40
xaa 108,232,44
wl 6
xaa 112,236,32
ta 252,22,12288
xaa 116,236,36
ta 254,22,14336
xaa 120,236,40
xaa 124,236,44
xva 128,60,32
xva 132,60,36
s_add_u32 m0, s29, 49152
s_mov_b32 s30, 147456
xva 136,60,40
xva 140,60,44
wl 6
wv 4
s_barrier
xaa 64,240,48
ta 192,19,16384
xaa 68,240,52
ta 194,19,18432
xaa 72,240,56
dm 7,16,30,0
xaa 76,240,60
wl 6
xaa 80,244,48
ta 196,20,16384
xaa 84,244,52
ta 198,20,18432
xaa 88,244,56
dm 8,16,30,1024
xaa 92,244,60
wl 6
xaa 96,248,48
ta 200,21,16384
xaa 100,248,52
ta 202,21,18432
xaa 104,248,56
dm 9,16,30,2048
xaa 108,248,60
wl 6
xaa 112,252,48
ta 204,22,16384
xaa 116,252,52
ta 206,22,18432
xaa 120,252,56
dm 10,16,30,3072
xaa 124,252,60
xva 128,60,48
xva 132,60,52
xva 136,60,56
xva 140,60,60
wl 6
xaa 64,192,64
ta 208,19,20480
xaa 68,192,68
ta 210,19,22528
xaa 72,192,72
xaa 76,192,76
wl 6
xaa 80,196,64
ta 212,20,20480
xaa 84,196,68
ta 214,20,22528
xaa 88,196,72
xaa 92,196,76
wl 6
xaa 96,200,64
ta 216,21,20480
xaa 100,200,68
ta 218,21,22528
xaa 104,200,72
xaa 108,200,76
wl 6
xaa 112,204,64
ta 220,22,20480
xaa 116,204,68
ta 222,22,22528
xaa 120,204,72
xaa 124,204,76
xva 128,60,64
xva 132,60,68
xva 136,60,72
xva 140,60,76
wl 6
xaa 64,208,80
ta 224,19,24576
xaa 68,208,84
ta 226,19,26624
xaa 72,208,88
xaa 76,208,92
wl 6
xaa 80,212,80
ta 228,20,24576
xaa 84,212,84
ta 230,20,26624
xaa 88,212,88
xaa 92,212,92
wl 6
xaa 96,216,80
ta 232,21,24576
xaa 100,216,84
ta 234,21,26624
xaa 104,216,88
xaa 108,216,92
wl 6
xaa 112,220,80
ta 236,22,24576
xaa 116,220,84
ta 238,22,26624
xaa 120,220,88
xaa 124,220,92
xva 128,60,80
xva 132,60,84
xva 136,60,88
xva 140,60,92
wl 6
xaa 64,224,96
ta 240,19,28672
xaa 68,224,100
ta 242,19,30720
xaa 72,224,104
xaa 76,224,108
wl 6
xaa 80,228,96
ta 244,20,28672
xaa 84,228,100
ta 246,20,30720
xaa 88,228,104
xaa 92,228,108
wl 6
xaa 96,232,96
ta 248,21,28672
xaa 100,232,100
ta 250,21,30720
xaa 104,232,104
xaa 108,232,108
wl 6
xaa 112,236,96
ta 252,22,28672
xaa 116,236,100
ta 254,22,30720
xaa 120,236,104
xaa 124,236,108
xva 128,60,96
xva 132,60,100
s_add_u32 m0, s29, 0
s_mov_b32 s30, 128
xva 136,60,104
xva 140,60,108
wl 6
wv 4
s_barrier
xaa 64,240,112
ta 192,19,32768
xaa 68,240,116
ta 194,19,34816
xaa 72,240,120
dm 7,16,30,0
xaa 76,240,124
wl 6
xaa 80,244,112
ta 196,20,32768
xaa 84,244,116
ta 198,20,34816
xaa 88,244,120
dm 8,16,30,1024
xaa 92,244,124
wl 6
xaa 96,248,112
ta 200,21,32768
xaa 100,248,116
ta 202,21,34816
xaa 104,248,120
dm 9,16,30,2048
xaa 108,248,124
wl 6
xaa 112,252,112
ta 204,22,32768
xaa 116,252,116
ta 206,22,34816
xaa 120,252,120
dm 10,16,30,3072
xaa 124,252,124
xva 128,60,112
xva 132,60,116
xva 136,60,120
xva 140,60,124
wl 6
xaa 64,192,128
ta 208,19,36864
xaa 68,192,132
ta 210,19,38912
xaa 72,192,136
xaa 76,192,140
wl 6
xaa 80,196,128
ta 212,20,36864
xaa 84,196,132
ta 214,20,38912
xaa 88,196,136
xaa 92,196,140
wl 6
xaa 96,200,128
ta 216,21,36864
xaa 100,200,132
ta 218,21,38912
xaa 104,200,136
xaa 108,200,140
wl 6
xaa 112,204,128
ta 220,22,36864
xaa 116,204,132
ta 222,22,38912
xaa 120,204,136
xaa 124,204,140
xva 128,60,128
xva 132,60,132
xva 136,60,136
xva 140,60,140
wl 6
xaa 64,208,144
ta 224,19,40960
xaa 68,208,148
ta 226,19,43008
xaa 72,208,152
xaa 76,208,156
wl 6
xaa 80,212,144
ta 228,20,40960
xaa 84,212,148
ta 230,20,43008
xaa 88,212,152
xaa 92,212,156
wl 6
xaa 96,216,144
ta 232,21,40960
xaa 100,216,148
ta 234,21,43008
xaa 104,216,152
xaa 108,216,156
wl 6
xaa 112,220,144
ta 236,22,40960
xaa 116,220,148
ta 238,22,43008
xaa 120,220,152
xaa 124,220,156
xva 128,60,144
xva 132,60,148
xva 136,60,152
xva 140,60,156
wl 6
xaa 64,224,160
ta 240,19,45056
xaa 68,224,164
ta 242,19,47104
xaa 72,224,168
xaa 76,224,172
wl 6
xaa 80,228,160
ta 244,20,45056
xaa 84,228,164
ta 246,20,47104
xaa 88,228,168
xaa 92,228,172
wl 6
xaa 96,232,160
ta 248,21,45056
xaa 100,232,164
ta 250,21,47104
xaa 104,232,168
xaa 108,232,172
wl 6
xaa 112,236,160
ta 252,22,45056
xaa 116,236,164
ta 254,22,47104
xaa 120,236,168
xaa 124,236,172
xva 128,60,160
xva 132,60,164
s_add_u32 m0, s29, 16384
s_mov_b32 s30, 49280
xva 136,60,168
xva 140,60,172
wl 6
wv 4
s_barrier
xaa 64,240,176
ta 192,19,49152
xaa 68,240,180
ta 194,19,51200
xaa 72,240,184
dm 7,16,30,0
xaa 76,240,188
wl 6
xaa 80,244,176
ta 196,20,49152
xaa 84,244,180
ta 198,20,51200
xaa 88,244,184
dm 8,16,30,1024
xaa 92,244,188
wl 6
xaa 96,248,176
ta 200,21,49152
xaa 100,248,180
ta 202,21,51200
xaa 104,248,184
dm 9,16,30,2048
xaa 108,248,188
wl 6
xaa 112,252,176
ta 204,22,49152
xaa 116,252,180
ta 206,22,51200
xaa 120,252,184
dm 10,16,30,3072
xaa 124,252,188
xva 128,60,176
xva 132,60,180
xva 136,60,184
xva 140,60,188
wl 6
xav 64,192,28
ta 208,19,53248
xav 68,192,32
ta 210,19,55296
xav 72,192,36
xav 76,192,40
wl 6
xav 80,196,28
ta 212,20,53248
xav 84,196,32
ta 214,20,55296
xav 88,196,36
xav 92,196,40
wl 6
xav 96,200,28
ta 216,21,53248
xav 100,200,32
ta 218,21,55296
xav 104,200,36
xav 108,200,40
wl 6
xav 112,204,28
ta 220,22,53248
xav 116,204,32
ta 222,22,55296
xav 120,204,36
xav 124,204,40
xvv 128,60,28
xvv 132,60,32
xvv 136,60,36
xvv 140,60,40
wl 6
xav 64,208,44
ta 224,19,57344
xav 68,208,48
ta 226,19,59392
xav 72,208,52
xav 76,208,56
wl 6
xav 80,212,44
ta 228,20,57344
xav 84,212,48
ta 230,20,59392
xav 88,212,52
xav 92,212,56
wl 6
xav 96,216,44
ta 232,21,57344
xav 100,216,48
ta 234,21,59392
xav 104,216,52
xav 108,216,56
wl 6
xav 112,220,44
ta 236,22,57344
xav 116,220,48
ta 238,22,59392
xav 120,220,52
xav 124,220,56
xvv 128,60,44
xvv 132,60,48
xvv 136,60,52
xvv 140,60,56
wl 6
xav 64,224,224
ta 240,19,61440
xav 68,224,228
ta 242,19,63488
xav 72,224,232
xav 76,224,236
wl 6
xav 80,228,224
ta 244,20,61440
xav 84,228,228
ta 246,20,63488
xav 88,228,232
xav 92,228,236
wl 6
xav 96,232,224
ta 248,21,61440
xav 100,232,228
ta 250,21,63488
xav 104,232,232
xav 108,232,236
wl 6
xav 112,236,224
ta 252,22,61440
xav 116,236,228
ta 254,22,63488
xav 120,236,232
xav 124,236,236
xvv 128,60,224
xvv 132,60,228
s_add_u32 m0, s29, 32768
s_mov_b32 s30, 98432
xvv 136,60,232
xvv 140,60,236
wl 6
wv 4
s_barrier
xav 64,240,240
ta 192,19,0
xav 68,240,244
ta 194,19,2048
xav 72,240,248
dm 7,16,30,0
xav 76,240,252
wl 6
xav 80,244,240
ta 196,20,0
xav 84,244,244
ta 198,20,2048
xav 88,244,248
dm 8,16,30,1024
xav 92,244,252
wl 6
xav 96,248,240
ta 200,21,0
xav 100,248,244
ta 202,21,2048
xav 104,248,248
dm 9,16,30,2048
xav 108,248,252
wl 6
xav 112,252,240
ta 204,22,0
xav 116,252,244
ta 206,22,2048
xav 120,252,248
dm 10,16,30,3072
xav 124,252,252
xvv 128,60,240
xvv 132,60,244
xvv 136,60,248
xvv 140,60,252
wl 6
v_mfma_f32_16x16x32_bf16 v[160:163], a[192:195], a[0:3], 0
ta 208,19,4096
v_mfma_f32_16x16x32_bf16 v[164:167], a[192:195], a[4:7], 0
ta 210,19,6144
v_mfma_f32_16x16x32_bf16 v[168:171], a[192:195], a[8:11], 0
v_mfma_f32_16x16x32_bf16 v[172:175], a[192:195], a[12:15], 0
wl 6
v_rcp_f32 v144, v128
v_mfma_f32_16x16x32_bf16 v[176:179], a[196:199], a[0:3], 0
ta 212,20,4096
v_mfma_f32_16x16x32_bf16 v[180:183], a[196:199], a[4:7], 0
ta 214,20,6144
v_mfma_f32_16x16x32_bf16 v[184:187], a[196:199], a[8:11], 0
v_rcp_f32 v145, v132
v_mfma_f32_16x16x32_bf16 v[188:191], a[196:199], a[12:15], 0
wl 6
v_rcp_f32 v146, v136
v_mfma_f32_16x16x32_bf16 v[192:195], a[200:203], a[0:3], 0
ta 216,21,4096
v_mfma_f32_16x16x32_bf16 v[196:199], a[200:203], a[4:7], 0
ta 218,21,6144
v_mfma_f32_16x16x32_bf16 v[200:203], a[200:203], a[8:11], 0
v_rcp_f32 v147, v140
v_mfma_f32_16x16x32_bf16 v[204:207], a[200:203], a[12:15], 0
wl 6
s_mov_b64 s[100:101], -1
v_mfma_f32_16x16x32_bf16 v[208:211], a[204:207], a[0:3], 0
ta 220,22,4096
v_cmp_le_f32 vcc, 0x1f800000, v128
v_mfma_f32_16x16x32_bf16 v[212:215], a[204:207], a[4:7], 0
ta 222,22,6144
v_mfma_f32_16x16x32_bf16 v[216:219], a[204:207], a[8:11], 0
s_nop 0
s_and_b64 s[100:101], s[100:101], vcc
v_mfma_f32_16x16x32_bf16 v[220:223], a[204:207], a[12:15], 0
wl 6
xaa 160,208,16
ta 224,19,8192
v_cmp_ge_f32 vcc, 0x67800000, v128
xaa 164,208,20
ta 226,19,10240
s_nop 1
s_and_b64 s[100:101], s[100:101], vcc
xaa 168,208,24
xaa 172,208,28
wl 6
v_cmp_le_f32 vcc, 0x1f800000, v132
xaa 176,212,16
ta 228,20,8192
xaa 180,212,20
ta 230,20,10240
s_and_b64 s[100:101], s[100:101], vcc
xaa 184,212,24
xaa 188,212,28
wl 6
v_cmp_ge_f32 vcc, 0x67800000, v132
xaa 192,216,16
ta 232,21,8192
xaa 196,216,20
ta 234,21,10240
s_and_b64 s[100:101], s[100:101], vcc
xaa 200,216,24
xaa 204,216,28
wl 6
v_cmp_le_f32 vcc, 0x1f800000, v136
xaa 208,220,16
ta 236,22,8192
xaa 212,220,20
ta 238,22,10240
s_and_b64 s[100:101], s[100:101], vcc
xaa 216,220,24
v_cmp_ge_f32 vcc, 0x67800000, v136
xaa 220,220,28
wl 6
xaa 160,224,32
ta 240,19,12288
s_and_b64 s[100:101], s[100:101], vcc
xaa 164,224,36
ta 242,19,14336
xaa 168,224,40
v_cmp_le_f32 vcc, 0x1f800000, v140
xaa 172,224,44
wl 6
xaa 176,228,32
ta 244,20,12288
s_and_b64 s[100:101], s[100:101], vcc
xaa 180,228,36
ta 246,20,14336
xaa 184,228,40
v_cmp_ge_f32 vcc, 0x67800000, v140
xaa 188,228,44
wl 6
xaa 192,232,32
ta 248,21,12288
s_and_b64 s[100:101], s[100:101], vcc
xaa 196,232,36
ta 250,21,14336
xaa 200,232,40
s_mov_b32 s31, 0
xaa 204,232,44
wl 6
xaa 208,236,32
ta 252,22,12288
v_mul_f32 v64, v144, v64
xaa 212,236,36
ta 254,22,14336
s_add_u32 m0, s29, 49152
xaa 216,236,40
s_mov_b32 s30, 147584
v_mul_f32 v65, v144, v65
xaa 220,236,44
wl 6
wv 4
s_barrier
xaa 160,240,48
ta 192,19,16384
v_mul_f32 v66, v144, v66
xaa 164,240,52
ta 194,19,18432
v_mul_f32 v67, v144, v67
xaa 168,240,56
dm 7,16,30,0
xaa 172,240,60
wl 6
v_mul_f32 v80, v144, v80
xaa 176,244,48
ta 196,20,16384
xaa 180,244,52
ta 198,20,18432
v_mul_f32 v81, v144, v81
xaa 184,244,56
dm 8,16,30,1024
xaa 188,244,60
wl 6
v_mul_f32 v82, v144, v82
xaa 192,248,48
ta 200,21,16384
xaa 196,248,52
ta 202,21,18432
v_mul_f32 v83, v144, v83
xaa 200,248,56
dm 9,16,30,2048
cv 64,64,65
xaa 204,248,60
wl 6
xaa 208,252,48
ta 204,22,16384
cv 65,66,67
xaa 212,252,52
ta 206,22,18432
xaa 216,252,56
dm 10,16,30,3072
cv 66,80,81
xaa 220,252,60
wl 6
xaa 160,192,64
ta 208,19,20480
cv 67,82,83
xaa 164,192,68
ta 210,19,22528
xaa 168,192,72
buffer_store_dwordx4 v[64:67], v23, s[20:23], s31 offen sc1
xaa 172,192,76
wl 6
xaa 176,196,64
ta 212,20,20480
v_mul_f32 v68, v145, v68
xaa 180,196,68
ta 214,20,22528
xaa 184,196,72
v_mul_f32 v69, v145, v69
xaa 188,196,76
wl 6
xaa 192,200,64
ta 216,21,20480
v_mul_f32 v70, v145, v70
xaa 196,200,68
ta 218,21,22528
v_mul_f32 v71, v145, v71
xaa 200,200,72
xaa 204,200,76
wl 6
v_mul_f32 v84, v145, v84
xaa 208,204,64
ta 220,22,20480
xaa 212,204,68
ta 222,22,22528
v_mul_f32 v85, v145, v85
xaa 216,204,72
xaa 220,204,76
wl 6
v_mul_f32 v86, v145, v86
xaa 160,208,80
ta 224,19,24576
xaa 164,208,84
ta 226,19,26624
v_mul_f32 v87, v145, v87
xaa 168,208,88
xaa 172,208,92
wl 6
cv 68,68,69
xaa 176,212,80
ta 228,20,24576
xaa 180,212,84
ta 230,20,26624
cv 69,70,71
xaa 184,212,88
cv 70,84,85
xaa 188,212,92
wl 6
xaa 192,216,80
ta 232,21,24576
cv 71,86,87
xaa 196,216,84
ta 234,21,26624
xaa 200,216,88
buffer_store_dwordx4 v[68:71], v24, s[20:23], s31 offen sc1
xaa 204,216,92
wl 6
xaa 208,220,80
ta 236,22,24576
v_mul_f32 v72, v146, v72
xaa 212,220,84
ta 238,22,26624
xaa 216,220,88
v_mul_f32 v73, v146, v73
xaa 220,220,92
wl 6
xaa 160,224,96
ta 240,19,28672
v_mul_f32 v74, v146, v74
xaa 164,224,100
ta 242,19,30720
xaa 168,224,104
v_mul_f32 v75, v146, v75
xaa 172,224,108
wl 6
xaa 176,228,96
ta 244,20,28672
v_mul_f32 v88, v146, v88
xaa 180,228,100
ta 246,20,30720
v_mul_f32 v89, v146, v89
xaa 184,228,104
xaa 188,228,108
wl 6
v_mul_f32 v90, v146, v90
xaa 192,232,96
ta 248,21,28672
xaa 196,232,100
ta 250,21,30720
v_mul_f32 v91, v146, v91
xaa 200,232,104
xaa 204,232,108
wl 6
cv 72,72,73
xaa 208,236,96
ta 252,22,28672
xaa 212,236,100
ta 254,22,30720
s_add_u32 m0, s29, 0
xaa 216,236,104
s_mov_b32 s30, 256
cv 73,74,75
xaa 220,236,108
wl 6
wv 6
s_barrier
xaa 160,240,112
ta 192,19,32768
cv 74,88,89
xaa 164,240,116
ta 194,19,34816
cv 75,90,91
xaa 168,240,120
dm 7,16,30,0
xaa 172,240,124
wl 6
buffer_store_dwordx4 v[72:75], v25, s[20:23], s31 offen sc1
xaa 176,244,112
ta 196,20,32768
v_mul_f32 v76, v147, v76
xaa 180,244,116
ta 198,20,34816
xaa 184,244,120
dm 8,16,30,1024
v_mul_f32 v77, v147, v77
xaa 188,244,124
wl 6
xaa 192,248,112
ta 200,21,32768
v_mul_f32 v78, v147, v78
xaa 196,248,116
ta 202,21,34816
xaa 200,248,120
dm 9,16,30,2048
v_mul_f32 v79, v147, v79
xaa 204,248,124
wl 6
xaa 208,252,112
ta 204,22,32768
v_mul_f32 v92, v147, v92
xaa 212,252,116
ta 206,22,34816
xaa 216,252,120
dm 10,16,30,3072
v_mul_f32 v93, v147, v93
xaa 220,252,124
wl 6
xaa 160,192,128
ta 208,19,36864
v_mul_f32 v94, v147, v94
xaa 164,192,132
ta 210,19,38912
v_mul_f32 v95, v147, v95
xaa 168,192,136
xaa 172,192,140
wl 6
cv 76,76,77
xaa 176,196,128
ta 212,20,36864
xaa 180,196,132
ta 214,20,38912
cv 77,78,79
xaa 184,196,136
xaa 188,196,140
wl 6
cv 78,92,93
xaa 192,200,128
ta 216,21,36864
xaa 196,200,132
ta 218,21,38912
cv 79,94,95
xaa 200,200,136
xaa 204,200,140
wl 6
buffer_store_dwordx4 v[76:79], v26, s[20:23], s31 offen sc1
xaa 208,204,128
ta 220,22,36864
xaa 212,204,132
ta 222,22,38912
s_mov_b32 s31, 1024
xaa 216,204,136
v_mul_f32 v96, v144, v96
xaa 220,204,140
wl 6
xaa 160,208,144
ta 224,19,40960
v_mul_f32 v97, v144, v97
xaa 164,208,148
ta 226,19,43008
xaa 168,208,152
v_mul_f32 v98, v144, v98
xaa 172,208,156
wl 6
xaa 176,212,144
ta 228,20,40960
v_mul_f32 v99, v144, v99
xaa 180,212,148
ta 230,20,43008
xaa 184,212,152
v_mul_f32 v112, v144, v112
xaa 188,212,156
wl 6
xaa 192,216,144
ta 232,21,40960
v_mul_f32 v113, v144, v113
xaa 196,216,148
ta 234,21,43008
xaa 200,216,152
v_mul_f32 v114, v144, v114
xaa 204,216,156
wl 6
xaa 208,220,144
ta 236,22,40960
v_mul_f32 v115, v144, v115
xaa 212,220,148
ta 238,22,43008
cv 96,96,97
xaa 216,220,152
xaa 220,220,156
wl 6
cv 97,98,99
xaa 160,224,160
ta 240,19,45056
xaa 164,224,164
ta 242,19,47104
cv 98,112,113
xaa 168,224,168
xaa 172,224,172
wl 6
cv 99,114,115
xaa 176,228,160
ta 244,20,45056
xaa 180,228,164
ta 246,20,47104
xaa 184,228,168
buffer_store_dwordx4 v[96:99], v23, s[20:23], s31 offen sc1
xaa 188,228,172
wl 6
v_mul_f32 v100, v145, v100
xaa 192,232,160
ta 248,21,45056
xaa 196,232,164
ta 250,21,47104
v_mul_f32 v101, v145, v101
xaa 200,232,168
v_mul_f32 v102, v145, v102
xaa 204,232,172
wl 6
xaa 208,236,160
ta 252,22,45056
v_mul_f32 v103, v145, v103
xaa 212,236,164
ta 254,22,47104
s_add_u32 m0, s29, 16384
xaa 216,236,168
s_mov_b32 s30, 49408
v_mul_f32 v116, v145, v116
xaa 220,236,172
wl 6
wv 9
s_barrier
xaa 160,240,176
ta 192,19,49152
v_mul_f32 v117, v145, v117
xaa 164,240,180
ta 194,19,51200
xaa 168,240,184
dm 7,16,30,0
v_mul_f32 v118, v145, v118
xaa 172,240,188
wl 6
xaa 176,244,176
ta 196,20,49152
v_mul_f32 v119, v145, v119
xaa 180,244,180
ta 198,20,51200
xaa 184,244,184
dm 8,16,30,1024
cv 100,100,101
xaa 188,244,188
wl 6
xaa 192,248,176
ta 200,21,49152
cv 101,102,103
xaa 196,248,180
ta 202,21,51200
cv 102,116,117
xaa 200,248,184
dm 9,16,30,2048
xaa 204,248,188
wl 6
cv 103,118,119
xaa 208,252,176
ta 204,22,49152
xaa 212,252,180
ta 206,22,51200
xaa 216,252,184
dm 10,16,30,3072
xaa 220,252,188
wl 6
buffer_store_dwordx4 v[100:103], v24, s[20:23], s31 offen sc1
v_mul_f32 v104, v146, v104
xav 160,192,28
ta 208,19,53248
xav 164,192,32
ta 210,19,55296
v_mul_f32 v105, v146, v105
xav 168,192,36
xav 172,192,40
wl 6
v_mul_f32 v106, v146, v106
xav 176,196,28
ta 212,20,53248
xav 180,196,32
ta 214,20,55296
v_mul_f32 v107, v146, v107
xav 184,196,36
v_mul_f32 v120, v146, v120
xav 188,196,40
wl 6
xav 192,200,28
ta 216,21,53248
v_mul_f32 v121, v146, v121
xav 196,200,32
ta 218,21,55296
xav 200,200,36
v_mul_f32 v122, v146, v122
xav 204,200,40
wl 6
xav 208,204,28
ta 220,22,53248
v_mul_f32 v123, v146, v123
xav 212,204,32
ta 222,22,55296
xav 216,204,36
cv 104,104,105
xav 220,204,40
wl 6
xav 160,208,44
ta 224,19,57344
cv 105,106,107
xav 164,208,48
ta 226,19,59392
xav 168,208,52
cv 106,120,121
xav 172,208,56
wl 6
xav 176,212,44
ta 228,20,57344
cv 107,122,123
xav 180,212,48
ta 230,20,59392
xav 184,212,52
buffer_store_dwordx4 v[104:107], v25, s[20:23], s31 offen sc1
xav 188,212,56
wl 6
v_mul_f32 v108, v147, v108
xav 192,216,44
ta 232,21,57344
xav 196,216,48
ta 234,21,59392
v_mul_f32 v109, v147, v109
xav 200,216,52
xav 204,216,56
wl 6
v_mul_f32 v110, v147, v110
xav 208,220,44
ta 236,22,57344
xav 212,220,48
ta 238,22,59392
v_mul_f32 v111, v147, v111
xav 216,220,52
xav 220,220,56
wl 6
v_mul_f32 v124, v147, v124
xav 160,224,224
ta 240,19,61440
xav 164,224,228
ta 242,19,63488
v_mul_f32 v125, v147, v125
xav 168,224,232
v_mul_f32 v126, v147, v126
xav 172,224,236
wl 6
xav 176,228,224
ta 244,20,61440
v_mul_f32 v127, v147, v127
xav 180,228,228
ta 246,20,63488
xav 184,228,232
cv 108,108,109
xav 188,228,236
wl 6
xav 192,232,224
ta 248,21,61440
cv 109,110,111
xav 196,232,228
ta 250,21,63488
xav 200,232,232
cv 110,124,125
xav 204,232,236
wl 6
xav 208,236,224
ta 252,22,61440
cv 111,126,127
xav 212,236,228
ta 254,22,63488
s_add_u32 m0, s29, 32768
xav 216,236,232
s_mov_b32 s30, 98560
buffer_store_dwordx4 v[108:111], v26, s[20:23], s31 offen sc1
xav 220,236,236
wl 6
wv 9
s_barrier
xav 160,240,240
ta 192,19,0
xav 164,240,244
ta 194,19,2048
xav 168,240,248
dm 7,16,30,0
xav 172,240,252
wl 6
xav 176,244,240
ta 196,20,0
xav 180,244,244
ta 198,20,2048
xav 184,244,248
dm 8,16,30,1024
xav 188,244,252
wl 6
xav 192,248,240
ta 200,21,0
xav 196,248,244
ta 202,21,2048
xav 200,248,248
dm 9,16,30,2048
xav 204,248,252
wl 6
xav 208,252,240
ta 204,22,0
xav 212,252,244
ta 206,22,2048
xav 216,252,248
dm 10,16,30,3072
xav 220,252,252
wl 6
v_mfma_f32_16x16x32_bf16 v[64:67], a[192:195], a[0:3], 0
ta 208,19,4096
v_mfma_f32_16x16x32_bf16 v[68:71], a[192:195], a[4:7], 0
ta 210,19,6144
v_mfma_f32_16x16x32_bf16 v[72:75], a[192:195], a[8:11], 0
v_mfma_f32_16x16x32_bf16 v[76:79], a[192:195], a[12:15], 0
wl 6
s_mov_b32 s31, 2048
v_mfma_f32_16x16x32_bf16 v[80:83], a[196:199], a[0:3], 0
ta 212,20,4096
v_mul_f32 v160, v144, v160
v_mfma_f32_16x16x32_bf16 v[84:87], a[196:199], a[4:7], 0
ta 214,20,6144
v_mfma_f32_16x16x32_bf16 v[88:91], a[196:199], a[8:11], 0
v_mul_f32 v161, v144, v161
v_mfma_f32_16x16x32_bf16 v[92:95], a[196:199], a[12:15], 0
wl 6
v_mfma_f32_16x16x32_bf16 v[96:99], a[200:203], a[0:3], 0
ta 216,21,4096
v_mul_f32 v162, v144, v162
v_mfma_f32_16x16x32_bf16 v[100:103], a[200:203], a[4:7], 0
ta 218,21,6144
v_mul_f32 v163, v144, v163
v_mfma_f32_16x16x32_bf16 v[104:107], a[200:203], a[8:11], 0
v_mfma_f32_16x16x32_bf16 v[108:111], a[200:203], a[12:15], 0
wl 6
v_mul_f32 v176, v144, v176
v_mfma_f32_16x16x32_bf16 v[112:115], a[204:207], a[0:3], 0
ta 220,22,4096
v_mfma_f32_16x16x32_bf16 v[116:119], a[204:207], a[4:7], 0
ta 222,22,6144
v_mul_f32 v177, v144, v177
v_mfma_f32_16x16x32_bf16 v[120:123], a[204:207], a[8:11], 0
v_mul_f32 v178, v144, v178
v_mfma_f32_16x16x32_bf16 v[124:127], a[204:207], a[12:15], 0
wl 6
xaa 64,208,16
ta 224,19,8192
v_mul_f32 v179, v144, v179
xaa 68,208,20
ta 226,19,10240
xaa 72,208,24
cv 160,160,161
xaa 76,208,28
wl 6
xaa 80,212,16
ta 228,20,8192
cv 161,162,163
xaa 84,212,20
ta 230,20,10240
cv 162,176,177
xaa 88,212,24
xaa 92,212,28
wl 6
cv 163,178,179
xaa 96,216,16
ta 232,21,8192
xaa 100,216,20
ta 234,21,10240
xaa 104,216,24
buffer_store_dwordx4 v[160:163], v23, s[20:23], s31 offen sc1
v_mul_f32 v164, v145, v164
xaa 108,216,28
wl 6
xaa 112,220,16
ta 236,22,8192
v_mul_f32 v165, v145, v165
xaa 116,220,20
ta 238,22,10240
xaa 120,220,24
v_mul_f32 v166, v145, v166
xaa 124,220,28
wl 6
xaa 64,224,32
ta 240,19,12288
v_mul_f32 v167, v145, v167
xaa 68,224,36
ta 242,19,14336
v_mul_f32 v180, v145, v180
xaa 72,224,40
xaa 76,224,44
wl 6
v_mul_f32 v181, v145, v181
xaa 80,228,32
ta 244,20,12288
xaa 84,228,36
ta 246,20,14336
v_mul_f32 v182, v145, v182
xaa 88,228,40
v_mul_f32 v183, v145, v183
xaa 92,228,44
wl 6
xaa 96,232,32
ta 248,21,12288
cv 164,164,165
xaa 100,232,36
ta 250,21,14336
xaa 104,232,40
cv 165,166,167
xaa 108,232,44
wl 6
cv 166,180,181
xaa 112,236,32
ta 252,22,12288
xaa 116,236,36
ta 254,22,14336
s_add_u32 m0, s29, 49152
xaa 120,236,40
s_mov_b32 s30, 147712
cv 167,182,183
xaa 124,236,44
wl 6
wv 8
s_barrier
xaa 64,240,48
ta 192,19,16384
xaa 68,240,52
ta 194,19,18432
xaa 72,240,56
dm 7,16,30,0
xaa 76,240,60
wl 6
buffer_store_dwordx4 v[164:167], v24, s[20:23], s31 offen sc1
v_mul_f32 v168, v146, v168
xaa 80,244,48
ta 196,20,16384
v_mul_f32 v169, v146, v169
xaa 84,244,52
ta 198,20,18432
v_mul_f32 v170, v146, v170
xaa 88,244,56
dm 8,16,30,1024
v_mul_f32 v171, v146, v171
xaa 92,244,60
wl 6
v_mul_f32 v184, v146, v184
xaa 96,248,48
ta 200,21,16384
xaa 100,248,52
ta 202,21,18432
v_mul_f32 v185, v146, v185
xaa 104,248,56
dm 9,16,30,2048
xaa 108,248,60
wl 6
v_mul_f32 v186, v146, v186
xaa 112,252,48
ta 204,22,16384
xaa 116,252,52
ta 206,22,18432
v_mul_f32 v187, v146, v187
xaa 120,252,56
dm 10,16,30,3072
cv 168,168,169
xaa 124,252,60
wl 6
xaa 64,192,64
ta 208,19,20480
cv 169,170,171
xaa 68,192,68
ta 210,19,22528
xaa 72,192,72
cv 170,184,185
xaa 76,192,76
wl 6
cv 171,186,187
xaa 80,196,64
ta 212,20,20480
xaa 84,196,68
ta 214,20,22528
xaa 88,196,72
buffer_store_dwordx4 v[168:171], v25, s[20:23], s31 offen sc1
xaa 92,196,76
wl 6
v_mul_f32 v172, v147, v172
xaa 96,200,64
ta 216,21,20480
xaa 100,200,68
ta 218,21,22528
v_mul_f32 v173, v147, v173
xaa 104,200,72
v_mul_f32 v174, v147, v174
xaa 108,200,76
wl 6
xaa 112,204,64
ta 220,22,20480
v_mul_f32 v175, v147, v175
xaa 116,204,68
ta 222,22,22528
xaa 120,204,72
v_mul_f32 v188, v147, v188
xaa 124,204,76
wl 6
v_mul_f32 v189, v147, v189
xaa 64,208,80
ta 224,19,24576
xaa 68,208,84
ta 226,19,26624
v_mul_f32 v190, v147, v190
xaa 72,208,88
xaa 76,208,92
wl 6
v_mul_f32 v191, v147, v191
xaa 80,212,80
ta 228,20,24576
cv 172,172,173
xaa 84,212,84
ta 230,20,26624
xaa 88,212,88
cv 173,174,175
xaa 92,212,92
wl 6
xaa 96,216,80
ta 232,21,24576
cv 174,188,189
xaa 100,216,84
ta 234,21,26624
xaa 104,216,88
cv 175,190,191
xaa 108,216,92
wl 6
buffer_store_dwordx4 v[172:175], v26, s[20:23], s31 offen sc1
xaa 112,220,80
ta 236,22,24576
xaa 116,220,84
ta 238,22,26624
s_mov_b32 s31, 3072
xaa 120,220,88
xaa 124,220,92
wl 6
v_mul_f32 v192, v144, v192
xaa 64,224,96
ta 240,19,28672
v_mul_f32 v193, v144, v193
xaa 68,224,100
ta 242,19,30720
xaa 72,224,104
v_mul_f32 v194, v144, v194
xaa 76,224,108
wl 6
xaa 80,228,96
ta 244,20,28672
v_mul_f32 v195, v144, v195
xaa 84,228,100
ta 246,20,30720
xaa 88,228,104
v_mul_f32 v208, v144, v208
xaa 92,228,108
wl 6
v_mul_f32 v209, v144, v209
xaa 96,232,96
ta 248,21,28672
xaa 100,232,100
ta 250,21,30720
v_mul_f32 v210, v144, v210
xaa 104,232,104
xaa 108,232,108
wl 6
v_mul_f32 v211, v144, v211
xaa 112,236,96
ta 252,22,28672
cv 192,192,193
xaa 116,236,100
ta 254,22,30720
xaa 120,236,104
cv 193,194,195
xaa 124,236,108
wl 6
wv 8
s_barrier
xaa 64,240,112
ta 192,19,32768
cv 194,208,209
xaa 68,240,116
ta 194,19,34816
cv 195,210,211
xaa 72,240,120
xaa 76,240,124
wl 6
buffer_store_dwordx4 v[192:195], v23, s[20:23], s31 offen sc1
xaa 80,244,112
ta 196,20,32768
xaa 84,244,116
ta 198,20,34816
v_mul_f32 v196, v145, v196
xaa 88,244,120
xaa 92,244,124
wl 6
v_mul_f32 v197, v145, v197
xaa 96,248,112
ta 200,19,36864
v_mul_f32 v198, v145, v198
xaa 100,248,116
ta 202,19,38912
xaa 104,248,120
v_mul_f32 v199, v145, v199
xaa 108,248,124
wl 6
xaa 112,252,112
ta 204,20,36864
v_mul_f32 v212, v145, v212
xaa 116,252,116
ta 206,20,38912
v_mul_f32 v213, v145, v213
xaa 120,252,120
xaa 124,252,124
wl 6
v_mul_f32 v214, v145, v214
xaa 64,192,128
ta 208,19,40960
xaa 68,192,132
ta 210,19,43008
v_mul_f32 v215, v145, v215
xaa 72,192,136
xaa 76,192,140
wl 6
cv 196,196,197
xaa 80,196,128
ta 212,20,40960
cv 197,198,199
xaa 84,196,132
ta 214,20,43008
xaa 88,196,136
cv 198,212,213
xaa 92,196,140
wl 6
xaa 64,200,144
ta 216,19,45056
cv 199,214,215
xaa 68,200,148
ta 218,19,47104
xaa 72,200,152
buffer_store_dwordx4 v[196:199], v24, s[20:23], s31 offen sc1
xaa 76,200,156
wl 6
v_mul_f32 v200, v146, v200
xaa 80,204,144
ta 220,20,45056
xaa 84,204,148
ta 222,20,47104
v_mul_f32 v201, v146, v201
xaa 88,204,152
xaa 92,204,156
wl 6
wv 4
s_barrier
xaa 64,208,160
ta 224,19,49152
v_mul_f32 v202, v146, v202
xaa 68,208,164
ta 226,19,51200
v_mul_f32 v203, v146, v203
xaa 72,208,168
v_mul_f32 v216, v146, v216
xaa 76,208,172
wl 6
xaa 80,212,160
ta 228,20,49152
v_mul_f32 v217, v146, v217
xaa 84,212,164
ta 230,20,51200
v_mul_f32 v218, v146, v218
xaa 88,212,168
xaa 92,212,172
wl 6
v_mul_f32 v219, v146, v219
xaa 64,216,176
ta 232,19,53248
xaa 68,216,180
ta 234,19,55296
cv 200,200,201
xaa 72,216,184
cv 201,202,203
xaa 76,216,188
wl 6
xaa 80,220,176
ta 236,20,53248
cv 202,216,217
xaa 84,220,180
ta 238,20,55296
xaa 88,220,184
cv 203,218,219
xaa 92,220,188
wl 6
xav 64,224,28
ta 240,19,57344
xav 68,224,32
ta 242,19,59392
xav 72,224,36
buffer_store_dwordx4 v[200:203], v25, s[20:23], s31 offen sc1
v_mul_f32 v204, v147, v204
xav 76,224,40
wl 6
v_mul_f32 v205, v147, v205
xav 80,228,28
ta 244,20,57344
xav 84,228,32
ta 246,20,59392
v_mul_f32 v206, v147, v206
xav 88,228,36
v_mul_f32 v207, v147, v207
xav 92,228,40
wl 6
xav 64,232,44
ta 248,19,61440
v_mul_f32 v220, v147, v220
xav 68,232,48
ta 250,19,63488
xav 72,232,52
v_mul_f32 v221, v147, v221
xav 76,232,56
wl 6
xav 80,236,44
ta 252,20,61440
v_mul_f32 v222, v147, v222
xav 84,236,48
ta 254,20,63488
v_mul_f32 v223, v147, v223
xav 88,236,52
xav 92,236,56
wl 6
cv 204,204,205
xav 64,240,224
ta 192,21,32768
xav 68,240,228
ta 194,21,34816
cv 205,206,207
xav 72,240,232
cv 206,220,221
xav 76,240,236
wl 6
xav 80,244,224
ta 196,22,32768
cv 207,222,223
xav 84,244,228
ta 198,22,34816
xav 88,244,232
buffer_store_dwordx4 v[204:207], v26, s[20:23], s31 offen sc1
xav 92,244,236
wl 6
xav 64,248,240
ta 200,21,36864
xav 68,248,244
ta 202,21,38912
xav 72,248,248
xav 76,248,252
wl 6
xav 80,252,240
ta 204,22,36864
xav 84,252,244
ta 206,22,38912
xav 88,252,248
xav 92,252,252
wl 6
xaa 96,192,128
ta 208,21,40960
xaa 100,192,132
ta 210,21,43008
xaa 104,192,136
xaa 108,192,140
wl 6
s_mov_b32 s31, 4096
xaa 112,196,128
ta 212,22,40960
v_mul_f32 v64, v144, v64
xaa 116,196,132
ta 214,22,43008
v_mul_f32 v65, v144, v65
xaa 120,196,136
v_mul_f32 v66, v144, v66
xaa 124,196,140
wl 6
v_mul_f32 v67, v144, v67
xaa 96,200,144
ta 216,21,45056
v_mul_f32 v80, v144, v80
xaa 100,200,148
ta 218,21,47104
v_mul_f32 v81, v144, v81
xaa 104,200,152
v_mul_f32 v82, v144, v82
xaa 108,200,156
wl 6
v_mul_f32 v83, v144, v83
xaa 112,204,144
ta 220,22,45056
cv 64,64,65
xaa 116,204,148
ta 222,22,47104
cv 65,66,67
xaa 120,204,152
cv 66,80,81
xaa 124,204,156
wl 6
cv 67,82,83
xaa 96,208,160
ta 224,21,49152
xaa 100,208,164
ta 226,21,51200
xaa 104,208,168
buffer_store_dwordx4 v[64:67], v23, s[20:23], s31 offen sc1
v_mul_f32 v68, v145, v68
xaa 108,208,172
wl 6
v_mul_f32 v69, v145, v69
v_mul_f32 v70, v145, v70
xaa 112,212,160
ta 228,22,49152
v_mul_f32 v71, v145, v71
xaa 116,212,164
ta 230,22,51200
v_mul_f32 v84, v145, v84
xaa 120,212,168
v_mul_f32 v85, v145, v85
xaa 124,212,172
wl 6
v_mul_f32 v86, v145, v86
xaa 96,216,176
ta 232,21,53248
v_mul_f32 v87, v145, v87
xaa 100,216,180
ta 234,21,55296
cv 68,68,69
xaa 104,216,184
cv 69,70,71
xaa 108,216,188
wl 6
cv 70,84,85
xaa 112,220,176
ta 236,22,53248
cv 71,86,87
xaa 116,220,180
ta 238,22,55296
xaa 120,220,184
buffer_store_dwordx4 v[68:71], v24, s[20:23], s31 offen sc1
xaa 124,220,188
wl 6
v_mul_f32 v72, v146, v72
xav 96,224,28
ta 240,21,57344
v_mul_f32 v73, v146, v73
xav 100,224,32
ta 242,21,59392
v_mul_f32 v74, v146, v74
xav 104,224,36
v_mul_f32 v75, v146, v75
xav 108,224,40
wl 6
v_mul_f32 v88, v146, v88
xav 112,228,28
ta 244,22,57344
v_mul_f32 v89, v146, v89
xav 116,228,32
ta 246,22,59392
v_mul_f32 v90, v146, v90
xav 120,228,36
v_mul_f32 v91, v146, v91
xav 124,228,40
wl 6
cv 72,72,73
xav 96,232,44
ta 248,21,61440
cv 73,74,75
xav 100,232,48
ta 250,21,63488
cv 74,88,89
xav 104,232,52
cv 75,90,91
xav 108,232,56
wl 6
buffer_store_dwordx4 v[72:75], v25, s[20:23], s31 offen sc1
xav 112,236,44
ta 252,22,61440
v_mul_f32 v76, v147, v76
xav 116,236,48
ta 254,22,63488
v_mul_f32 v77, v147, v77
xav 120,236,52
v_mul_f32 v78, v147, v78
xav 124,236,56
wl 6
v_mul_f32 v79, v147, v79
xav 96,240,224
v_mul_f32 v92, v147, v92
xav 100,240,228
v_mul_f32 v93, v147, v93
xav 104,240,232
v_mul_f32 v94, v147, v94
xav 108,240,236
wl 4
v_mul_f32 v95, v147, v95
xav 112,244,224
cv 76,76,77
xav 116,244,228
cv 77,78,79
xav 120,244,232
cv 78,92,93
xav 124,244,236
wl 2
cv 79,94,95
xav 96,248,240
buffer_store_dwordx4 v[76:79], v26, s[20:23], s31 offen sc1
xav 100,248,244
xav 104,248,248
xav 108,248,252
wl 0
xav 112,252,240
xav 116,252,244
xav 120,252,248
xav 124,252,252
s_mov_b32 s31, 5120
v_mul_f32 v96, v144, v96
v_mul_f32 v97, v144, v97
v_mul_f32 v98, v144, v98
v_mul_f32 v99, v144, v99
v_mul_f32 v112, v144, v112
v_mul_f32 v113, v144, v113
v_mul_f32 v114, v144, v114
v_mul_f32 v115, v144, v115
cv 96,96,97
cv 97,98,99
cv 98,112,113
cv 99,114,115
buffer_store_dwordx4 v[96:99], v23, s[20:23], s31 offen sc1
v_mul_f32 v100, v145, v100
v_mul_f32 v101, v145, v101
v_mul_f32 v102, v145, v102
v_mul_f32 v103, v145, v103
v_mul_f32 v116, v145, v116
v_mul_f32 v117, v145, v117
v_mul_f32 v118, v145, v118
v_mul_f32 v119, v145, v119
cv 100,100,101
cv 101,102,103
cv 102,116,117
cv 103,118,119
buffer_store_dwordx4 v[100:103], v24, s[20:23], s31 offen sc1
v_mul_f32 v104, v146, v104
v_mul_f32 v105, v146, v105
v_mul_f32 v106, v146, v106
v_mul_f32 v107, v146, v107
v_mul_f32 v120, v146, v120
v_mul_f32 v121, v146, v121
v_mul_f32 v122, v146, v122
v_mul_f32 v123, v146, v123
cv 104,104,105
cv 105,106,107
cv 106,120,121
cv 107,122,123
buffer_store_dwordx4 v[104:107], v25, s[20:23], s31 offen sc1
v_mul_f32 v108, v147, v108
v_mul_f32 v109, v147, v109
v_mul_f32 v110, v147, v110
v_mul_f32 v111, v147, v111
v_mul_f32 v124, v147, v124
v_mul_f32 v125, v147, v125
v_mul_f32 v126, v147, v126
v_mul_f32 v127, v147, v127
cv 108,108,109
cv 109,110,111
cv 110,124,125
cv 111,126,127
buffer_store_dwordx4 v[108:111], v26, s[20:23], s31 offen sc1
s_cmp_eq_u64 s[100:101], -1
s_cselect_b32 s3, 0, 1
s_barrier
v_mov_b32 v28, s3
s_lshl_b32 s3, s26, 2
v_mov_b32 v29, s3
ds_write_b32 v29, v28
wl 0
s_barrier
v_mov_b32 v29, 0
ds_read_b128 v[32:35], v29
wl 0
v_or3_b32 v32, v32, v33, v34
v_or_b32 v32, v32, v35
s_nop 0
v_readfirstlane_b32 s3, v32
s_nop 3
s_cmp_eq_u32 s3, 0
s_cbranch_scc0 K2_SAFE
K2_DONE:
s_load_dwordx2 s[40:41], s[0:1], 32
s_load_dwordx2 s[42:43], s[0:1], 104
s_load_dwordx2 s[44:45], s[0:1], 0
s_load_dwordx4 s[48:51], s[0:1], 48
s_load_dwordx2 s[52:53], s[0:1], 64
s_load_dwordx2 s[54:55], s[0:1], 88
s_and_b32 s20, s2, 3
s_lshr_b32 s3, s2, 2
s_and_b32 s3, s3, 1
s_lshl_b32 s3, s3, 3
s_lshr_b32 s21, s2, 5
s_add_u32 s21, s21, s3
s_lshr_b32 s22, s2, 3
s_and_b32 s22, s22, 3
s_lshl_b32 s56, s20, 2
s_add_u32 s56, s56, s22
s_mov_b32 s23, s26
s_lshr_b32 s58, s2, 5
s_lshl_b32 s58, s58, 2
s_and_b32 s3, s2, 7
s_lshr_b32 s3, s3, 1
s_add_u32 s58, s58, s3
s_lshl_b32 s58, s58, 7
s_add_u32 s58, s58, 204800
s_lshr_b32 s59, s21, 1
s_lshl_b32 s59, s59, 2
s_add_u32 s59, s59, s20
s_lshl_b32 s59, s59, 7
s_add_u32 s59, s59, 204800
v_add_u32 v10, 0, v0
v_mul_u32_u24 v11, 3277, v10
v_lshrrev_b32 v11, 16, v11
v_mul_u32_u24 v12, 20, v11
v_sub_u32 v12, v10, v12
v_lshrrev_b32 v13, 2, v11
v_and_b32 v13, 1, v13
v_lshlrev_b32 v13, 1, v13
v_xor_b32 v12, v12, v13
v_lshlrev_b32 v12, 4, v12
v_mul_u32_u24 v11, 1280, v11
v_add_u32 v11, v11, v12
v_add_u32 v2, 8192, v11
v_add_u32 v10, 64, v0
v_mul_u32_u24 v11, 3277, v10
v_lshrrev_b32 v11, 16, v11
v_mul_u32_u24 v12, 20, v11
v_sub_u32 v12, v10, v12
v_lshrrev_b32 v13, 2, v11
v_and_b32 v13, 1, v13
v_lshlrev_b32 v13, 1, v13
v_xor_b32 v12, v12, v13
v_lshlrev_b32 v12, 4, v12
v_mul_u32_u24 v11, 1280, v11
v_add_u32 v11, v11, v12
v_add_u32 v3, 7168, v11
v_add_u32 v10, 128, v0
v_mul_u32_u24 v11, 3277, v10
v_lshrrev_b32 v11, 16, v11
v_mul_u32_u24 v12, 20, v11
v_sub_u32 v12, v10, v12
v_lshrrev_b32 v13, 2, v11
v_and_b32 v13, 1, v13
v_lshlrev_b32 v13, 1, v13
v_xor_b32 v12, v12, v13
v_lshlrev_b32 v12, 4, v12
v_mul_u32_u24 v11, 1280, v11
v_add_u32 v11, v11, v12
v_add_u32 v4, 6144, v11
v_add_u32 v10, 192, v0
v_mul_u32_u24 v11, 3277, v10
v_lshrrev_b32 v11, 16, v11
v_mul_u32_u24 v12, 20, v11
v_sub_u32 v12, v10, v12
v_lshrrev_b32 v13, 2, v11
v_and_b32 v13, 1, v13
v_lshlrev_b32 v13, 1, v13
v_xor_b32 v12, v12, v13
v_lshlrev_b32 v12, 4, v12
v_mul_u32_u24 v11, 1280, v11
v_add_u32 v11, v11, v12
v_add_u32 v5, 5120, v11
v_add_u32 v10, 256, v0
v_mul_u32_u24 v11, 3277, v10
v_lshrrev_b32 v11, 16, v11
v_mul_u32_u24 v12, 20, v11
v_sub_u32 v12, v10, v12
v_lshrrev_b32 v13, 2, v11
v_and_b32 v13, 1, v13
v_lshlrev_b32 v13, 1, v13
v_xor_b32 v12, v12, v13
v_lshlrev_b32 v12, 4, v12
v_mul_u32_u24 v11, 1280, v11
v_add_u32 v11, v11, v12
v_add_u32 v6, 8192, v11
s_mul_i32 s3, s23, 20480
v_add_u32 v2, s3, v2
v_add_u32 v3, s3, v3
v_add_u32 v4, s3, v4
v_add_u32 v5, s3, v5
v_add_u32 v6, s3, v6
s_lshl_b32 s3, s21, 3
s_lshl_b32 s24, s23, 1
s_add_u32 s24, s24, s3
s_mul_i32 s3, s24, 196608
s_mul_i32 s25, s20, 49152
s_add_u32 s3, s3, s25
s_add_u32 s3, s3, 4194304
v_lshlrev_b32 v10, 4, v0
v_add_u32 v15, s3, v10
v_add_u32 v16, 196608, v15
s_mul_i32 s26, s23, 5120
s_mul_i32 s27, s20, 1966080
wl 0
s_mul_i32 s3, s22, 320
wl 0
s_add_u32 s8, s40, s3
s_addc_u32 s9, s41, 0
s_sub_u32 s8, s8, 8192
s_subb_u32 s9, s9, 0
s_sub_u32 s10, 7872512, s3
s_mov_b32 s11, 0x20000
s_mov_b32 s12, s42
s_mov_b32 s13, s43
s_mov_b32 s14, 268435456
s_mov_b32 s15, 0x20000
s_add_u32 m0, s26, 0
s_add_u32 s29, s27, 0
dm 2,8,29,0
dm 3,8,29,1024
dm 4,8,29,2048
dm 5,8,29,3072
s_add_u32 m0, s26, 4096
s_nop 0
buffer_load_dwordx4 v6, s[8:11], s29 offen lds
s_lshl_b32 s3, s20, 7
s_add_u32 s3, s3, s24
s_mul_i32 s3, s3, 20480
s_mul_i32 s25, s22, 5120
s_add_u32 s3, s3, s25
s_add_u32 s3, s3, 33554432
v_lshrrev_b32 v10, 4, v0
v_lshrrev_b32 v11, 2, v0
v_and_b32 v11, 3, v11
v_lshlrev_b32 v12, 2, v10
v_add_u32 v11, v11, v12
v_mul_u32_u24 v11, 320, v11
v_and_b32 v12, 3, v0
v_lshlrev_b32 v12, 3, v12
v_add_u32 v11, v11, v12
v_and_b32 v12, 1, v10
v_lshlrev_b32 v12, 5, v12
v_add_u32 v7, v11, v12
v_xor_b32 v12, 32, v12
v_add_u32 v8, v11, v12
v_add_u32 v9, 61440, v7
v_add_u32 v14, 61440, v8
v_lshlrev_b32 v10, 4, v0
v_add_u32 v17, s3, v10
v_add_u32 v18, 20480, v17
s_add_u32 m0, s26, 20480
s_add_u32 s29, s27, 81920
dm 2,8,29,0
dm 3,8,29,1024
dm 4,8,29,2048
dm 5,8,29,3072
s_add_u32 m0, s26, 24576
s_nop 0
buffer_load_dwordx4 v6, s[8:11], s29 offen lds
s_add_u32 m0, s26, 40960
s_add_u32 s29, s27, 163840
dm 2,8,29,0
dm 3,8,29,1024
dm 4,8,29,2048
dm 5,8,29,3072
s_add_u32 m0, s26, 45056
s_nop 0
buffer_load_dwordx4 v6, s[8:11], s29 offen lds
s_mov_b32 s16, s44
s_mov_b32 s17, s45
s_mov_b32 s18, 2621440
s_mov_b32 s19, 0x20000
v_and_b32 v120, 7, v0
v_lshrrev_b32 v121, 4, v0
v_lshrrev_b32 v122, 3, v0
v_and_b32 v122, 1, v122
s_lshl_b32 s30, s21, 3
s_lshr_b32 s3, s56, 1
s_add_u32 s30, s30, s3
s_and_b32 s31, s56, 1
s_mul_i32 s3, s30, 20480
s_lshl_b32 s25, s31, 7
s_add_u32 s3, s3, s25
v_lshlrev_b32 v123, 10, v122
v_lshlrev_b32 v124, 8, v121
v_add_u32 v123, v123, v124
v_lshlrev_b32 v124, 4, v120
v_add_u32 v123, v123, v124
v_add_u32 v123, s3, v123
s_lshl_b32 s36, s23, 11
s_add_u32 s37, s36, 8192
s_and_b32 s38, s23, 1
s_lshl_b32 s38, s38, 11
s_add_u32 s38, s38, 16384
v_add_u32 v125, s36, v123
v_add_u32 v126, s37, v123
v_add_u32 v127, s38, v123
s_lshl_b32 s3, s30, 4
s_lshl_b32 s25, s31, 3
s_add_u32 s3, s3, s25
v_add_u32 v128, s3, v120
v_mul_u32_u24 v128, 1280, v128
v_lshlrev_b32 v124, 6, v122
v_add_u32 v128, v128, v124
v_lshlrev_b32 v124, 3, v121
v_add_u32 v128, v128, v124
s_lshr_b32 s3, s36, 4
v_add_u32 v129, s3, v128
s_lshr_b32 s3, s37, 4
v_add_u32 v130, s3, v128
s_lshr_b32 s3, s38, 4
v_add_u32 v131, s3, v128
buffer_load_dwordx2 v[132:133], v129, s[16:19], 0 offen offset:0
buffer_load_dwordx2 v[134:135], v129, s[16:19], 0 offen offset:32
buffer_load_dwordx2 v[136:137], v130, s[16:19], 0 offen offset:0
buffer_load_dwordx2 v[138:139], v130, s[16:19], 0 offen offset:32
buffer_load_dwordx2 v[140:141], v131, s[16:19], 0 offen offset:0
buffer_load_dwordx2 v[142:143], v131, s[16:19], 0 offen offset:32
s_mov_b32 s32, s52
s_mov_b32 s33, s53
s_mov_b32 s34, 1966080
s_mov_b32 s35, 0x20000
s_lshl_b32 s3, s23, 6
v_add_u32 v144, s3, v0
s_mul_i32 s25, s2, 480
v_add_u32 v145, 0, v144
v_cmp_gt_u32 vcc, 480, v145
v_add_u32 v145, s25, v145
v_lshlrev_b32 v146, 4, v145
v_mov_b32 v147, 0x7ff00000
v_cndmask_b32 v146, v147, v146, vcc
buffer_load_dwordx4 v[160:163], v146, s[32:35], 0 offen
s_mov_b32 s3, 53687092
v_mul_hi_u32 v146, v145, s3
v_mul_u32_u24 v157, 80, v146
v_sub_u32 v157, v145, v157
v_mul_u32_u24 v158, 6554, v157
v_lshrrev_b32 v158, 16, v158
v_mul_u32_u24 v159, 10, v158
v_sub_u32 v159, v157, v159
v_mul_u32_u24 v158, 245760, v158
v_mul_u32_u24 v146, 160, v146
v_lshlrev_b32 v159, 4, v159
v_add_u32 v158, v158, v146
v_add_u32 v158, v158, v159
v_cndmask_b32 v168, v147, v158, vcc
v_add_u32 v145, 256, v144
v_cmp_gt_u32 vcc, 480, v145
v_add_u32 v145, s25, v145
v_lshlrev_b32 v146, 4, v145
v_mov_b32 v147, 0x7ff00000
v_cndmask_b32 v146, v147, v146, vcc
buffer_load_dwordx4 v[164:167], v146, s[32:35], 0 offen
s_mov_b32 s3, 53687092
v_mul_hi_u32 v146, v145, s3
v_mul_u32_u24 v157, 80, v146
v_sub_u32 v157, v145, v157
v_mul_u32_u24 v158, 6554, v157
v_lshrrev_b32 v158, 16, v158
v_mul_u32_u24 v159, 10, v158
v_sub_u32 v159, v157, v159
v_mul_u32_u24 v158, 245760, v158
v_mul_u32_u24 v146, 160, v146
v_lshlrev_b32 v159, 4, v159
v_add_u32 v158, v158, v146
v_add_u32 v158, v158, v159
v_cndmask_b32 v169, v147, v158, vcc
wv 23
s_barrier
s_cmp_lg_u32 s23, 0
s_cbranch_scc1 KT_OB
v_mov_b32 v250, s58
v_mov_b32 v251, 1
s_mov_b64 exec, 1
buffer_atomic_add v251, v250, s[12:15], 0 offen sc1
v_mov_b32 v250, s59
s_mov_b32 s25, 0
KT_OP:
buffer_load_dword v251, v250, s[12:15], 0 offen sc1
wv 0
v_readfirstlane_b32 s3, v251
s_add_u32 s25, s25, 1
s_nop 2
s_cmp_ge_u32 s3, 8
s_cbranch_scc1 KT_OD
s_sleep 1
s_cmp_lt_u32 s25, 16384
s_cbranch_scc1 KT_OP
KT_OD:
s_mov_b64 exec, -1
KT_OB:
wv 18
s_barrier
s_mov_b32 s28, 0
buffer_load_dwordx4 v[68:71], v15, s[12:15], s28 offen sc1
buffer_load_dwordx4 v[72:75], v16, s[12:15], s28 offen sc1
s_mov_b32 s28, 1024
buffer_load_dwordx4 v[76:79], v15, s[12:15], s28 offen sc1
buffer_load_dwordx4 v[80:83], v16, s[12:15], s28 offen sc1
s_mov_b32 s28, 2048
buffer_load_dwordx4 v[84:87], v15, s[12:15], s28 offen sc1
buffer_load_dwordx4 v[88:91], v16, s[12:15], s28 offen sc1
s_mov_b32 s28, 3072
buffer_load_dwordx4 v[92:95], v15, s[12:15], s28 offen sc1
buffer_load_dwordx4 v[96:99], v16, s[12:15], s28 offen sc1
tv 20,7,0
tv 22,7,5120
tv 24,8,0
tv 26,8,5120
tv 28,7,64
tv 30,7,5184
tv 32,8,64
tv 34,8,5184
tv 36,7,128
tv 38,7,5248
tv 40,8,128
tv 42,8,5248
wl 8
wv 6
v_mfma_f32_16x16x32_bf16 v[176:179], v[20:23], v[68:71], 0
s_add_u32 m0, s26, 61440
tv 44,7,192
s_add_u32 s29, s27, 245760
dm 2,8,29,0
v_mfma_f32_16x16x32_bf16 v[180:183], v[20:23], v[72:75], 0
tv 46,7,5312
v_mfma_f32_16x16x32_bf16 v[184:187], v[24:27], v[68:71], 0
tv 48,8,192
v_mfma_f32_16x16x32_bf16 v[188:191], v[24:27], v[72:75], 0
wl 7
tv 50,8,5312
v_mfma_f32_16x16x32_bf16 v[192:195], v[28:31], v[68:71], 0
tv 52,7,256
dm 3,8,29,1024
v_mfma_f32_16x16x32_bf16 v[196:199], v[28:31], v[72:75], 0
tv 54,7,5376
v_mfma_f32_16x16x32_bf16 v[200:203], v[32:35], v[68:71], 0
tv 56,8,256
v_mfma_f32_16x16x32_bf16 v[204:207], v[32:35], v[72:75], 0
wl 7
tv 58,8,5376
v_mfma_f32_16x16x32_bf16 v[208:211], v[36:39], v[68:71], 0
tv 60,7,10240
dm 4,8,29,2048
v_mfma_f32_16x16x32_bf16 v[212:215], v[36:39], v[72:75], 0
tv 62,7,15360
v_mfma_f32_16x16x32_bf16 v[216:219], v[40:43], v[68:71], 0
tv 64,8,10240
v_mfma_f32_16x16x32_bf16 v[220:223], v[40:43], v[72:75], 0
wl 7
tv 66,8,15360
v_mfma_f32_16x16x32_bf16 v[224:227], v[44:47], v[68:71], 0
tv 20,7,10304
dm 5,8,29,3072
v_mfma_f32_16x16x32_bf16 v[228:231], v[44:47], v[72:75], 0
tv 22,7,15424
v_mfma_f32_16x16x32_bf16 v[232:235], v[48:51], v[68:71], 0
tv 24,8,10304
s_add_u32 m0, s26, 65536
v_mfma_f32_16x16x32_bf16 v[236:239], v[48:51], v[72:75], 0
wl 7
tv 26,8,15424
v_mfma_f32_16x16x32_bf16 v[240:243], v[52:55], v[68:71], 0
tv 28,7,10368
buffer_load_dwordx4 v6, s[8:11], s29 offen lds
v_mfma_f32_16x16x32_bf16 v[244:247], v[52:55], v[72:75], 0
tv 30,7,15488
v_mfma_f32_16x16x32_bf16 v[248:251], v[56:59], v[68:71], 0
tv 32,8,10368
s_mov_b32 s28, 4096
v_mfma_f32_16x16x32_bf16 v[252:255], v[56:59], v[72:75], 0
wl 7
wv 9
tv 34,8,15488
xvv 176,60,76
tv 36,7,10432
buffer_load_dwordx4 v[100:103], v15, s[12:15], s28 offen sc1
xvv 180,60,80
tv 38,7,15552
xvv 184,64,76
tv 40,8,10432
xvv 188,64,80
wl 7
tv 42,8,15552
xvv 192,20,76
tv 44,7,10496
buffer_load_dwordx4 v[104:107], v16, s[12:15], s28 offen sc1
xvv 196,20,80
tv 46,7,15616
xvv 200,24,76
tv 48,8,10496
s_add_u32 m0, s26, 81920
xvv 204,24,80
wl 7
tv 50,8,15616
s_barrier
xvv 208,28,76
s_add_u32 s29, s27, 327680
tv 52,7,20480
dm 2,8,29,0
xvv 212,28,80
tv 54,7,25600
xvv 216,32,76
tv 56,8,20480
xvv 220,32,80
wl 7
tv 58,8,25600
xvv 224,36,76
tv 60,7,20544
dm 3,8,29,1024
xvv 228,36,80
tv 62,7,25664
xvv 232,40,76
tv 64,8,20544
xvv 236,40,80
wl 7
tv 66,8,25664
xvv 240,44,76
tv 20,7,20608
dm 4,8,29,2048
xvv 244,44,80
tv 22,7,25728
xvv 248,48,76
tv 24,8,20608
s_mov_b32 s28, 5120
xvv 252,48,80
wl 7
wv 12
tv 26,8,25728
xvv 176,52,84
tv 28,7,20672
buffer_load_dwordx4 v[108:111], v15, s[12:15], s28 offen sc1
xvv 180,52,88
tv 30,7,25792
s_mov_b32 s57, 79691776
xvv 184,56,84
tv 32,8,20672
buffer_store_dwordx4 v[160:163], v168, s[12:15], s57 offen sc1
xvv 188,56,88
wl 7
tv 34,8,25792
xvv 192,60,84
tv 36,7,20736
buffer_load_dwordx4 v[112:115], v16, s[12:15], s28 offen sc1
xvv 196,60,88
tv 38,7,25856
xvv 200,64,84
tv 40,8,20736
xvv 204,64,88
wl 7
tv 42,8,25856
xvv 208,20,84
tv 44,7,30720
dm 5,8,29,3072
xvv 212,20,88
tv 46,7,35840
xvv 216,24,84
tv 48,8,30720
s_add_u32 m0, s26, 86016
xvv 220,24,88
wl 7
tv 50,8,35840
xvv 224,28,84
tv 52,7,30784
buffer_load_dwordx4 v6, s[8:11], s29 offen lds
xvv 228,28,88
tv 54,7,35904
buffer_store_dwordx4 v[164:167], v169, s[12:15], s57 offen sc1
xvv 232,32,84
tv 56,8,30784
xvv 236,32,88
wl 7
tv 58,8,35904
xvv 240,36,84
tv 60,7,30848
xvv 244,36,88
tv 62,7,35968
xvv 248,40,84
tv 64,8,30848
s_mov_b32 s28, 6144
xvv 252,40,88
wl 7
wv 16
tv 66,8,35968
xvv 176,44,92
tv 20,7,30912
buffer_load_dwordx4 v[68:71], v15, s[12:15], s28 offen sc1
xvv 180,44,96
tv 22,7,36032
xvv 184,48,92
tv 24,8,30912
xvv 188,48,96
wl 7
tv 26,8,36032
xvv 192,52,92
tv 28,7,30976
buffer_load_dwordx4 v[72:75], v16, s[12:15], s28 offen sc1
xvv 196,52,96
tv 30,7,36096
xvv 200,56,92
tv 32,8,30976
s_add_u32 m0, s26, 102400
xvv 204,56,96
wl 7
tv 34,8,36096
s_barrier
xvv 208,60,92
s_add_u32 s29, s27, 409600
tv 36,7,40960
dm 2,8,29,0
xvv 212,60,96
tv 38,7,46080
xvv 216,64,92
tv 40,8,40960
xvv 220,64,96
wl 7
tv 42,8,46080
xvv 224,20,92
tv 44,7,41024
dm 3,8,29,1024
xvv 228,20,96
tv 46,7,46144
xvv 232,24,92
tv 48,8,41024
xvv 236,24,96
wl 7
tv 50,8,46144
xvv 240,28,92
tv 52,7,41088
dm 4,8,29,2048
xvv 244,28,96
tv 54,7,46208
xvv 248,32,92
tv 56,8,41088
s_mov_b32 s28, 7168
xvv 252,32,96
wl 7
wv 14
tv 58,8,46208
xvv 176,36,100
tv 60,7,41152
buffer_load_dwordx4 v[76:79], v15, s[12:15], s28 offen sc1
xvv 180,36,104
tv 62,7,46272
xvv 184,40,100
tv 64,8,41152
xvv 188,40,104
wl 7
tv 66,8,46272
xvv 192,44,100
tv 20,7,41216
buffer_load_dwordx4 v[80:83], v16, s[12:15], s28 offen sc1
xvv 196,44,104
tv 22,7,46336
xvv 200,48,100
tv 24,8,41216
xvv 204,48,104
wl 7
tv 26,8,46336
xvv 208,52,100
tv 28,7,51200
dm 5,8,29,3072
xvv 212,52,104
tv 30,7,56320
xvv 216,56,100
tv 32,8,51200
s_add_u32 m0, s26, 106496
xvv 220,56,104
wl 7
tv 34,8,56320
xvv 224,60,100
tv 36,7,51264
buffer_load_dwordx4 v6, s[8:11], s29 offen lds
xvv 228,60,104
tv 38,7,56384
xvv 232,64,100
tv 40,8,51264
xvv 236,64,104
wl 7
tv 42,8,56384
xvv 240,20,100
tv 44,7,51328
xvv 244,20,104
tv 46,7,56448
xvv 248,24,100
tv 48,8,51328
s_mov_b32 s28, 8192
xvv 252,24,104
wl 7
wv 12
tv 50,8,56448
xvv 176,28,108
tv 52,7,51392
buffer_load_dwordx4 v[84:87], v15, s[12:15], s28 offen sc1
xvv 180,28,112
tv 54,7,56512
xvv 184,32,108
tv 56,8,51392
xvv 188,32,112
wl 7
tv 58,8,56512
xvv 192,36,108
tv 60,7,51456
buffer_load_dwordx4 v[88:91], v16, s[12:15], s28 offen sc1
xvv 196,36,112
tv 62,7,56576
xvv 200,40,108
tv 64,8,51456
s_add_u32 m0, s26, 0
xvv 204,40,112
wl 7
tv 66,8,56576
s_barrier
xvv 208,44,108
s_add_u32 s29, s27, 491520
tv 20,9,0
dm 2,8,29,0
xvv 212,44,112
tv 22,9,5120
xvv 216,48,108
tv 24,14,0
xvv 220,48,112
wl 7
tv 26,14,5120
xvv 224,52,108
tv 28,9,64
dm 3,8,29,1024
xvv 228,52,112
tv 30,9,5184
xvv 232,56,108
tv 32,14,64
xvv 236,56,112
wl 7
tv 34,14,5184
xvv 240,60,108
tv 36,9,128
dm 4,8,29,2048
xvv 244,60,112
tv 38,9,5248
xvv 248,64,108
tv 40,14,128
s_mov_b32 s28, 9216
xvv 252,64,112
wl 7
wv 12
tv 42,14,5248
xvv 176,20,68
tv 44,9,192
buffer_load_dwordx4 v[92:95], v15, s[12:15], s28 offen sc1
xvv 180,20,72
tv 46,9,5312
xvv 184,24,68
tv 48,14,192
xvv 188,24,72
wl 7
tv 50,14,5312
xvv 192,28,68
tv 52,9,256
buffer_load_dwordx4 v[96:99], v16, s[12:15], s28 offen sc1
xvv 196,28,72
tv 54,9,5376
xvv 200,32,68
tv 56,14,256
xvv 204,32,72
wl 7
tv 58,14,5376
xvv 208,36,68
tv 60,9,10240
dm 5,8,29,3072
xvv 212,36,72
tv 62,9,15360
xvv 216,40,68
tv 64,14,10240
s_add_u32 m0, s26, 4096
xvv 220,40,72
wl 7
tv 66,14,15360
xvv 224,44,68
tv 20,9,10304
buffer_load_dwordx4 v6, s[8:11], s29 offen lds
xvv 228,44,72
tv 22,9,15424
xvv 232,48,68
tv 24,14,10304
xvv 236,48,72
wl 7
tv 26,14,15424
xvv 240,52,68
tv 28,9,10368
xvv 244,52,72
tv 30,9,15488
xvv 248,56,68
tv 32,14,10368
s_mov_b32 s28, 10240
xvv 252,56,72
wl 7
wv 11
tv 34,14,15488
xvv 176,60,76
tv 36,9,10432
buffer_load_dwordx4 v[100:103], v15, s[12:15], s28 offen sc1
xvv 180,60,80
tv 38,9,15552
xvv 184,64,76
tv 40,14,10432
xvv 188,64,80
wl 7
tv 42,14,15552
xvv 192,20,76
tv 44,9,10496
buffer_load_dwordx4 v[104:107], v16, s[12:15], s28 offen sc1
xvv 196,20,80
tv 46,9,15616
xvv 200,24,76
tv 48,14,10496
s_add_u32 m0, s26, 20480
xvv 204,24,80
wl 7
tv 50,14,15616
s_barrier
xvv 208,28,76
s_add_u32 s29, s27, 573440
tv 52,9,20480
dm 2,8,29,0
xvv 212,28,80
tv 54,9,25600
xvv 216,32,76
tv 56,14,20480
xvv 220,32,80
wl 7
tv 58,14,25600
xvv 224,36,76
tv 60,9,20544
dm 3,8,29,1024
xvv 228,36,80
tv 62,9,25664
xvv 232,40,76
tv 64,14,20544
xvv 236,40,80
wl 7
tv 66,14,25664
xvv 240,44,76
tv 20,9,20608
dm 4,8,29,2048
xvv 244,44,80
tv 22,9,25728
xvv 248,48,76
tv 24,14,20608
s_mov_b32 s28, 11264
xvv 252,48,80
wl 7
wv 12
tv 26,14,25728
xvv 176,52,84
tv 28,9,20672
buffer_load_dwordx4 v[108:111], v15, s[12:15], s28 offen sc1
xvv 180,52,88
tv 30,9,25792
xvv 184,56,84
tv 32,14,20672
xvv 188,56,88
wl 7
tv 34,14,25792
xvv 192,60,84
tv 36,9,20736
buffer_load_dwordx4 v[112:115], v16, s[12:15], s28 offen sc1
xvv 196,60,88
tv 38,9,25856
xvv 200,64,84
tv 40,14,20736
xvv 204,64,88
wl 7
tv 42,14,25856
xvv 208,20,84
tv 44,9,30720
dm 5,8,29,3072
xvv 212,20,88
tv 46,9,35840
xvv 216,24,84
tv 48,14,30720
s_add_u32 m0, s26, 24576
xvv 220,24,88
wl 7
tv 50,14,35840
xvv 224,28,84
tv 52,9,30784
buffer_load_dwordx4 v6, s[8:11], s29 offen lds
xvv 228,28,88
tv 54,9,35904
xvv 232,32,84
tv 56,14,30784
xvv 236,32,88
wl 7
tv 58,14,35904
xvv 240,36,84
tv 60,9,30848
xvv 244,36,88
tv 62,9,35968
xvv 248,40,84
tv 64,14,30848
s_mov_b32 s28, 12288
xvv 252,40,88
wl 7
wv 11
tv 66,14,35968
xvv 176,44,92
tv 20,9,30912
buffer_load_dwordx4 v[68:71], v15, s[12:15], s28 offen sc1
xvv 180,44,96
tv 22,9,36032
xvv 184,48,92
tv 24,14,30912
xvv 188,48,96
wl 7
tv 26,14,36032
xvv 192,52,92
tv 28,9,30976
buffer_load_dwordx4 v[72:75], v16, s[12:15], s28 offen sc1
xvv 196,52,96
tv 30,9,36096
xvv 200,56,92
tv 32,14,30976
s_add_u32 m0, s26, 40960
xvv 204,56,96
wl 7
tv 34,14,36096
s_barrier
xvv 208,60,92
s_add_u32 s29, s27, 655360
tv 36,9,40960
dm 2,8,29,0
xvv 212,60,96
tv 38,9,46080
xvv 216,64,92
tv 40,14,40960
xvv 220,64,96
wl 7
tv 42,14,46080
xvv 224,20,92
tv 44,9,41024
dm 3,8,29,1024
xvv 228,20,96
tv 46,9,46144
xvv 232,24,92
tv 48,14,41024
xvv 236,24,96
wl 7
tv 50,14,46144
xvv 240,28,92
tv 52,9,41088
dm 4,8,29,2048
xvv 244,28,96
tv 54,9,46208
xvv 248,32,92
tv 56,14,41088
s_mov_b32 s28, 13312
xvv 252,32,96
wl 7
wv 12
tv 58,14,46208
xvv 176,36,100
tv 60,9,41152
buffer_load_dwordx4 v[76:79], v15, s[12:15], s28 offen sc1
xvv 180,36,104
tv 62,9,46272
xvv 184,40,100
tv 64,14,41152
xvv 188,40,104
wl 7
tv 66,14,46272
xvv 192,44,100
tv 20,9,41216
buffer_load_dwordx4 v[80:83], v16, s[12:15], s28 offen sc1
xvv 196,44,104
tv 22,9,46336
xvv 200,48,100
tv 24,14,41216
xvv 204,48,104
wl 7
tv 26,14,46336
xvv 208,52,100
tv 28,9,51200
dm 5,8,29,3072
xvv 212,52,104
tv 30,9,56320
xvv 216,56,100
tv 32,14,51200
s_add_u32 m0, s26, 45056
xvv 220,56,104
wl 7
tv 34,14,56320
xvv 224,60,100
tv 36,9,51264
buffer_load_dwordx4 v6, s[8:11], s29 offen lds
xvv 228,60,104
tv 38,9,56384
xvv 232,64,100
tv 40,14,51264
xvv 236,64,104
wl 7
tv 42,14,56384
xvv 240,20,100
tv 44,9,51328
xvv 244,20,104
tv 46,9,56448
xvv 248,24,100
tv 48,14,51328
s_mov_b32 s28, 14336
xvv 252,24,104
wl 7
wv 11
tv 50,14,56448
xvv 176,28,108
tv 52,9,51392
buffer_load_dwordx4 v[84:87], v15, s[12:15], s28 offen sc1
xvv 180,28,112
tv 54,9,56512
xvv 184,32,108
tv 56,14,51392
xvv 188,32,112
wl 7
tv 58,14,56512
xvv 192,36,108
tv 60,9,51456
buffer_load_dwordx4 v[88:91], v16, s[12:15], s28 offen sc1
xvv 196,36,112
tv 62,9,56576
xvv 200,40,108
tv 64,14,51456
s_add_u32 m0, s26, 61440
xvv 204,40,112
wl 7
tv 66,14,56576
s_barrier
xvv 208,44,108
s_add_u32 s29, s27, 737280
tv 20,7,0
dm 2,8,29,0
xvv 212,44,112
tv 22,7,5120
xvv 216,48,108
tv 24,8,0
xvv 220,48,112
wl 7
tv 26,8,5120
xvv 224,52,108
tv 28,7,64
dm 3,8,29,1024
xvv 228,52,112
tv 30,7,5184
xvv 232,56,108
tv 32,8,64
xvv 236,56,112
wl 7
tv 34,8,5184
xvv 240,60,108
tv 36,7,128
dm 4,8,29,2048
xvv 244,60,112
tv 38,7,5248
xvv 248,64,108
tv 40,8,128
s_mov_b32 s28, 15360
xvv 252,64,112
wl 7
wv 12
tv 42,8,5248
xvv 176,20,68
tv 44,7,192
buffer_load_dwordx4 v[92:95], v15, s[12:15], s28 offen sc1
xvv 180,20,72
tv 46,7,5312
xvv 184,24,68
tv 48,8,192
xvv 188,24,72
wl 7
tv 50,8,5312
xvv 192,28,68
tv 52,7,256
buffer_load_dwordx4 v[96:99], v16, s[12:15], s28 offen sc1
xvv 196,28,72
tv 54,7,5376
xvv 200,32,68
tv 56,8,256
xvv 204,32,72
wl 7
tv 58,8,5376
xvv 208,36,68
tv 60,7,10240
dm 5,8,29,3072
xvv 212,36,72
tv 62,7,15360
xvv 216,40,68
tv 64,8,10240
s_add_u32 m0, s26, 65536
xvv 220,40,72
wl 7
tv 66,8,15360
xvv 224,44,68
tv 20,7,10304
buffer_load_dwordx4 v6, s[8:11], s29 offen lds
xvv 228,44,72
tv 22,7,15424
xvv 232,48,68
tv 24,8,10304
xvv 236,48,72
wl 7
tv 26,8,15424
xvv 240,52,68
tv 28,7,10368
xvv 244,52,72
tv 30,7,15488
xvv 248,56,68
tv 32,8,10368
s_mov_b32 s28, 16384
xvv 252,56,72
wl 7
wv 11
tv 34,8,15488
xvv 176,60,76
tv 36,7,10432
buffer_load_dwordx4 v[100:103], v15, s[12:15], s28 offen sc1
xvv 180,60,80
tv 38,7,15552
xvv 184,64,76
tv 40,8,10432
xvv 188,64,80
wl 7
tv 42,8,15552
xvv 192,20,76
tv 44,7,10496
buffer_load_dwordx4 v[104:107], v16, s[12:15], s28 offen sc1
xvv 196,20,80
tv 46,7,15616
xvv 200,24,76
tv 48,8,10496
s_add_u32 m0, s26, 81920
xvv 204,24,80
wl 7
tv 50,8,15616
s_barrier
xvv 208,28,76
s_add_u32 s29, s27, 819200
tv 52,7,20480
dm 2,8,29,0
xvv 212,28,80
tv 54,7,25600
xvv 216,32,76
tv 56,8,20480
xvv 220,32,80
wl 7
tv 58,8,25600
xvv 224,36,76
tv 60,7,20544
dm 3,8,29,1024
xvv 228,36,80
tv 62,7,25664
xvv 232,40,76
tv 64,8,20544
xvv 236,40,80
wl 7
tv 66,8,25664
xvv 240,44,76
tv 20,7,20608
dm 4,8,29,2048
xvv 244,44,80
tv 22,7,25728
xvv 248,48,76
tv 24,8,20608
s_mov_b32 s28, 17408
xvv 252,48,80
wl 7
wv 12
tv 26,8,25728
xvv 176,52,84
tv 28,7,20672
buffer_load_dwordx4 v[108:111], v15, s[12:15], s28 offen sc1
xvv 180,52,88
tv 30,7,25792
xvv 184,56,84
tv 32,8,20672
xvv 188,56,88
wl 7
tv 34,8,25792
xvv 192,60,84
tv 36,7,20736
buffer_load_dwordx4 v[112:115], v16, s[12:15], s28 offen sc1
xvv 196,60,88
tv 38,7,25856
xvv 200,64,84
tv 40,8,20736
xvv 204,64,88
wl 7
tv 42,8,25856
xvv 208,20,84
tv 44,7,30720
dm 5,8,29,3072
xvv 212,20,88
tv 46,7,35840
xvv 216,24,84
tv 48,8,30720
s_add_u32 m0, s26, 86016
xvv 220,24,88
wl 7
tv 50,8,35840
xvv 224,28,84
tv 52,7,30784
buffer_load_dwordx4 v6, s[8:11], s29 offen lds
xvv 228,28,88
tv 54,7,35904
xvv 232,32,84
tv 56,8,30784
xvv 236,32,88
wl 7
tv 58,8,35904
xvv 240,36,84
tv 60,7,30848
xvv 244,36,88
tv 62,7,35968
xvv 248,40,84
tv 64,8,30848
s_mov_b32 s28, 18432
xvv 252,40,88
wl 7
wv 11
tv 66,8,35968
xvv 176,44,92
tv 20,7,30912
buffer_load_dwordx4 v[68:71], v15, s[12:15], s28 offen sc1
xvv 180,44,96
tv 22,7,36032
xvv 184,48,92
tv 24,8,30912
xvv 188,48,96
wl 7
tv 26,8,36032
xvv 192,52,92
tv 28,7,30976
buffer_load_dwordx4 v[72:75], v16, s[12:15], s28 offen sc1
xvv 196,52,96
tv 30,7,36096
xvv 200,56,92
tv 32,8,30976
s_add_u32 m0, s26, 102400
xvv 204,56,96
wl 7
tv 34,8,36096
s_barrier
xvv 208,60,92
s_add_u32 s29, s27, 901120
tv 36,7,40960
dm 2,8,29,0
xvv 212,60,96
tv 38,7,46080
xvv 216,64,92
tv 40,8,40960
xvv 220,64,96
wl 7
tv 42,8,46080
xvv 224,20,92
tv 44,7,41024
dm 3,8,29,1024
xvv 228,20,96
tv 46,7,46144
xvv 232,24,92
tv 48,8,41024
xvv 236,24,96
wl 7
tv 50,8,46144
xvv 240,28,92
tv 52,7,41088
dm 4,8,29,2048
xvv 244,28,96
tv 54,7,46208
xvv 248,32,92
tv 56,8,41088
s_mov_b32 s28, 19456
xvv 252,32,96
wl 7
wv 12
tv 58,8,46208
xvv 176,36,100
tv 60,7,41152
buffer_load_dwordx4 v[76:79], v15, s[12:15], s28 offen sc1
xvv 180,36,104
tv 62,7,46272
xvv 184,40,100
tv 64,8,41152
xvv 188,40,104
wl 7
tv 66,8,46272
xvv 192,44,100
tv 20,7,41216
buffer_load_dwordx4 v[80:83], v16, s[12:15], s28 offen sc1
xvv 196,44,104
tv 22,7,46336
xvv 200,48,100
tv 24,8,41216
xvv 204,48,104
wl 7
tv 26,8,46336
xvv 208,52,100
tv 28,7,51200
dm 5,8,29,3072
xvv 212,52,104
tv 30,7,56320
xvv 216,56,100
tv 32,8,51200
s_add_u32 m0, s26, 106496
xvv 220,56,104
wl 7
tv 34,8,56320
xvv 224,60,100
tv 36,7,51264
buffer_load_dwordx4 v6, s[8:11], s29 offen lds
xvv 228,60,104
tv 38,7,56384
xvv 232,64,100
tv 40,8,51264
xvv 236,64,104
wl 7
tv 42,8,56384
xvv 240,20,100
tv 44,7,51328
xvv 244,20,104
tv 46,7,56448
xvv 248,24,100
tv 48,8,51328
s_mov_b32 s28, 20480
xvv 252,24,104
wl 7
wv 11
tv 50,8,56448
xvv 176,28,108
tv 52,7,51392
buffer_load_dwordx4 v[84:87], v15, s[12:15], s28 offen sc1
xvv 180,28,112
tv 54,7,56512
xvv 184,32,108
tv 56,8,51392
xvv 188,32,112
wl 7
tv 58,8,56512
xvv 192,36,108
tv 60,7,51456
buffer_load_dwordx4 v[88:91], v16, s[12:15], s28 offen sc1
xvv 196,36,112
tv 62,7,56576
xvv 200,40,108
tv 64,8,51456
s_add_u32 m0, s26, 0
xvv 204,40,112
wl 7
tv 66,8,56576
s_barrier
xvv 208,44,108
s_add_u32 s29, s27, 983040
tv 20,9,0
dm 2,8,29,0
xvv 212,44,112
tv 22,9,5120
xvv 216,48,108
tv 24,14,0
xvv 220,48,112
wl 7
tv 26,14,5120
xvv 224,52,108
tv 28,9,64
dm 3,8,29,1024
xvv 228,52,112
tv 30,9,5184
xvv 232,56,108
tv 32,14,64
xvv 236,56,112
wl 7
tv 34,14,5184
xvv 240,60,108
tv 36,9,128
dm 4,8,29,2048
xvv 244,60,112
tv 38,9,5248
xvv 248,64,108
tv 40,14,128
s_mov_b32 s28, 21504
xvv 252,64,112
wl 7
wv 12
tv 42,14,5248
xvv 176,20,68
tv 44,9,192
buffer_load_dwordx4 v[92:95], v15, s[12:15], s28 offen sc1
xvv 180,20,72
tv 46,9,5312
xvv 184,24,68
tv 48,14,192
xvv 188,24,72
wl 7
tv 50,14,5312
xvv 192,28,68
tv 52,9,256
buffer_load_dwordx4 v[96:99], v16, s[12:15], s28 offen sc1
xvv 196,28,72
tv 54,9,5376
xvv 200,32,68
tv 56,14,256
xvv 204,32,72
wl 7
tv 58,14,5376
xvv 208,36,68
tv 60,9,10240
dm 5,8,29,3072
xvv 212,36,72
tv 62,9,15360
xvv 216,40,68
tv 64,14,10240
s_add_u32 m0, s26, 4096
xvv 220,40,72
wl 7
tv 66,14,15360
xvv 224,44,68
tv 20,9,10304
buffer_load_dwordx4 v6, s[8:11], s29 offen lds
xvv 228,44,72
tv 22,9,15424
xvv 232,48,68
tv 24,14,10304
xvv 236,48,72
wl 7
tv 26,14,15424
xvv 240,52,68
tv 28,9,10368
xvv 244,52,72
tv 30,9,15488
xvv 248,56,68
tv 32,14,10368
s_mov_b32 s28, 22528
xvv 252,56,72
wl 7
wv 11
tv 34,14,15488
xvv 176,60,76
tv 36,9,10432
buffer_load_dwordx4 v[100:103], v15, s[12:15], s28 offen sc1
xvv 180,60,80
tv 38,9,15552
xvv 184,64,76
tv 40,14,10432
xvv 188,64,80
wl 7
tv 42,14,15552
xvv 192,20,76
tv 44,9,10496
buffer_load_dwordx4 v[104:107], v16, s[12:15], s28 offen sc1
xvv 196,20,80
tv 46,9,15616
xvv 200,24,76
tv 48,14,10496
s_add_u32 m0, s26, 20480
xvv 204,24,80
wl 7
tv 50,14,15616
s_barrier
xvv 208,28,76
s_add_u32 s29, s27, 1064960
tv 52,9,20480
dm 2,8,29,0
xvv 212,28,80
tv 54,9,25600
xvv 216,32,76
tv 56,14,20480
xvv 220,32,80
wl 7
tv 58,14,25600
xvv 224,36,76
tv 60,9,20544
dm 3,8,29,1024
xvv 228,36,80
tv 62,9,25664
xvv 232,40,76
tv 64,14,20544
xvv 236,40,80
wl 7
tv 66,14,25664
xvv 240,44,76
tv 20,9,20608
dm 4,8,29,2048
xvv 244,44,80
tv 22,9,25728
xvv 248,48,76
tv 24,14,20608
s_mov_b32 s28, 23552
xvv 252,48,80
wl 7
wv 12
tv 26,14,25728
xvv 176,52,84
tv 28,9,20672
buffer_load_dwordx4 v[108:111], v15, s[12:15], s28 offen sc1
xvv 180,52,88
tv 30,9,25792
xvv 184,56,84
tv 32,14,20672
xvv 188,56,88
wl 7
tv 34,14,25792
xvv 192,60,84
tv 36,9,20736
buffer_load_dwordx4 v[112:115], v16, s[12:15], s28 offen sc1
xvv 196,60,88
tv 38,9,25856
xvv 200,64,84
tv 40,14,20736
xvv 204,64,88
wl 7
tv 42,14,25856
xvv 208,20,84
tv 44,9,30720
dm 5,8,29,3072
xvv 212,20,88
tv 46,9,35840
xvv 216,24,84
tv 48,14,30720
s_add_u32 m0, s26, 24576
xvv 220,24,88
wl 7
tv 50,14,35840
xvv 224,28,84
tv 52,9,30784
buffer_load_dwordx4 v6, s[8:11], s29 offen lds
xvv 228,28,88
tv 54,9,35904
xvv 232,32,84
tv 56,14,30784
xvv 236,32,88
wl 7
tv 58,14,35904
xvv 240,36,84
tv 60,9,30848
xvv 244,36,88
tv 62,9,35968
xvv 248,40,84
tv 64,14,30848
s_mov_b32 s28, 24576
xvv 252,40,88
wl 7
wv 11
tv 66,14,35968
xvv 176,44,92
tv 20,9,30912
buffer_load_dwordx4 v[68:71], v15, s[12:15], s28 offen sc1
xvv 180,44,96
tv 22,9,36032
xvv 184,48,92
tv 24,14,30912
xvv 188,48,96
wl 7
tv 26,14,36032
xvv 192,52,92
tv 28,9,30976
buffer_load_dwordx4 v[72:75], v16, s[12:15], s28 offen sc1
xvv 196,52,96
tv 30,9,36096
xvv 200,56,92
tv 32,14,30976
s_add_u32 m0, s26, 40960
xvv 204,56,96
wl 7
tv 34,14,36096
s_barrier
xvv 208,60,92
s_add_u32 s29, s27, 1146880
tv 36,9,40960
dm 2,8,29,0
xvv 212,60,96
tv 38,9,46080
xvv 216,64,92
tv 40,14,40960
xvv 220,64,96
wl 7
tv 42,14,46080
xvv 224,20,92
tv 44,9,41024
dm 3,8,29,1024
xvv 228,20,96
tv 46,9,46144
xvv 232,24,92
tv 48,14,41024
xvv 236,24,96
wl 7
tv 50,14,46144
xvv 240,28,92
tv 52,9,41088
dm 4,8,29,2048
xvv 244,28,96
tv 54,9,46208
xvv 248,32,92
tv 56,14,41088
s_mov_b32 s28, 25600
xvv 252,32,96
wl 7
wv 12
tv 58,14,46208
xvv 176,36,100
tv 60,9,41152
buffer_load_dwordx4 v[76:79], v15, s[12:15], s28 offen sc1
xvv 180,36,104
tv 62,9,46272
xvv 184,40,100
tv 64,14,41152
xvv 188,40,104
wl 7
tv 66,14,46272
xvv 192,44,100
tv 20,9,41216
buffer_load_dwordx4 v[80:83], v16, s[12:15], s28 offen sc1
xvv 196,44,104
tv 22,9,46336
xvv 200,48,100
tv 24,14,41216
xvv 204,48,104
wl 7
tv 26,14,46336
xvv 208,52,100
tv 28,9,51200
dm 5,8,29,3072
xvv 212,52,104
tv 30,9,56320
xvv 216,56,100
tv 32,14,51200
s_add_u32 m0, s26, 45056
xvv 220,56,104
wl 7
tv 34,14,56320
xvv 224,60,100
tv 36,9,51264
buffer_load_dwordx4 v6, s[8:11], s29 offen lds
xvv 228,60,104
tv 38,9,56384
xvv 232,64,100
tv 40,14,51264
xvv 236,64,104
wl 7
tv 42,14,56384
xvv 240,20,100
tv 44,9,51328
xvv 244,20,104
tv 46,9,56448
xvv 248,24,100
tv 48,14,51328
s_mov_b32 s28, 26624
xvv 252,24,104
wl 7
wv 11
tv 50,14,56448
xvv 176,28,108
tv 52,9,51392
buffer_load_dwordx4 v[84:87], v15, s[12:15], s28 offen sc1
xvv 180,28,112
tv 54,9,56512
xvv 184,32,108
tv 56,14,51392
xvv 188,32,112
wl 7
tv 58,14,56512
xvv 192,36,108
tv 60,9,51456
buffer_load_dwordx4 v[88:91], v16, s[12:15], s28 offen sc1
xvv 196,36,112
tv 62,9,56576
xvv 200,40,108
tv 64,14,51456
s_add_u32 m0, s26, 61440
xvv 204,40,112
wl 7
tv 66,14,56576
s_barrier
xvv 208,44,108
s_add_u32 s29, s27, 1228800
tv 20,7,0
dm 2,8,29,0
xvv 212,44,112
tv 22,7,5120
xvv 216,48,108
tv 24,8,0
xvv 220,48,112
wl 7
tv 26,8,5120
xvv 224,52,108
tv 28,7,64
dm 3,8,29,1024
xvv 228,52,112
tv 30,7,5184
xvv 232,56,108
tv 32,8,64
xvv 236,56,112
wl 7
tv 34,8,5184
xvv 240,60,108
tv 36,7,128
dm 4,8,29,2048
xvv 244,60,112
tv 38,7,5248
xvv 248,64,108
tv 40,8,128
s_mov_b32 s28, 27648
xvv 252,64,112
wl 7
wv 12
tv 42,8,5248
xvv 176,20,68
tv 44,7,192
buffer_load_dwordx4 v[92:95], v15, s[12:15], s28 offen sc1
xvv 180,20,72
tv 46,7,5312
xvv 184,24,68
tv 48,8,192
xvv 188,24,72
wl 7
tv 50,8,5312
xvv 192,28,68
tv 52,7,256
buffer_load_dwordx4 v[96:99], v16, s[12:15], s28 offen sc1
xvv 196,28,72
tv 54,7,5376
xvv 200,32,68
tv 56,8,256
xvv 204,32,72
wl 7
tv 58,8,5376
xvv 208,36,68
tv 60,7,10240
dm 5,8,29,3072
xvv 212,36,72
tv 62,7,15360
xvv 216,40,68
tv 64,8,10240
s_add_u32 m0, s26, 65536
xvv 220,40,72
wl 7
tv 66,8,15360
xvv 224,44,68
tv 20,7,10304
buffer_load_dwordx4 v6, s[8:11], s29 offen lds
xvv 228,44,72
tv 22,7,15424
xvv 232,48,68
tv 24,8,10304
xvv 236,48,72
wl 7
tv 26,8,15424
xvv 240,52,68
tv 28,7,10368
xvv 244,52,72
tv 30,7,15488
xvv 248,56,68
tv 32,8,10368
s_mov_b32 s28, 28672
xvv 252,56,72
wl 7
wv 11
tv 34,8,15488
xvv 176,60,76
tv 36,7,10432
buffer_load_dwordx4 v[100:103], v15, s[12:15], s28 offen sc1
xvv 180,60,80
tv 38,7,15552
xvv 184,64,76
tv 40,8,10432
xvv 188,64,80
wl 7
tv 42,8,15552
xvv 192,20,76
tv 44,7,10496
buffer_load_dwordx4 v[104:107], v16, s[12:15], s28 offen sc1
xvv 196,20,80
tv 46,7,15616
xvv 200,24,76
tv 48,8,10496
s_add_u32 m0, s26, 81920
xvv 204,24,80
wl 7
tv 50,8,15616
s_barrier
xvv 208,28,76
s_add_u32 s29, s27, 1310720
tv 52,7,20480
dm 2,8,29,0
xvv 212,28,80
tv 54,7,25600
xvv 216,32,76
tv 56,8,20480
xvv 220,32,80
wl 7
tv 58,8,25600
xvv 224,36,76
tv 60,7,20544
dm 3,8,29,1024
xvv 228,36,80
tv 62,7,25664
xvv 232,40,76
tv 64,8,20544
xvv 236,40,80
wl 7
tv 66,8,25664
xvv 240,44,76
tv 20,7,20608
dm 4,8,29,2048
xvv 244,44,80
tv 22,7,25728
xvv 248,48,76
tv 24,8,20608
s_mov_b32 s28, 29696
xvv 252,48,80
wl 7
wv 12
tv 26,8,25728
xvv 176,52,84
tv 28,7,20672
buffer_load_dwordx4 v[108:111], v15, s[12:15], s28 offen sc1
xvv 180,52,88
tv 30,7,25792
xvv 184,56,84
tv 32,8,20672
xvv 188,56,88
wl 7
tv 34,8,25792
xvv 192,60,84
tv 36,7,20736
buffer_load_dwordx4 v[112:115], v16, s[12:15], s28 offen sc1
xvv 196,60,88
tv 38,7,25856
xvv 200,64,84
tv 40,8,20736
xvv 204,64,88
wl 7
tv 42,8,25856
xvv 208,20,84
tv 44,7,30720
dm 5,8,29,3072
xvv 212,20,88
tv 46,7,35840
xvv 216,24,84
tv 48,8,30720
s_add_u32 m0, s26, 86016
xvv 220,24,88
wl 7
tv 50,8,35840
xvv 224,28,84
tv 52,7,30784
buffer_load_dwordx4 v6, s[8:11], s29 offen lds
xvv 228,28,88
tv 54,7,35904
xvv 232,32,84
tv 56,8,30784
xvv 236,32,88
wl 7
tv 58,8,35904
xvv 240,36,84
tv 60,7,30848
xvv 244,36,88
tv 62,7,35968
xvv 248,40,84
tv 64,8,30848
s_mov_b32 s28, 30720
xvv 252,40,88
wl 7
wv 11
tv 66,8,35968
xvv 176,44,92
tv 20,7,30912
buffer_load_dwordx4 v[68:71], v15, s[12:15], s28 offen sc1
xvv 180,44,96
tv 22,7,36032
xvv 184,48,92
tv 24,8,30912
xvv 188,48,96
wl 7
tv 26,8,36032
xvv 192,52,92
tv 28,7,30976
buffer_load_dwordx4 v[72:75], v16, s[12:15], s28 offen sc1
xvv 196,52,96
tv 30,7,36096
xvv 200,56,92
tv 32,8,30976
s_add_u32 m0, s26, 102400
xvv 204,56,96
wl 7
tv 34,8,36096
s_barrier
xvv 208,60,92
s_add_u32 s29, s27, 1392640
tv 36,7,40960
dm 2,8,29,0
xvv 212,60,96
tv 38,7,46080
xvv 216,64,92
tv 40,8,40960
xvv 220,64,96
wl 7
tv 42,8,46080
xvv 224,20,92
tv 44,7,41024
dm 3,8,29,1024
xvv 228,20,96
tv 46,7,46144
xvv 232,24,92
tv 48,8,41024
xvv 236,24,96
wl 7
tv 50,8,46144
xvv 240,28,92
tv 52,7,41088
dm 4,8,29,2048
xvv 244,28,96
tv 54,7,46208
xvv 248,32,92
tv 56,8,41088
s_mov_b32 s28, 31744
xvv 252,32,96
wl 7
wv 12
tv 58,8,46208
xvv 176,36,100
tv 60,7,41152
buffer_load_dwordx4 v[76:79], v15, s[12:15], s28 offen sc1
xvv 180,36,104
tv 62,7,46272
xvv 184,40,100
tv 64,8,41152
xvv 188,40,104
wl 7
tv 66,8,46272
xvv 192,44,100
tv 20,7,41216
buffer_load_dwordx4 v[80:83], v16, s[12:15], s28 offen sc1
xvv 196,44,104
tv 22,7,46336
xvv 200,48,100
tv 24,8,41216
xvv 204,48,104
wl 7
tv 26,8,46336
xvv 208,52,100
tv 28,7,51200
dm 5,8,29,3072
xvv 212,52,104
tv 30,7,56320
xvv 216,56,100
tv 32,8,51200
s_add_u32 m0, s26, 106496
xvv 220,56,104
wl 7
tv 34,8,56320
xvv 224,60,100
tv 36,7,51264
buffer_load_dwordx4 v6, s[8:11], s29 offen lds
xvv 228,60,104
tv 38,7,56384
xvv 232,64,100
tv 40,8,51264
xvv 236,64,104
wl 7
tv 42,8,56384
xvv 240,20,100
tv 44,7,51328
xvv 244,20,104
tv 46,7,56448
xvv 248,24,100
tv 48,8,51328
s_mov_b32 s28, 32768
xvv 252,24,104
wl 7
wv 11
tv 50,8,56448
xvv 176,28,108
tv 52,7,51392
buffer_load_dwordx4 v[84:87], v15, s[12:15], s28 offen sc1
xvv 180,28,112
tv 54,7,56512
xvv 184,32,108
tv 56,8,51392
xvv 188,32,112
wl 7
tv 58,8,56512
xvv 192,36,108
tv 60,7,51456
buffer_load_dwordx4 v[88:91], v16, s[12:15], s28 offen sc1
xvv 196,36,112
tv 62,7,56576
xvv 200,40,108
tv 64,8,51456
s_add_u32 m0, s26, 0
xvv 204,40,112
wl 7
tv 66,8,56576
s_barrier
xvv 208,44,108
s_add_u32 s29, s27, 1474560
tv 20,9,0
dm 2,8,29,0
xvv 212,44,112
tv 22,9,5120
xvv 216,48,108
tv 24,14,0
xvv 220,48,112
wl 7
tv 26,14,5120
xvv 224,52,108
tv 28,9,64
dm 3,8,29,1024
xvv 228,52,112
tv 30,9,5184
xvv 232,56,108
tv 32,14,64
xvv 236,56,112
wl 7
tv 34,14,5184
xvv 240,60,108
tv 36,9,128
dm 4,8,29,2048
xvv 244,60,112
tv 38,9,5248
xvv 248,64,108
tv 40,14,128
s_mov_b32 s28, 33792
xvv 252,64,112
wl 7
wv 12
tv 42,14,5248
xvv 176,20,68
tv 44,9,192
buffer_load_dwordx4 v[92:95], v15, s[12:15], s28 offen sc1
xvv 180,20,72
tv 46,9,5312
xvv 184,24,68
tv 48,14,192
xvv 188,24,72
wl 7
tv 50,14,5312
xvv 192,28,68
tv 52,9,256
buffer_load_dwordx4 v[96:99], v16, s[12:15], s28 offen sc1
xvv 196,28,72
tv 54,9,5376
xvv 200,32,68
tv 56,14,256
xvv 204,32,72
wl 7
tv 58,14,5376
xvv 208,36,68
tv 60,9,10240
dm 5,8,29,3072
xvv 212,36,72
tv 62,9,15360
xvv 216,40,68
tv 64,14,10240
s_add_u32 m0, s26, 4096
xvv 220,40,72
wl 7
tv 66,14,15360
xvv 224,44,68
tv 20,9,10304
buffer_load_dwordx4 v6, s[8:11], s29 offen lds
xvv 228,44,72
tv 22,9,15424
xvv 232,48,68
tv 24,14,10304
xvv 236,48,72
wl 7
tv 26,14,15424
xvv 240,52,68
tv 28,9,10368
xvv 244,52,72
tv 30,9,15488
xvv 248,56,68
tv 32,14,10368
s_mov_b32 s28, 34816
xvv 252,56,72
wl 7
wv 11
tv 34,14,15488
xvv 176,60,76
tv 36,9,10432
buffer_load_dwordx4 v[100:103], v15, s[12:15], s28 offen sc1
xvv 180,60,80
tv 38,9,15552
xvv 184,64,76
tv 40,14,10432
xvv 188,64,80
wl 7
tv 42,14,15552
xvv 192,20,76
tv 44,9,10496
buffer_load_dwordx4 v[104:107], v16, s[12:15], s28 offen sc1
xvv 196,20,80
tv 46,9,15616
xvv 200,24,76
tv 48,14,10496
s_add_u32 m0, s26, 20480
xvv 204,24,80
wl 7
tv 50,14,15616
s_barrier
xvv 208,28,76
s_add_u32 s29, s27, 1556480
tv 52,9,20480
dm 2,8,29,0
xvv 212,28,80
tv 54,9,25600
xvv 216,32,76
tv 56,14,20480
xvv 220,32,80
wl 7
tv 58,14,25600
xvv 224,36,76
tv 60,9,20544
dm 3,8,29,1024
xvv 228,36,80
tv 62,9,25664
xvv 232,40,76
tv 64,14,20544
xvv 236,40,80
wl 7
tv 66,14,25664
xvv 240,44,76
tv 20,9,20608
dm 4,8,29,2048
xvv 244,44,80
tv 22,9,25728
xvv 248,48,76
tv 24,14,20608
s_mov_b32 s28, 35840
xvv 252,48,80
wl 7
wv 12
tv 26,14,25728
xvv 176,52,84
tv 28,9,20672
buffer_load_dwordx4 v[108:111], v15, s[12:15], s28 offen sc1
xvv 180,52,88
tv 30,9,25792
xvv 184,56,84
tv 32,14,20672
xvv 188,56,88
wl 7
tv 34,14,25792
xvv 192,60,84
tv 36,9,20736
buffer_load_dwordx4 v[112:115], v16, s[12:15], s28 offen sc1
xvv 196,60,88
tv 38,9,25856
xvv 200,64,84
tv 40,14,20736
xvv 204,64,88
wl 7
tv 42,14,25856
xvv 208,20,84
tv 44,9,30720
dm 5,8,29,3072
xvv 212,20,88
tv 46,9,35840
xvv 216,24,84
tv 48,14,30720
s_add_u32 m0, s26, 24576
xvv 220,24,88
wl 7
tv 50,14,35840
xvv 224,28,84
tv 52,9,30784
buffer_load_dwordx4 v6, s[8:11], s29 offen lds
xvv 228,28,88
tv 54,9,35904
xvv 232,32,84
tv 56,14,30784
xvv 236,32,88
wl 7
tv 58,14,35904
xvv 240,36,84
tv 60,9,30848
xvv 244,36,88
tv 62,9,35968
xvv 248,40,84
tv 64,14,30848
s_mov_b32 s28, 36864
xvv 252,40,88
wl 7
wv 11
tv 66,14,35968
xvv 176,44,92
tv 20,9,30912
buffer_load_dwordx4 v[68:71], v15, s[12:15], s28 offen sc1
xvv 180,44,96
tv 22,9,36032
xvv 184,48,92
tv 24,14,30912
xvv 188,48,96
wl 7
tv 26,14,36032
xvv 192,52,92
tv 28,9,30976
buffer_load_dwordx4 v[72:75], v16, s[12:15], s28 offen sc1
xvv 196,52,96
tv 30,9,36096
xvv 200,56,92
tv 32,14,30976
s_add_u32 m0, s26, 40960
xvv 204,56,96
wl 7
tv 34,14,36096
s_barrier
xvv 208,60,92
s_add_u32 s29, s27, 1638400
tv 36,9,40960
dm 2,8,29,0
xvv 212,60,96
tv 38,9,46080
xvv 216,64,92
tv 40,14,40960
xvv 220,64,96
wl 7
tv 42,14,46080
xvv 224,20,92
tv 44,9,41024
dm 3,8,29,1024
xvv 228,20,96
tv 46,9,46144
xvv 232,24,92
tv 48,14,41024
xvv 236,24,96
wl 7
tv 50,14,46144
xvv 240,28,92
tv 52,9,41088
dm 4,8,29,2048
xvv 244,28,96
tv 54,9,46208
xvv 248,32,92
tv 56,14,41088
s_mov_b32 s28, 37888
xvv 252,32,96
wl 7
wv 12
tv 58,14,46208
xvv 176,36,100
tv 60,9,41152
buffer_load_dwordx4 v[76:79], v15, s[12:15], s28 offen sc1
xvv 180,36,104
tv 62,9,46272
xvv 184,40,100
tv 64,14,41152
xvv 188,40,104
wl 7
tv 66,14,46272
xvv 192,44,100
tv 20,9,41216
buffer_load_dwordx4 v[80:83], v16, s[12:15], s28 offen sc1
xvv 196,44,104
tv 22,9,46336
xvv 200,48,100
tv 24,14,41216
xvv 204,48,104
wl 7
tv 26,14,46336
xvv 208,52,100
tv 28,9,51200
dm 5,8,29,3072
xvv 212,52,104
tv 30,9,56320
xvv 216,56,100
tv 32,14,51200
s_add_u32 m0, s26, 45056
xvv 220,56,104
wl 7
tv 34,14,56320
xvv 224,60,100
tv 36,9,51264
buffer_load_dwordx4 v6, s[8:11], s29 offen lds
xvv 228,60,104
tv 38,9,56384
xvv 232,64,100
tv 40,14,51264
xvv 236,64,104
wl 7
tv 42,14,56384
xvv 240,20,100
tv 44,9,51328
xvv 244,20,104
tv 46,9,56448
xvv 248,24,100
tv 48,14,51328
s_mov_b32 s28, 38912
xvv 252,24,104
wl 7
wv 11
tv 50,14,56448
xvv 176,28,108
tv 52,9,51392
buffer_load_dwordx4 v[84:87], v15, s[12:15], s28 offen sc1
xvv 180,28,112
tv 54,9,56512
xvv 184,32,108
tv 56,14,51392
xvv 188,32,112
wl 7
tv 58,14,56512
xvv 192,36,108
tv 60,9,51456
buffer_load_dwordx4 v[88:91], v16, s[12:15], s28 offen sc1
xvv 196,36,112
tv 62,9,56576
xvv 200,40,108
tv 64,14,51456
s_add_u32 m0, s26, 61440
xvv 204,40,112
wl 7
tv 66,14,56576
s_barrier
xvv 208,44,108
s_add_u32 s29, s27, 1720320
tv 20,7,0
dm 2,8,29,0
xvv 212,44,112
tv 22,7,5120
xvv 216,48,108
tv 24,8,0
xvv 220,48,112
wl 7
tv 26,8,5120
xvv 224,52,108
tv 28,7,64
dm 3,8,29,1024
xvv 228,52,112
tv 30,7,5184
xvv 232,56,108
tv 32,8,64
xvv 236,56,112
wl 7
tv 34,8,5184
xvv 240,60,108
tv 36,7,128
dm 4,8,29,2048
xvv 244,60,112
tv 38,7,5248
xvv 248,64,108
tv 40,8,128
s_mov_b32 s28, 39936
xvv 252,64,112
wl 7
wv 12
tv 42,8,5248
xvv 176,20,68
tv 44,7,192
buffer_load_dwordx4 v[92:95], v15, s[12:15], s28 offen sc1
xvv 180,20,72
tv 46,7,5312
xvv 184,24,68
tv 48,8,192
xvv 188,24,72
wl 7
tv 50,8,5312
xvv 192,28,68
tv 52,7,256
buffer_load_dwordx4 v[96:99], v16, s[12:15], s28 offen sc1
xvv 196,28,72
tv 54,7,5376
xvv 200,32,68
tv 56,8,256
xvv 204,32,72
wl 7
tv 58,8,5376
xvv 208,36,68
tv 60,7,10240
dm 5,8,29,3072
xvv 212,36,72
tv 62,7,15360
xvv 216,40,68
tv 64,8,10240
s_add_u32 m0, s26, 65536
xvv 220,40,72
wl 7
tv 66,8,15360
xvv 224,44,68
tv 20,7,10304
buffer_load_dwordx4 v6, s[8:11], s29 offen lds
xvv 228,44,72
tv 22,7,15424
xvv 232,48,68
tv 24,8,10304
xvv 236,48,72
wl 7
tv 26,8,15424
xvv 240,52,68
tv 28,7,10368
xvv 244,52,72
tv 30,7,15488
xvv 248,56,68
tv 32,8,10368
s_mov_b32 s28, 40960
xvv 252,56,72
wl 7
wv 11
tv 34,8,15488
xvv 176,60,76
tv 36,7,10432
buffer_load_dwordx4 v[100:103], v15, s[12:15], s28 offen sc1
xvv 180,60,80
tv 38,7,15552
xvv 184,64,76
tv 40,8,10432
xvv 188,64,80
wl 7
tv 42,8,15552
xvv 192,20,76
tv 44,7,10496
buffer_load_dwordx4 v[104:107], v16, s[12:15], s28 offen sc1
xvv 196,20,80
tv 46,7,15616
xvv 200,24,76
tv 48,8,10496
s_add_u32 m0, s26, 81920
xvv 204,24,80
wl 7
tv 50,8,15616
s_barrier
xvv 208,28,76
s_add_u32 s29, s27, 1802240
tv 52,7,20480
dm 2,8,29,0
xvv 212,28,80
tv 54,7,25600
xvv 216,32,76
tv 56,8,20480
xvv 220,32,80
wl 7
tv 58,8,25600
xvv 224,36,76
tv 60,7,20544
dm 3,8,29,1024
xvv 228,36,80
tv 62,7,25664
xvv 232,40,76
tv 64,8,20544
xvv 236,40,80
wl 7
tv 66,8,25664
xvv 240,44,76
tv 20,7,20608
dm 4,8,29,2048
xvv 244,44,80
tv 22,7,25728
xvv 248,48,76
tv 24,8,20608
s_mov_b32 s28, 41984
xvv 252,48,80
wl 7
wv 12
tv 26,8,25728
xvv 176,52,84
tv 28,7,20672
buffer_load_dwordx4 v[108:111], v15, s[12:15], s28 offen sc1
xvv 180,52,88
tv 30,7,25792
xvv 184,56,84
tv 32,8,20672
xvv 188,56,88
wl 7
tv 34,8,25792
xvv 192,60,84
tv 36,7,20736
buffer_load_dwordx4 v[112:115], v16, s[12:15], s28 offen sc1
xvv 196,60,88
tv 38,7,25856
xvv 200,64,84
tv 40,8,20736
xvv 204,64,88
wl 7
tv 42,8,25856
xvv 208,20,84
tv 44,7,30720
dm 5,8,29,3072
xvv 212,20,88
tv 46,7,35840
xvv 216,24,84
tv 48,8,30720
s_add_u32 m0, s26, 86016
xvv 220,24,88
wl 7
tv 50,8,35840
xvv 224,28,84
tv 52,7,30784
buffer_load_dwordx4 v6, s[8:11], s29 offen lds
xvv 228,28,88
tv 54,7,35904
xvv 232,32,84
tv 56,8,30784
xvv 236,32,88
wl 7
tv 58,8,35904
xvv 240,36,84
tv 60,7,30848
xvv 244,36,88
tv 62,7,35968
xvv 248,40,84
tv 64,8,30848
s_mov_b32 s28, 43008
xvv 252,40,88
wl 7
wv 11
tv 66,8,35968
xvv 176,44,92
tv 20,7,30912
buffer_load_dwordx4 v[68:71], v15, s[12:15], s28 offen sc1
xvv 180,44,96
tv 22,7,36032
xvv 184,48,92
tv 24,8,30912
xvv 188,48,96
wl 7
tv 26,8,36032
xvv 192,52,92
tv 28,7,30976
buffer_load_dwordx4 v[72:75], v16, s[12:15], s28 offen sc1
xvv 196,52,96
tv 30,7,36096
xvv 200,56,92
tv 32,8,30976
s_add_u32 m0, s26, 102400
xvv 204,56,96
wl 7
tv 34,8,36096
s_barrier
xvv 208,60,92
s_add_u32 s29, s27, 1884160
tv 36,7,40960
dm 2,8,29,0
xvv 212,60,96
tv 38,7,46080
xvv 216,64,92
tv 40,8,40960
xvv 220,64,96
wl 7
tv 42,8,46080
xvv 224,20,92
tv 44,7,41024
dm 3,8,29,1024
xvv 228,20,96
tv 46,7,46144
xvv 232,24,92
tv 48,8,41024
xvv 236,24,96
wl 7
tv 50,8,46144
xvv 240,28,92
tv 52,7,41088
dm 4,8,29,2048
xvv 244,28,96
tv 54,7,46208
xvv 248,32,92
tv 56,8,41088
s_mov_b32 s28, 44032
xvv 252,32,96
wl 7
wv 12
tv 58,8,46208
xvv 176,36,100
tv 60,7,41152
buffer_load_dwordx4 v[76:79], v15, s[12:15], s28 offen sc1
xvv 180,36,104
tv 62,7,46272
xvv 184,40,100
tv 64,8,41152
xvv 188,40,104
wl 7
tv 66,8,46272
xvv 192,44,100
tv 20,7,41216
buffer_load_dwordx4 v[80:83], v16, s[12:15], s28 offen sc1
xvv 196,44,104
tv 22,7,46336
xvv 200,48,100
tv 24,8,41216
xvv 204,48,104
wl 7
tv 26,8,46336
xvv 208,52,100
tv 28,7,51200
dm 5,8,29,3072
xvv 212,52,104
tv 30,7,56320
xvv 216,56,100
tv 32,8,51200
s_add_u32 m0, s26, 106496
xvv 220,56,104
wl 7
tv 34,8,56320
xvv 224,60,100
tv 36,7,51264
buffer_load_dwordx4 v6, s[8:11], s29 offen lds
xvv 228,60,104
tv 38,7,56384
xvv 232,64,100
tv 40,8,51264
xvv 236,64,104
wl 7
tv 42,8,56384
xvv 240,20,100
tv 44,7,51328
xvv 244,20,104
tv 46,7,56448
xvv 248,24,100
tv 48,8,51328
s_mov_b32 s28, 45056
xvv 252,24,104
wl 7
wv 11
tv 50,8,56448
xvv 176,28,108
tv 52,7,51392
buffer_load_dwordx4 v[84:87], v15, s[12:15], s28 offen sc1
xvv 180,28,112
tv 54,7,56512
xvv 184,32,108
tv 56,8,51392
xvv 188,32,112
wl 7
tv 58,8,56512
xvv 192,36,108
tv 60,7,51456
buffer_load_dwordx4 v[88:91], v16, s[12:15], s28 offen sc1
xvv 196,36,112
tv 62,7,56576
xvv 200,40,108
tv 64,8,51456
xvv 204,40,112
wl 7
tv 66,8,56576
s_barrier
xvv 208,44,108
tv 20,9,0
xvv 212,44,112
tv 22,9,5120
xvv 216,48,108
tv 24,14,0
xvv 220,48,112
wl 7
tv 26,14,5120
xvv 224,52,108
tv 28,9,64
xvv 228,52,112
tv 30,9,5184
xvv 232,56,108
tv 32,14,64
xvv 236,56,112
wl 7
tv 34,14,5184
xvv 240,60,108
tv 36,9,128
xvv 244,60,112
tv 38,9,5248
xvv 248,64,108
tv 40,14,128
s_mov_b32 s28, 46080
xvv 252,64,112
wl 7
wv 9
tv 42,14,5248
xvv 176,20,68
tv 44,9,192
buffer_load_dwordx4 v[92:95], v15, s[12:15], s28 offen sc1
xvv 180,20,72
tv 46,9,5312
xvv 184,24,68
tv 48,14,192
xvv 188,24,72
wl 7
tv 50,14,5312
xvv 192,28,68
tv 52,9,256
buffer_load_dwordx4 v[96:99], v16, s[12:15], s28 offen sc1
xvv 196,28,72
tv 54,9,5376
xvv 200,32,68
tv 56,14,256
xvv 204,32,72
wl 7
tv 58,14,5376
xvv 208,36,68
tv 60,9,10240
xvv 212,36,72
tv 62,9,15360
xvv 216,40,68
tv 64,14,10240
xvv 220,40,72
wl 7
tv 66,14,15360
xvv 224,44,68
tv 20,9,10304
xvv 228,44,72
tv 22,9,15424
xvv 232,48,68
tv 24,14,10304
xvv 236,48,72
wl 7
tv 26,14,15424
xvv 240,52,68
tv 28,9,10368
xvv 244,52,72
tv 30,9,15488
xvv 248,56,68
tv 32,14,10368
s_mov_b32 s28, 47104
xvv 252,56,72
wl 7
wv 6
tv 34,14,15488
xvv 176,60,76
tv 36,9,10432
buffer_load_dwordx4 v[100:103], v15, s[12:15], s28 offen sc1
xvv 180,60,80
tv 38,9,15552
xvv 184,64,76
tv 40,14,10432
xvv 188,64,80
wl 7
tv 42,14,15552
xvv 192,20,76
tv 44,9,10496
buffer_load_dwordx4 v[104:107], v16, s[12:15], s28 offen sc1
xvv 196,20,80
tv 46,9,15616
xvv 200,24,76
tv 48,14,10496
xvv 204,24,80
wl 7
tv 50,14,15616
s_barrier
xvv 208,28,76
tv 52,9,20480
xvv 212,28,80
tv 54,9,25600
xvv 216,32,76
tv 56,14,20480
xvv 220,32,80
wl 7
tv 58,14,25600
xvv 224,36,76
tv 60,9,20544
xvv 228,36,80
tv 62,9,25664
xvv 232,40,76
tv 64,14,20544
xvv 236,40,80
wl 7
tv 66,14,25664
xvv 240,44,76
tv 20,9,20608
xvv 244,44,80
tv 22,9,25728
xvv 248,48,76
tv 24,14,20608
s_mov_b32 s28, 48128
xvv 252,48,80
wl 7
wv 4
tv 26,14,25728
xvv 176,52,84
tv 28,9,20672
buffer_load_dwordx4 v[108:111], v15, s[12:15], s28 offen sc1
xvv 180,52,88
tv 30,9,25792
xvv 184,56,84
tv 32,14,20672
xvv 188,56,88
wl 7
tv 34,14,25792
xvv 192,60,84
tv 36,9,20736
buffer_load_dwordx4 v[112:115], v16, s[12:15], s28 offen sc1
xvv 196,60,88
tv 38,9,25856
xvv 200,64,84
tv 40,14,20736
xvv 204,64,88
wl 7
tv 42,14,25856
xvv 208,20,84
tv 44,9,30720
xvv 212,20,88
tv 46,9,35840
xvv 216,24,84
tv 48,14,30720
xvv 220,24,88
wl 7
tv 50,14,35840
xvv 224,28,84
tv 52,9,30784
xvv 228,28,88
tv 54,9,35904
xvv 232,32,84
tv 56,14,30784
xvv 236,32,88
wl 7
tv 58,14,35904
xvv 240,36,84
tv 60,9,30848
xvv 244,36,88
tv 62,9,35968
xvv 248,40,84
tv 64,14,30848
xvv 252,40,88
wl 7
wv 4
tv 66,14,35968
xvv 176,44,92
tv 20,9,30912
xvv 180,44,96
tv 22,9,36032
xvv 184,48,92
tv 24,14,30912
xvv 188,48,96
wl 7
tv 26,14,36032
xvv 192,52,92
tv 28,9,30976
xvv 196,52,96
tv 30,9,36096
xvv 200,56,92
tv 32,14,30976
xvv 204,56,96
wl 7
tv 34,14,36096
s_barrier
xvv 208,60,92
tv 36,9,40960
xvv 212,60,96
tv 38,9,46080
xvv 216,64,92
tv 40,14,40960
xvv 220,64,96
wl 7
tv 42,14,46080
xvv 224,20,92
tv 44,9,41024
xvv 228,20,96
tv 46,9,46144
xvv 232,24,92
tv 48,14,41024
xvv 236,24,96
wl 7
tv 50,14,46144
xvv 240,28,92
tv 52,9,41088
xvv 244,28,96
tv 54,9,46208
xvv 248,32,92
tv 56,14,41088
xvv 252,32,96
wl 7
wv 2
tv 58,14,46208
xvv 176,36,100
tv 60,9,41152
xvv 180,36,104
tv 62,9,46272
xvv 184,40,100
tv 64,14,41152
xvv 188,40,104
wl 7
tv 66,14,46272
xvv 192,44,100
tv 20,9,41216
xvv 196,44,104
tv 22,9,46336
xvv 200,48,100
tv 24,14,41216
xvv 204,48,104
wl 7
tv 26,14,46336
xvv 208,52,100
tv 28,9,51200
xvv 212,52,104
tv 30,9,56320
xvv 216,56,100
tv 32,14,51200
xvv 220,56,104
wl 7
tv 34,14,56320
xvv 224,60,100
tv 36,9,51264
xvv 228,60,104
tv 38,9,56384
xvv 232,64,100
tv 40,14,51264
xvv 236,64,104
wl 7
tv 42,14,56384
xvv 240,20,100
tv 44,9,51328
xvv 244,20,104
tv 46,9,56448
xvv 248,24,100
tv 48,14,51328
xvv 252,24,104
wl 7
wv 0
tv 50,14,56448
xvv 176,28,108
tv 52,9,51392
xvv 180,28,112
tv 54,9,56512
xvv 184,32,108
tv 56,14,51392
xvv 188,32,112
wl 7
tv 58,14,56512
xvv 192,36,108
tv 60,9,51456
xvv 196,36,112
tv 62,9,56576
xvv 200,40,108
tv 64,14,51456
xvv 204,40,112
wl 7
tv 66,14,56576
xvv 208,44,108
xvv 212,44,112
xvv 216,48,108
xvv 220,48,112
wl 4
xvv 224,52,108
xvv 228,52,112
xvv 232,56,108
xvv 236,56,112
wl 0
xvv 240,60,108
xvv 244,60,112
xvv 248,64,108
xvv 252,64,112
s_mov_b32 s28, 0
cv 20,176,177
cv 21,178,179
cv 22,184,185
cv 23,186,187
buffer_store_dwordx4 v[20:23], v17, s[12:15], s28 offen sc1
cv 24,180,181
cv 25,182,183
cv 26,188,189
cv 27,190,191
buffer_store_dwordx4 v[24:27], v18, s[12:15], s28 offen sc1
s_mov_b32 s28, 1024
cv 28,192,193
cv 29,194,195
cv 30,200,201
cv 31,202,203
buffer_store_dwordx4 v[28:31], v17, s[12:15], s28 offen sc1
cv 32,196,197
cv 33,198,199
cv 34,204,205
cv 35,206,207
buffer_store_dwordx4 v[32:35], v18, s[12:15], s28 offen sc1
s_mov_b32 s28, 2048
cv 36,208,209
cv 37,210,211
cv 38,216,217
cv 39,218,219
buffer_store_dwordx4 v[36:39], v17, s[12:15], s28 offen sc1
cv 40,212,213
cv 41,214,215
cv 42,220,221
cv 43,222,223
buffer_store_dwordx4 v[40:43], v18, s[12:15], s28 offen sc1
s_mov_b32 s28, 3072
cv 44,224,225
cv 45,226,227
cv 46,232,233
cv 47,234,235
buffer_store_dwordx4 v[44:47], v17, s[12:15], s28 offen sc1
cv 48,228,229
cv 49,230,231
cv 50,236,237
cv 51,238,239
buffer_store_dwordx4 v[48:51], v18, s[12:15], s28 offen sc1
s_mov_b32 s28, 4096
cv 52,240,241
cv 53,242,243
cv 54,248,249
cv 55,250,251
buffer_store_dwordx4 v[52:55], v17, s[12:15], s28 offen sc1
cv 56,244,245
cv 57,246,247
cv 58,252,253
cv 59,254,255
buffer_store_dwordx4 v[56:59], v18, s[12:15], s28 offen sc1
s_lshl_b32 s3, s23, 6
v_add_u32 v144, s3, v0
v_add_u32 v145, 0, v144
v_min_u32 v145, 639, v145
v_mul_u32_u24 v146, 410, v145
v_lshrrev_b32 v146, 16, v146
v_mul_u32_u24 v147, 160, v146
v_sub_u32 v147, v145, v147
v_lshlrev_b32 v148, 4, v147
v_mul_u32_u24 v147, 2560, v146
v_add_u32 v147, v147, v148
s_mov_b32 s25, 5120
buffer_load_dwordx4 v[160:163], v147, s[12:15], s25 offen sc1
s_mov_b32 s25, 20480
buffer_load_dwordx4 v[164:167], v147, s[12:15], s25 offen sc1
s_mov_b32 s25, 35840
buffer_load_dwordx4 v[168:171], v147, s[12:15], s25 offen sc1
s_mov_b32 s25, 51200
buffer_load_dwordx4 v[172:175], v147, s[12:15], s25 offen sc1
v_mul_u32_u24 v146, 5120, v146
v_add_u32 v148, v148, v146
v_add_u32 v148, 122880, v148
v_add_u32 v145, 256, v144
v_min_u32 v145, 639, v145
v_mul_u32_u24 v146, 410, v145
v_lshrrev_b32 v146, 16, v146
v_mul_u32_u24 v147, 160, v146
v_sub_u32 v147, v145, v147
v_lshlrev_b32 v149, 4, v147
v_mul_u32_u24 v147, 2560, v146
v_add_u32 v147, v147, v149
s_mov_b32 s25, 5120
buffer_load_dwordx4 v[176:179], v147, s[12:15], s25 offen sc1
s_mov_b32 s25, 20480
buffer_load_dwordx4 v[180:183], v147, s[12:15], s25 offen sc1
s_mov_b32 s25, 35840
buffer_load_dwordx4 v[184:187], v147, s[12:15], s25 offen sc1
s_mov_b32 s25, 51200
buffer_load_dwordx4 v[188:191], v147, s[12:15], s25 offen sc1
v_mul_u32_u24 v146, 5120, v146
v_add_u32 v149, v149, v146
v_add_u32 v149, 122880, v149
v_add_u32 v145, 512, v144
v_min_u32 v145, 639, v145
v_mul_u32_u24 v146, 410, v145
v_lshrrev_b32 v146, 16, v146
v_mul_u32_u24 v147, 160, v146
v_sub_u32 v147, v145, v147
v_lshlrev_b32 v150, 4, v147
v_mul_u32_u24 v147, 2560, v146
v_add_u32 v147, v147, v150
s_mov_b32 s25, 5120
buffer_load_dwordx4 v[192:195], v147, s[12:15], s25 offen sc1
s_mov_b32 s25, 20480
buffer_load_dwordx4 v[196:199], v147, s[12:15], s25 offen sc1
s_mov_b32 s25, 35840
buffer_load_dwordx4 v[200:203], v147, s[12:15], s25 offen sc1
s_mov_b32 s25, 51200
buffer_load_dwordx4 v[204:207], v147, s[12:15], s25 offen sc1
v_mul_u32_u24 v146, 5120, v146
v_add_u32 v150, v150, v146
v_add_u32 v150, 122880, v150
wv 0
s_barrier
s_cmp_lg_u32 s23, 0
s_cbranch_scc1 KT_A0
s_lshl_b32 s3, s21, 7
s_add_u32 s3, s3, 196608
v_mov_b32 v250, s3
v_mov_b32 v251, 1
s_mov_b64 exec, 1
buffer_atomic_add v251, v250, s[12:15], 0 offen sc1
s_mov_b64 exec, -1
KT_A0:
v_add_u32 v110, 0, v0
v_mul_u32_u24 v111, 5462, v110
v_lshrrev_b32 v111, 16, v111
v_mul_u32_u24 v112, 12, v111
v_sub_u32 v112, v110, v112
v_lshrrev_b32 v113, 2, v111
v_and_b32 v113, 1, v113
v_lshlrev_b32 v113, 1, v113
v_xor_b32 v112, v112, v113
v_lshlrev_b32 v112, 4, v112
v_mul_u32_u24 v111, 3072, v111
v_add_u32 v111, v111, v112
v_add_u32 v2, 8192, v111
v_add_u32 v110, 64, v0
v_mul_u32_u24 v111, 5462, v110
v_lshrrev_b32 v111, 16, v111
v_mul_u32_u24 v112, 12, v111
v_sub_u32 v112, v110, v112
v_lshrrev_b32 v113, 2, v111
v_and_b32 v113, 1, v113
v_lshlrev_b32 v113, 1, v113
v_xor_b32 v112, v112, v113
v_lshlrev_b32 v112, 4, v112
v_mul_u32_u24 v111, 3072, v111
v_add_u32 v111, v111, v112
v_add_u32 v3, 7168, v111
v_add_u32 v110, 128, v0
v_mul_u32_u24 v111, 5462, v110
v_lshrrev_b32 v111, 16, v111
v_mul_u32_u24 v112, 12, v111
v_sub_u32 v112, v110, v112
v_lshrrev_b32 v113, 2, v111
v_and_b32 v113, 1, v113
v_lshlrev_b32 v113, 1, v113
v_xor_b32 v112, v112, v113
v_lshlrev_b32 v112, 4, v112
v_mul_u32_u24 v111, 3072, v111
v_add_u32 v111, v111, v112
v_add_u32 v4, 6144, v111
s_lshr_b32 s3, s23, 1
s_mul_i32 s3, s3, 49152
v_add_u32 v2, s3, v2
v_add_u32 v3, s3, v3
v_add_u32 v4, s3, v4
s_and_b32 s3, s23, 1
s_cmp_eq_u32 s3, 0
s_cselect_b32 s8, s48, s50
s_cselect_b32 s9, s49, s51
s_mul_i32 s3, s56, 192
s_add_u32 s8, s8, s3
s_addc_u32 s9, s9, 0
s_sub_u32 s8, s8, 8192
s_subb_u32 s9, s9, 0
s_sub_u32 s10, 1974272, s3
s_mov_b32 s11, 0x20000
s_mul_i32 s26, s23, 3072
v_lshrrev_b32 v10, 4, v0
v_lshrrev_b32 v11, 2, v0
v_mul_u32_u24 v11, 192, v11
v_and_b32 v12, 3, v0
v_lshlrev_b32 v12, 3, v12
v_add_u32 v11, v11, v12
v_and_b32 v12, 1, v10
v_lshlrev_b32 v12, 5, v12
v_add_u32 v7, v11, v12
v_xor_b32 v12, 32, v12
v_add_u32 v8, v11, v12
v_lshlrev_b32 v10, 4, v0
s_mul_i32 s3, s24, 20480
s_add_u32 s3, s3, 67108864
v_add_u32 v15, s3, v10
v_add_u32 v16, 20480, v15
s_mul_i32 s3, s24, 49152
s_mul_i32 s25, s56, 3072
s_add_u32 s3, s3, s25
s_add_u32 s3, s3, 71303168
v_add_u32 v17, s3, v10
v_add_u32 v18, 49152, v17
v_add_f32 v160, v160, v164
v_add_f32 v161, v161, v165
v_add_f32 v162, v162, v166
v_add_f32 v163, v163, v167
v_add_f32 v160, v160, v168
v_add_f32 v161, v161, v169
v_add_f32 v162, v162, v170
v_add_f32 v163, v163, v171
v_add_f32 v160, v160, v172
v_add_f32 v161, v161, v173
v_add_f32 v162, v162, v174
v_add_f32 v163, v163, v175
v_subrev_u32 v146, 133120, v148
v_cmp_gt_u32 vcc, 5120, v146
s_nop 1
v_cndmask_b32 v146, 0, 1.0, vcc
cv 160,160,160
v_and_b32 v160, 0xffff0000, v160
v_add_f32 v160, v160, v146
cv 161,161,161
v_and_b32 v161, 0xffff0000, v161
v_add_f32 v161, v161, v146
cv 162,162,162
v_and_b32 v162, 0xffff0000, v162
v_add_f32 v162, v162, v146
cv 163,163,163
v_and_b32 v163, 0xffff0000, v163
v_add_f32 v163, v163, v146
ds_write_b128 v148, v[160:163]
v_add_f32 v176, v176, v180
v_add_f32 v177, v177, v181
v_add_f32 v178, v178, v182
v_add_f32 v179, v179, v183
v_add_f32 v176, v176, v184
v_add_f32 v177, v177, v185
v_add_f32 v178, v178, v186
v_add_f32 v179, v179, v187
v_add_f32 v176, v176, v188
v_add_f32 v177, v177, v189
v_add_f32 v178, v178, v190
v_add_f32 v179, v179, v191
v_subrev_u32 v146, 133120, v149
v_cmp_gt_u32 vcc, 5120, v146
s_nop 1
v_cndmask_b32 v146, 0, 1.0, vcc
cv 176,176,176
v_and_b32 v176, 0xffff0000, v176
v_add_f32 v176, v176, v146
cv 177,177,177
v_and_b32 v177, 0xffff0000, v177
v_add_f32 v177, v177, v146
cv 178,178,178
v_and_b32 v178, 0xffff0000, v178
v_add_f32 v178, v178, v146
cv 179,179,179
v_and_b32 v179, 0xffff0000, v179
v_add_f32 v179, v179, v146
ds_write_b128 v149, v[176:179]
v_add_f32 v192, v192, v196
v_add_f32 v193, v193, v197
v_add_f32 v194, v194, v198
v_add_f32 v195, v195, v199
v_add_f32 v192, v192, v200
v_add_f32 v193, v193, v201
v_add_f32 v194, v194, v202
v_add_f32 v195, v195, v203
v_add_f32 v192, v192, v204
v_add_f32 v193, v193, v205
v_add_f32 v194, v194, v206
v_add_f32 v195, v195, v207
v_subrev_u32 v146, 133120, v150
v_cmp_gt_u32 vcc, 5120, v146
s_nop 1
v_cndmask_b32 v146, 0, 1.0, vcc
cv 192,192,192
v_and_b32 v192, 0xffff0000, v192
v_add_f32 v192, v192, v146
cv 193,193,193
v_and_b32 v193, 0xffff0000, v193
v_add_f32 v193, v193, v146
cv 194,194,194
v_and_b32 v194, 0xffff0000, v194
v_add_f32 v194, v194, v146
cv 195,195,195
v_and_b32 v195, 0xffff0000, v195
v_add_f32 v195, v195, v146
ds_write_b128 v150, v[192:195]
v_lshlrev_b32 v208, 16, v132
v_and_b32 v209, 0xffff0000, v132
v_lshlrev_b32 v210, 16, v133
v_and_b32 v211, 0xffff0000, v133
v_lshlrev_b32 v212, 16, v134
v_and_b32 v213, 0xffff0000, v134
v_lshlrev_b32 v214, 16, v135
v_and_b32 v215, 0xffff0000, v135
v_lshlrev_b32 v216, 16, v136
v_and_b32 v217, 0xffff0000, v136
v_lshlrev_b32 v218, 16, v137
v_and_b32 v219, 0xffff0000, v137
v_lshlrev_b32 v220, 16, v138
v_and_b32 v221, 0xffff0000, v138
v_lshlrev_b32 v222, 16, v139
v_and_b32 v223, 0xffff0000, v139
v_lshlrev_b32 v224, 16, v140
v_and_b32 v225, 0xffff0000, v140
v_lshlrev_b32 v226, 16, v141
v_and_b32 v227, 0xffff0000, v141
v_lshlrev_b32 v228, 16, v142
v_and_b32 v229, 0xffff0000, v142
v_lshlrev_b32 v230, 16, v143
v_and_b32 v231, 0xffff0000, v143
v_lshlrev_b32 v151, 7, v122
v_lshlrev_b32 v146, 4, v121
v_add_u32 v151, v151, v146
v_add_u32 v151, 122880, v151
s_lshr_b32 s3, s36, 3
v_add_u32 v152, s3, v151
s_lshr_b32 s3, s37, 3
v_add_u32 v153, s3, v151
s_lshr_b32 s3, s38, 3
v_add_u32 v154, s3, v151
s_cmp_lt_u32 s23, 2
s_cselect_b32 s39, 1.0, 0
v_mul_u32_u24 v155, 144, v120
v_add_u32 v155, 143360, v155
v_lshlrev_b32 v156, 3, v121
v_lshlrev_b32 v146, 2, v122
v_add_u32 v156, v156, v146
s_lshl_b32 s3, s23, 5
v_add_u32 v156, s3, v156
v_add_u32 v156, v156, v155
s_cmp_lg_u32 s23, 0
s_cbranch_scc1 KT_B0
s_mov_b64 exec, 1
s_mov_b32 s25, 0
KT_P0:
buffer_load_dword v251, v250, s[12:15], 0 offen sc1
wv 0
v_cmp_gt_u32 vcc, 16, v251
s_add_u32 s25, s25, 1
s_nop 3
s_and_b64 vcc, vcc, exec
s_cbranch_scc0 KT_D0
s_sleep 1
s_cmp_lt_u32 s25, 16384
s_cbranch_scc1 KT_P0
KT_D0:
s_mov_b64 exec, -1
KT_B0:
wl 0
s_barrier
s_mov_b32 s25, 33554432
buffer_load_dwordx4 v[20:23], v125, s[12:15], s25 offen sc1
s_mov_b32 s25, 33554432
buffer_load_dwordx4 v[24:27], v126, s[12:15], s25 offen sc1
s_mov_b32 s25, 33554432
buffer_load_dwordx4 v[28:31], v127, s[12:15], s25 offen sc1
s_mov_b32 s25, 36175872
buffer_load_dwordx4 v[32:35], v125, s[12:15], s25 offen sc1
s_mov_b32 s25, 36175872
buffer_load_dwordx4 v[36:39], v126, s[12:15], s25 offen sc1
s_mov_b32 s25, 36175872
buffer_load_dwordx4 v[40:43], v127, s[12:15], s25 offen sc1
s_mov_b32 s25, 38797312
buffer_load_dwordx4 v[44:47], v125, s[12:15], s25 offen sc1
s_mov_b32 s25, 38797312
buffer_load_dwordx4 v[48:51], v126, s[12:15], s25 offen sc1
s_mov_b32 s25, 38797312
buffer_load_dwordx4 v[52:55], v127, s[12:15], s25 offen sc1
s_mov_b32 s25, 41418752
buffer_load_dwordx4 v[56:59], v125, s[12:15], s25 offen sc1
s_mov_b32 s25, 41418752
buffer_load_dwordx4 v[60:63], v126, s[12:15], s25 offen sc1
s_mov_b32 s25, 41418752
buffer_load_dwordx4 v[64:67], v127, s[12:15], s25 offen sc1
ds_read_b128 v[160:163], v152 offset:0
ds_read_b128 v[164:167], v152 offset:64
ds_read_b128 v[168:171], v153 offset:0
ds_read_b128 v[172:175], v153 offset:64
ds_read_b128 v[176:179], v154 offset:0
ds_read_b128 v[180:183], v154 offset:64
s_add_u32 m0, s26, 0
s_mov_b32 s29, 0
dm 2,8,29,0
dm 3,8,29,1024
dm 4,8,29,2048
s_add_u32 m0, s26, 12288
s_mov_b32 s29, 98304
dm 2,8,29,0
dm 3,8,29,1024
dm 4,8,29,2048
s_add_u32 m0, s26, 24576
s_mov_b32 s29, 196608
dm 2,8,29,0
dm 3,8,29,1024
dm 4,8,29,2048
s_add_u32 m0, s26, 36864
s_mov_b32 s29, 294912
dm 2,8,29,0
dm 3,8,29,1024
dm 4,8,29,2048
v_mov_b32 v146, 0x3f80
v_mov_b32 v147, 0x3f800000
wv 23
v_lshlrev_b32 v72, 16, v20
v_and_b32 v73, 0xffff0000, v20
v_lshlrev_b32 v74, 16, v21
v_and_b32 v75, 0xffff0000, v21
v_lshlrev_b32 v76, 16, v22
v_and_b32 v77, 0xffff0000, v22
v_lshlrev_b32 v78, 16, v23
v_and_b32 v79, 0xffff0000, v23
wv 22
v_lshlrev_b32 v80, 16, v24
v_and_b32 v81, 0xffff0000, v24
v_lshlrev_b32 v82, 16, v25
v_and_b32 v83, 0xffff0000, v25
v_lshlrev_b32 v84, 16, v26
v_and_b32 v85, 0xffff0000, v26
v_lshlrev_b32 v86, 16, v27
v_and_b32 v87, 0xffff0000, v27
wv 21
v_lshlrev_b32 v88, 16, v28
v_and_b32 v89, 0xffff0000, v28
v_lshlrev_b32 v90, 16, v29
v_and_b32 v91, 0xffff0000, v29
v_lshlrev_b32 v92, 16, v30
v_and_b32 v93, 0xffff0000, v30
v_lshlrev_b32 v94, 16, v31
v_and_b32 v95, 0xffff0000, v31
wv 20
v_dot2c_f32_bf16 v72, v32, v146
v_dot2c_f32_bf16 v73, v32, v147
v_dot2c_f32_bf16 v74, v33, v146
v_dot2c_f32_bf16 v75, v33, v147
v_dot2c_f32_bf16 v76, v34, v146
v_dot2c_f32_bf16 v77, v34, v147
v_dot2c_f32_bf16 v78, v35, v146
v_dot2c_f32_bf16 v79, v35, v147
wv 19
v_dot2c_f32_bf16 v80, v36, v146
v_dot2c_f32_bf16 v81, v36, v147
v_dot2c_f32_bf16 v82, v37, v146
v_dot2c_f32_bf16 v83, v37, v147
v_dot2c_f32_bf16 v84, v38, v146
v_dot2c_f32_bf16 v85, v38, v147
v_dot2c_f32_bf16 v86, v39, v146
v_dot2c_f32_bf16 v87, v39, v147
wv 18
v_dot2c_f32_bf16 v88, v40, v146
v_dot2c_f32_bf16 v89, v40, v147
v_dot2c_f32_bf16 v90, v41, v146
v_dot2c_f32_bf16 v91, v41, v147
v_dot2c_f32_bf16 v92, v42, v146
v_dot2c_f32_bf16 v93, v42, v147
v_dot2c_f32_bf16 v94, v43, v146
v_dot2c_f32_bf16 v95, v43, v147
wv 17
v_dot2c_f32_bf16 v72, v44, v146
v_dot2c_f32_bf16 v73, v44, v147
v_dot2c_f32_bf16 v74, v45, v146
v_dot2c_f32_bf16 v75, v45, v147
v_dot2c_f32_bf16 v76, v46, v146
v_dot2c_f32_bf16 v77, v46, v147
v_dot2c_f32_bf16 v78, v47, v146
v_dot2c_f32_bf16 v79, v47, v147
wv 16
v_dot2c_f32_bf16 v80, v48, v146
v_dot2c_f32_bf16 v81, v48, v147
v_dot2c_f32_bf16 v82, v49, v146
v_dot2c_f32_bf16 v83, v49, v147
v_dot2c_f32_bf16 v84, v50, v146
v_dot2c_f32_bf16 v85, v50, v147
v_dot2c_f32_bf16 v86, v51, v146
v_dot2c_f32_bf16 v87, v51, v147
wv 15
v_dot2c_f32_bf16 v88, v52, v146
v_dot2c_f32_bf16 v89, v52, v147
v_dot2c_f32_bf16 v90, v53, v146
v_dot2c_f32_bf16 v91, v53, v147
v_dot2c_f32_bf16 v92, v54, v146
v_dot2c_f32_bf16 v93, v54, v147
v_dot2c_f32_bf16 v94, v55, v146
v_dot2c_f32_bf16 v95, v55, v147
wv 14
v_dot2c_f32_bf16 v72, v56, v146
v_dot2c_f32_bf16 v73, v56, v147
v_dot2c_f32_bf16 v74, v57, v146
v_dot2c_f32_bf16 v75, v57, v147
v_dot2c_f32_bf16 v76, v58, v146
v_dot2c_f32_bf16 v77, v58, v147
v_dot2c_f32_bf16 v78, v59, v146
v_dot2c_f32_bf16 v79, v59, v147
wv 13
v_dot2c_f32_bf16 v80, v60, v146
v_dot2c_f32_bf16 v81, v60, v147
v_dot2c_f32_bf16 v82, v61, v146
v_dot2c_f32_bf16 v83, v61, v147
v_dot2c_f32_bf16 v84, v62, v146
v_dot2c_f32_bf16 v85, v62, v147
v_dot2c_f32_bf16 v86, v63, v146
v_dot2c_f32_bf16 v87, v63, v147
wv 12
v_dot2c_f32_bf16 v88, v64, v146
v_dot2c_f32_bf16 v89, v64, v147
v_dot2c_f32_bf16 v90, v65, v146
v_dot2c_f32_bf16 v91, v65, v147
v_dot2c_f32_bf16 v92, v66, v146
v_dot2c_f32_bf16 v93, v66, v147
v_dot2c_f32_bf16 v94, v67, v146
v_dot2c_f32_bf16 v95, v67, v147
wl 5
v_pk_fma_f32 v[208:209], v[72:73], v[160:161], v[208:209]
v_pk_fma_f32 v[210:211], v[74:75], v[162:163], v[210:211]
cv 100,208,209
cv 101,210,211
wl 4
v_pk_fma_f32 v[212:213], v[76:77], v[164:165], v[212:213]
v_pk_fma_f32 v[214:215], v[78:79], v[166:167], v[214:215]
cv 102,212,213
cv 103,214,215
wl 3
v_pk_fma_f32 v[216:217], v[80:81], v[168:169], v[216:217]
v_pk_fma_f32 v[218:219], v[82:83], v[170:171], v[218:219]
cv 104,216,217
cv 105,218,219
wl 2
v_pk_fma_f32 v[220:221], v[84:85], v[172:173], v[220:221]
v_pk_fma_f32 v[222:223], v[86:87], v[174:175], v[222:223]
cv 106,220,221
cv 107,222,223
wl 1
v_pk_fma_f32 v[224:225], v[88:89], v[176:177], v[224:225]
v_pk_fma_f32 v[226:227], v[90:91], v[178:179], v[226:227]
cv 108,224,225
cv 109,226,227
wl 0
v_pk_fma_f32 v[228:229], v[92:93], v[180:181], v[228:229]
v_pk_fma_f32 v[230:231], v[94:95], v[182:183], v[230:231]
cv 110,228,229
cv 111,230,231
v_lshlrev_b32 v208, 16, v100
v_and_b32 v209, 0xffff0000, v100
v_lshlrev_b32 v210, 16, v101
v_and_b32 v211, 0xffff0000, v101
v_lshlrev_b32 v212, 16, v102
v_and_b32 v213, 0xffff0000, v102
v_lshlrev_b32 v214, 16, v103
v_and_b32 v215, 0xffff0000, v103
v_lshlrev_b32 v216, 16, v104
v_and_b32 v217, 0xffff0000, v104
v_lshlrev_b32 v218, 16, v105
v_and_b32 v219, 0xffff0000, v105
v_lshlrev_b32 v220, 16, v106
v_and_b32 v221, 0xffff0000, v106
v_lshlrev_b32 v222, 16, v107
v_and_b32 v223, 0xffff0000, v107
v_lshlrev_b32 v224, 16, v108
v_and_b32 v225, 0xffff0000, v108
v_lshlrev_b32 v226, 16, v109
v_and_b32 v227, 0xffff0000, v109
v_lshlrev_b32 v228, 16, v110
v_and_b32 v229, 0xffff0000, v110
v_lshlrev_b32 v230, 16, v111
v_and_b32 v231, 0xffff0000, v111
s_mov_b32 s25, 58720256
buffer_store_dwordx4 v[100:103], v125, s[12:15], s25 offen sc1
buffer_store_dwordx4 v[104:107], v126, s[12:15], s25 offen sc1
buffer_store_dwordx4 v[108:111], v127, s[12:15], s25 offen sc1
ds_read_b128 v[20:23], v152 offset:10240
ds_read_b128 v[44:47], v152 offset:5120
ds_read_b128 v[24:27], v152 offset:10304
ds_read_b128 v[48:51], v152 offset:5184
ds_read_b128 v[28:31], v153 offset:10240
ds_read_b128 v[52:55], v153 offset:5120
ds_read_b128 v[32:35], v153 offset:10304
ds_read_b128 v[56:59], v153 offset:5184
ds_read_b128 v[36:39], v154 offset:10240
ds_read_b128 v[60:63], v154 offset:5120
ds_read_b128 v[40:43], v154 offset:10304
ds_read_b128 v[64:67], v154 offset:5184
v_pk_add_f32 v[158:159], v[208:209], v[210:211]
v_pk_add_f32 v[158:159], v[158:159], v[212:213]
v_pk_add_f32 v[158:159], v[158:159], v[214:215]
v_pk_add_f32 v[158:159], v[158:159], v[216:217]
v_pk_add_f32 v[158:159], v[158:159], v[218:219]
v_pk_add_f32 v[158:159], v[158:159], v[220:221]
v_pk_add_f32 v[158:159], v[158:159], v[222:223]
v_pk_add_f32 v[96:97], v[224:225], v[226:227]
v_pk_add_f32 v[96:97], v[96:97], v[228:229]
v_pk_add_f32 v[96:97], v[96:97], v[230:231]
v_add_f32 v158, v158, v159
v_add_f32 v96, v96, v97
v_fma_f32 v158, v96, s39, v158
ds_write_b32 v156, v158 offset:0
wl 0
s_barrier
ds_read_b128 v[160:163], v155 offset:0
ds_read_b128 v[164:167], v155 offset:16
ds_read_b128 v[168:171], v155 offset:32
ds_read_b128 v[172:175], v155 offset:48
ds_read_b128 v[176:179], v155 offset:64
ds_read_b128 v[180:183], v155 offset:80
ds_read_b128 v[184:187], v155 offset:96
ds_read_b128 v[188:191], v155 offset:112
wl 3
v_pk_add_f32 v[160:161], v[160:161], v[176:177]
v_pk_add_f32 v[162:163], v[162:163], v[178:179]
wl 2
v_pk_add_f32 v[164:165], v[164:165], v[180:181]
v_pk_add_f32 v[166:167], v[166:167], v[182:183]
wl 1
v_pk_add_f32 v[168:169], v[168:169], v[184:185]
v_pk_add_f32 v[170:171], v[170:171], v[186:187]
wl 0
v_pk_add_f32 v[172:173], v[172:173], v[188:189]
v_pk_add_f32 v[174:175], v[174:175], v[190:191]
v_pk_add_f32 v[160:161], v[160:161], v[168:169]
v_pk_add_f32 v[162:163], v[162:163], v[170:171]
v_pk_add_f32 v[164:165], v[164:165], v[172:173]
v_pk_add_f32 v[166:167], v[166:167], v[174:175]
v_pk_add_f32 v[160:161], v[160:161], v[164:165]
v_pk_add_f32 v[162:163], v[162:163], v[166:167]
v_pk_add_f32 v[160:161], v[160:161], v[162:163]
v_add_f32 v158, v160, v161
v_mul_f32 v158, 3133983949, v158
v_mov_b32 v159, v158
v_pk_add_f32 v[208:209], v[208:209], v[158:159]
v_pk_add_f32 v[210:211], v[210:211], v[158:159]
v_pk_add_f32 v[212:213], v[212:213], v[158:159]
v_pk_add_f32 v[214:215], v[214:215], v[158:159]
v_pk_add_f32 v[216:217], v[216:217], v[158:159]
v_pk_add_f32 v[218:219], v[218:219], v[158:159]
v_pk_add_f32 v[220:221], v[220:221], v[158:159]
v_pk_add_f32 v[222:223], v[222:223], v[158:159]
v_pk_add_f32 v[224:225], v[224:225], v[158:159]
v_pk_add_f32 v[226:227], v[226:227], v[158:159]
v_pk_add_f32 v[228:229], v[228:229], v[158:159]
v_pk_add_f32 v[230:231], v[230:231], v[158:159]
v_pk_mul_f32 v[98:99], v[208:209], v[208:209]
v_pk_fma_f32 v[98:99], v[210:211], v[210:211], v[98:99]
v_pk_fma_f32 v[98:99], v[212:213], v[212:213], v[98:99]
v_pk_fma_f32 v[98:99], v[214:215], v[214:215], v[98:99]
v_pk_fma_f32 v[98:99], v[216:217], v[216:217], v[98:99]
v_pk_fma_f32 v[98:99], v[218:219], v[218:219], v[98:99]
v_pk_fma_f32 v[98:99], v[220:221], v[220:221], v[98:99]
v_pk_fma_f32 v[98:99], v[222:223], v[222:223], v[98:99]
v_pk_mul_f32 v[96:97], v[224:225], v[224:225]
v_pk_fma_f32 v[96:97], v[226:227], v[226:227], v[96:97]
v_pk_fma_f32 v[96:97], v[228:229], v[228:229], v[96:97]
v_pk_fma_f32 v[96:97], v[230:231], v[230:231], v[96:97]
v_add_f32 v159, v98, v99
v_add_f32 v96, v96, v97
v_fma_f32 v159, v96, s39, v159
ds_write_b32 v156, v159 offset:1280
wl 0
s_barrier
ds_read_b128 v[160:163], v155 offset:1280
ds_read_b128 v[164:167], v155 offset:1296
ds_read_b128 v[168:171], v155 offset:1312
ds_read_b128 v[172:175], v155 offset:1328
ds_read_b128 v[176:179], v155 offset:1344
ds_read_b128 v[180:183], v155 offset:1360
ds_read_b128 v[184:187], v155 offset:1376
ds_read_b128 v[188:191], v155 offset:1392
wl 3
v_pk_add_f32 v[160:161], v[160:161], v[176:177]
v_pk_add_f32 v[162:163], v[162:163], v[178:179]
wl 2
v_pk_add_f32 v[164:165], v[164:165], v[180:181]
v_pk_add_f32 v[166:167], v[166:167], v[182:183]
wl 1
v_pk_add_f32 v[168:169], v[168:169], v[184:185]
v_pk_add_f32 v[170:171], v[170:171], v[186:187]
wl 0
v_pk_add_f32 v[172:173], v[172:173], v[188:189]
v_pk_add_f32 v[174:175], v[174:175], v[190:191]
v_pk_add_f32 v[160:161], v[160:161], v[168:169]
v_pk_add_f32 v[162:163], v[162:163], v[170:171]
v_pk_add_f32 v[164:165], v[164:165], v[172:173]
v_pk_add_f32 v[166:167], v[166:167], v[174:175]
v_pk_add_f32 v[160:161], v[160:161], v[164:165]
v_pk_add_f32 v[162:163], v[162:163], v[166:167]
v_pk_add_f32 v[160:161], v[160:161], v[162:163]
v_add_f32 v159, v160, v161
v_mul_f32 v159, 986500301, v159
v_add_f32 v159, 925353388, v159
v_rsq_f32 v159, v159
s_nop 0
v_mov_b32 v158, v159
v_pk_mul_f32 v[208:209], v[208:209], v[158:159]
v_pk_mul_f32 v[210:211], v[210:211], v[158:159]
v_pk_mul_f32 v[212:213], v[212:213], v[158:159]
v_pk_mul_f32 v[214:215], v[214:215], v[158:159]
v_pk_mul_f32 v[216:217], v[216:217], v[158:159]
v_pk_mul_f32 v[218:219], v[218:219], v[158:159]
v_pk_mul_f32 v[220:221], v[220:221], v[158:159]
v_pk_mul_f32 v[222:223], v[222:223], v[158:159]
v_pk_mul_f32 v[224:225], v[224:225], v[158:159]
v_pk_mul_f32 v[226:227], v[226:227], v[158:159]
v_pk_mul_f32 v[228:229], v[228:229], v[158:159]
v_pk_mul_f32 v[230:231], v[230:231], v[158:159]
v_pk_fma_f32 v[208:209], v[208:209], v[20:21], v[44:45]
v_pk_fma_f32 v[210:211], v[210:211], v[22:23], v[46:47]
v_pk_fma_f32 v[212:213], v[212:213], v[24:25], v[48:49]
v_pk_fma_f32 v[214:215], v[214:215], v[26:27], v[50:51]
v_pk_fma_f32 v[216:217], v[216:217], v[28:29], v[52:53]
v_pk_fma_f32 v[218:219], v[218:219], v[30:31], v[54:55]
v_pk_fma_f32 v[220:221], v[220:221], v[32:33], v[56:57]
v_pk_fma_f32 v[222:223], v[222:223], v[34:35], v[58:59]
v_pk_fma_f32 v[224:225], v[224:225], v[36:37], v[60:61]
v_pk_fma_f32 v[226:227], v[226:227], v[38:39], v[62:63]
v_pk_fma_f32 v[228:229], v[228:229], v[40:41], v[64:65]
v_pk_fma_f32 v[230:231], v[230:231], v[42:43], v[66:67]
cv 100,208,209
cv 101,210,211
cv 102,212,213
cv 103,214,215
cv 104,216,217
cv 105,218,219
cv 106,220,221
cv 107,222,223
cv 108,224,225
cv 109,226,227
cv 110,228,229
cv 111,230,231
s_mov_b32 s25, 67108864
buffer_store_dwordx4 v[100:103], v125, s[12:15], s25 offen sc1
buffer_store_dwordx4 v[104:107], v126, s[12:15], s25 offen sc1
buffer_store_dwordx4 v[108:111], v127, s[12:15], s25 offen sc1
wv 0
s_barrier
s_cmp_lg_u32 s23, 0
s_cbranch_scc1 KT_A1
s_lshl_b32 s3, s21, 7
s_add_u32 s3, s3, 198656
v_mov_b32 v250, s3
v_mov_b32 v251, 1
s_mov_b64 exec, 1
buffer_atomic_add v251, v250, s[12:15], 0 offen sc1
s_mov_b64 exec, -1
KT_A1:
s_cmp_lg_u32 s23, 0
s_cbranch_scc1 KT_B1
v_lshlrev_b32 v251, 7, v0
v_add_u32 v251, 196608, v251
v_cmp_eq_u32 vcc, 16, v0
s_nop 1
v_cndmask_b32 v250, v251, v250, vcc
s_mov_b64 exec, 0x1ffff
s_mov_b32 s25, 0
KT_P1:
buffer_load_dword v251, v250, s[12:15], 0 offen sc1
wv 0
v_cmp_gt_u32 vcc, 16, v251
s_add_u32 s25, s25, 1
s_nop 3
s_and_b64 vcc, vcc, exec
s_cbranch_scc0 KT_D1
s_sleep 1
s_cmp_lt_u32 s25, 16384
s_cbranch_scc1 KT_P1
KT_D1:
s_mov_b64 exec, -1
KT_B1:
wl 0
s_barrier
s_mov_b32 s28, 0
buffer_load_dwordx4 v[68:71], v15, s[12:15], s28 offen sc1
buffer_load_dwordx4 v[72:75], v16, s[12:15], s28 offen sc1
s_mov_b32 s28, 1024
buffer_load_dwordx4 v[76:79], v15, s[12:15], s28 offen sc1
buffer_load_dwordx4 v[80:83], v16, s[12:15], s28 offen sc1
s_mov_b32 s28, 2048
buffer_load_dwordx4 v[84:87], v15, s[12:15], s28 offen sc1
buffer_load_dwordx4 v[88:91], v16, s[12:15], s28 offen sc1
s_mov_b32 s28, 3072
buffer_load_dwordx4 v[92:95], v15, s[12:15], s28 offen sc1
buffer_load_dwordx4 v[96:99], v16, s[12:15], s28 offen sc1
tv 20,7,0
tv 22,7,6144
tv 24,8,0
tv 26,8,6144
tv 28,7,64
tv 30,7,6208
tv 32,8,64
tv 34,8,6208
tv 36,7,128
tv 38,7,6272
tv 40,8,128
tv 42,8,6272
wl 8
wv 6
v_mfma_f32_16x16x32_bf16 v[160:163], v[20:23], v[68:71], 0
tv 44,7,3072
v_mfma_f32_16x16x32_bf16 v[164:167], v[20:23], v[72:75], 0
tv 46,7,9216
v_mfma_f32_16x16x32_bf16 v[168:171], v[24:27], v[68:71], 0
tv 48,8,3072
v_mfma_f32_16x16x32_bf16 v[172:175], v[24:27], v[72:75], 0
wl 7
tv 50,8,9216
v_mfma_f32_16x16x32_bf16 v[176:179], v[28:31], v[68:71], 0
tv 52,7,3136
v_mfma_f32_16x16x32_bf16 v[180:183], v[28:31], v[72:75], 0
tv 54,7,9280
v_mfma_f32_16x16x32_bf16 v[184:187], v[32:35], v[68:71], 0
tv 56,8,3136
v_mfma_f32_16x16x32_bf16 v[188:191], v[32:35], v[72:75], 0
wl 7
tv 58,8,9280
v_mfma_f32_16x16x32_bf16 v[192:195], v[36:39], v[68:71], 0
tv 60,7,3200
v_mfma_f32_16x16x32_bf16 v[196:199], v[36:39], v[72:75], 0
tv 62,7,9344
v_mfma_f32_16x16x32_bf16 v[200:203], v[40:43], v[68:71], 0
tv 64,8,3200
s_add_u32 m0, s26, 49152
v_mfma_f32_16x16x32_bf16 v[204:207], v[40:43], v[72:75], 0
wl 7
tv 66,8,9344
s_barrier
v_mfma_f32_16x16x32_bf16 v[208:211], v[44:47], v[68:71], 0
s_mov_b32 s29, 393216
tv 20,7,12288
dm 2,8,29,0
v_mfma_f32_16x16x32_bf16 v[212:215], v[44:47], v[72:75], 0
tv 22,7,18432
v_mfma_f32_16x16x32_bf16 v[216:219], v[48:51], v[68:71], 0
tv 24,8,12288
v_mfma_f32_16x16x32_bf16 v[220:223], v[48:51], v[72:75], 0
wl 7
tv 26,8,18432
v_mfma_f32_16x16x32_bf16 v[224:227], v[52:55], v[68:71], 0
tv 28,7,12352
dm 3,8,29,1024
v_mfma_f32_16x16x32_bf16 v[228:231], v[52:55], v[72:75], 0
tv 30,7,18496
v_mfma_f32_16x16x32_bf16 v[232:235], v[56:59], v[68:71], 0
tv 32,8,12352
v_mfma_f32_16x16x32_bf16 v[236:239], v[56:59], v[72:75], 0
wl 7
tv 34,8,18496
v_mfma_f32_16x16x32_bf16 v[240:243], v[60:63], v[68:71], 0
tv 36,7,12416
dm 4,8,29,2048
v_mfma_f32_16x16x32_bf16 v[244:247], v[60:63], v[72:75], 0
tv 38,7,18560
v_mfma_f32_16x16x32_bf16 v[248:251], v[64:67], v[68:71], 0
tv 40,8,12416
s_mov_b32 s28, 4096
v_mfma_f32_16x16x32_bf16 v[252:255], v[64:67], v[72:75], 0
wl 7
wv 7
tv 42,8,18560
xvv 160,20,76
tv 44,7,15360
buffer_load_dwordx4 v[100:103], v15, s[12:15], s28 offen sc1
xvv 164,20,80
tv 46,7,21504
xvv 168,24,76
tv 48,8,15360
xvv 172,24,80
wl 7
tv 50,8,21504
xvv 176,28,76
tv 52,7,15424
buffer_load_dwordx4 v[104:107], v16, s[12:15], s28 offen sc1
xvv 180,28,80
tv 54,7,21568
xvv 184,32,76
tv 56,8,15424
xvv 188,32,80
wl 7
tv 58,8,21568
xvv 192,36,76
tv 60,7,15488
xvv 196,36,80
tv 62,7,21632
xvv 200,40,76
tv 64,8,15488
s_add_u32 m0, s26, 0
xvv 204,40,80
wl 7
tv 66,8,21632
s_barrier
xvv 208,44,76
s_mov_b32 s29, 491520
tv 20,7,24576
dm 2,8,29,0
xvv 212,44,80
tv 22,7,30720
xvv 216,48,76
tv 24,8,24576
xvv 220,48,80
wl 7
tv 26,8,30720
xvv 224,52,76
tv 28,7,24640
dm 3,8,29,1024
xvv 228,52,80
tv 30,7,30784
xvv 232,56,76
tv 32,8,24640
xvv 236,56,80
wl 7
tv 34,8,30784
xvv 240,60,76
tv 36,7,24704
dm 4,8,29,2048
xvv 244,60,80
tv 38,7,30848
xvv 248,64,76
tv 40,8,24704
s_mov_b32 s28, 5120
xvv 252,64,80
wl 7
wv 10
tv 42,8,30848
xvv 160,20,84
tv 44,7,27648
buffer_load_dwordx4 v[108:111], v15, s[12:15], s28 offen sc1
xvv 164,20,88
tv 46,7,33792
xvv 168,24,84
tv 48,8,27648
xvv 172,24,88
wl 7
tv 50,8,33792
xvv 176,28,84
tv 52,7,27712
buffer_load_dwordx4 v[112:115], v16, s[12:15], s28 offen sc1
xvv 180,28,88
tv 54,7,33856
xvv 184,32,84
tv 56,8,27712
xvv 188,32,88
wl 7
tv 58,8,33856
xvv 192,36,84
tv 60,7,27776
xvv 196,36,88
tv 62,7,33920
xvv 200,40,84
tv 64,8,27776
s_add_u32 m0, s26, 12288
xvv 204,40,88
wl 7
tv 66,8,33920
s_barrier
xvv 208,44,84
s_mov_b32 s29, 589824
tv 20,7,36864
dm 2,8,29,0
xvv 212,44,88
tv 22,7,43008
xvv 216,48,84
tv 24,8,36864
xvv 220,48,88
wl 7
tv 26,8,43008
xvv 224,52,84
tv 28,7,36928
dm 3,8,29,1024
xvv 228,52,88
tv 30,7,43072
xvv 232,56,84
tv 32,8,36928
xvv 236,56,88
wl 7
tv 34,8,43072
xvv 240,60,84
tv 36,7,36992
dm 4,8,29,2048
xvv 244,60,88
tv 38,7,43136
xvv 248,64,84
tv 40,8,36992
s_mov_b32 s28, 6144
xvv 252,64,88
wl 7
wv 13
tv 42,8,43136
xvv 160,20,92
tv 44,7,39936
buffer_load_dwordx4 v[68:71], v15, s[12:15], s28 offen sc1
xvv 164,20,96
tv 46,7,46080
xvv 168,24,92
tv 48,8,39936
xvv 172,24,96
wl 7
tv 50,8,46080
xvv 176,28,92
tv 52,7,40000
buffer_load_dwordx4 v[72:75], v16, s[12:15], s28 offen sc1
xvv 180,28,96
tv 54,7,46144
xvv 184,32,92
tv 56,8,40000
xvv 188,32,96
wl 7
tv 58,8,46144
xvv 192,36,92
tv 60,7,40064
xvv 196,36,96
tv 62,7,46208
xvv 200,40,92
tv 64,8,40064
s_add_u32 m0, s26, 24576
xvv 204,40,96
wl 7
tv 66,8,46208
wv 12
s_barrier
xvv 208,44,92
s_mov_b32 s29, 688128
tv 20,7,49152
dm 2,8,29,0
xvv 212,44,96
tv 22,7,55296
xvv 216,48,92
tv 24,8,49152
xvv 220,48,96
wl 7
tv 26,8,55296
xvv 224,52,92
tv 28,7,49216
dm 3,8,29,1024
xvv 228,52,96
tv 30,7,55360
xvv 232,56,92
tv 32,8,49216
xvv 236,56,96
wl 7
tv 34,8,55360
xvv 240,60,92
tv 36,7,49280
dm 4,8,29,2048
xvv 244,60,96
tv 38,7,55424
xvv 248,64,92
tv 40,8,49280
s_mov_b32 s28, 7168
xvv 252,64,96
wl 7
wv 13
tv 42,8,55424
xvv 160,20,100
tv 44,7,52224
buffer_load_dwordx4 v[76:79], v15, s[12:15], s28 offen sc1
xvv 164,20,104
tv 46,7,58368
xvv 168,24,100
tv 48,8,52224
xvv 172,24,104
wl 7
tv 50,8,58368
xvv 176,28,100
tv 52,7,52288
buffer_load_dwordx4 v[80:83], v16, s[12:15], s28 offen sc1
xvv 180,28,104
tv 54,7,58432
xvv 184,32,100
tv 56,8,52288
xvv 188,32,104
wl 7
tv 58,8,58432
xvv 192,36,100
tv 60,7,52352
xvv 196,36,104
tv 62,7,58496
xvv 200,40,100
tv 64,8,52352
s_add_u32 m0, s26, 36864
xvv 204,40,104
wl 7
tv 66,8,58496
wv 12
s_barrier
xvv 208,44,100
s_mov_b32 s29, 786432
tv 20,7,0
dm 2,8,29,0
xvv 212,44,104
tv 22,7,6144
xvv 216,48,100
tv 24,8,0
xvv 220,48,104
wl 7
tv 26,8,6144
xvv 224,52,100
tv 28,7,64
dm 3,8,29,1024
xvv 228,52,104
tv 30,7,6208
xvv 232,56,100
tv 32,8,64
xvv 236,56,104
wl 7
tv 34,8,6208
xvv 240,60,100
tv 36,7,128
dm 4,8,29,2048
xvv 244,60,104
tv 38,7,6272
xvv 248,64,100
tv 40,8,128
s_mov_b32 s28, 8192
xvv 252,64,104
wl 7
wv 13
tv 42,8,6272
xvv 160,20,108
tv 44,7,3072
buffer_load_dwordx4 v[84:87], v15, s[12:15], s28 offen sc1
xvv 164,20,112
tv 46,7,9216
xvv 168,24,108
tv 48,8,3072
xvv 172,24,112
wl 7
tv 50,8,9216
xvv 176,28,108
tv 52,7,3136
buffer_load_dwordx4 v[88:91], v16, s[12:15], s28 offen sc1
xvv 180,28,112
tv 54,7,9280
xvv 184,32,108
tv 56,8,3136
xvv 188,32,112
wl 7
tv 58,8,9280
xvv 192,36,108
tv 60,7,3200
xvv 196,36,112
tv 62,7,9344
xvv 200,40,108
tv 64,8,3200
s_add_u32 m0, s26, 49152
xvv 204,40,112
wl 7
tv 66,8,9344
wv 12
s_barrier
xvv 208,44,108
s_mov_b32 s29, 884736
tv 20,7,12288
dm 2,8,29,0
xvv 212,44,112
tv 22,7,18432
xvv 216,48,108
tv 24,8,12288
xvv 220,48,112
wl 7
tv 26,8,18432
xvv 224,52,108
tv 28,7,12352
dm 3,8,29,1024
xvv 228,52,112
tv 30,7,18496
xvv 232,56,108
tv 32,8,12352
xvv 236,56,112
wl 7
tv 34,8,18496
xvv 240,60,108
tv 36,7,12416
dm 4,8,29,2048
xvv 244,60,112
tv 38,7,18560
xvv 248,64,108
tv 40,8,12416
s_mov_b32 s28, 9216
xvv 252,64,112
wl 7
wv 13
tv 42,8,18560
xvv 160,20,68
tv 44,7,15360
buffer_load_dwordx4 v[92:95], v15, s[12:15], s28 offen sc1
xvv 164,20,72
tv 46,7,21504
xvv 168,24,68
tv 48,8,15360
xvv 172,24,72
wl 7
tv 50,8,21504
xvv 176,28,68
tv 52,7,15424
buffer_load_dwordx4 v[96:99], v16, s[12:15], s28 offen sc1
xvv 180,28,72
tv 54,7,21568
xvv 184,32,68
tv 56,8,15424
xvv 188,32,72
wl 7
tv 58,8,21568
xvv 192,36,68
tv 60,7,15488
xvv 196,36,72
tv 62,7,21632
xvv 200,40,68
tv 64,8,15488
s_add_u32 m0, s26, 0
xvv 204,40,72
wl 7
tv 66,8,21632
wv 12
s_barrier
xvv 208,44,68
s_mov_b32 s29, 983040
tv 20,7,24576
dm 2,8,29,0
xvv 212,44,72
tv 22,7,30720
xvv 216,48,68
tv 24,8,24576
xvv 220,48,72
wl 7
tv 26,8,30720
xvv 224,52,68
tv 28,7,24640
dm 3,8,29,1024
xvv 228,52,72
tv 30,7,30784
xvv 232,56,68
tv 32,8,24640
xvv 236,56,72
wl 7
tv 34,8,30784
xvv 240,60,68
tv 36,7,24704
dm 4,8,29,2048
xvv 244,60,72
tv 38,7,30848
xvv 248,64,68
tv 40,8,24704
s_mov_b32 s28, 10240
xvv 252,64,72
wl 7
wv 13
tv 42,8,30848
xvv 160,20,76
tv 44,7,27648
buffer_load_dwordx4 v[100:103], v15, s[12:15], s28 offen sc1
xvv 164,20,80
tv 46,7,33792
xvv 168,24,76
tv 48,8,27648
xvv 172,24,80
wl 7
tv 50,8,33792
xvv 176,28,76
tv 52,7,27712
buffer_load_dwordx4 v[104:107], v16, s[12:15], s28 offen sc1
xvv 180,28,80
tv 54,7,33856
xvv 184,32,76
tv 56,8,27712
xvv 188,32,80
wl 7
tv 58,8,33856
xvv 192,36,76
tv 60,7,27776
xvv 196,36,80
tv 62,7,33920
xvv 200,40,76
tv 64,8,27776
s_add_u32 m0, s26, 12288
xvv 204,40,80
wl 7
tv 66,8,33920
wv 12
s_barrier
xvv 208,44,76
s_mov_b32 s29, 1081344
tv 20,7,36864
dm 2,8,29,0
xvv 212,44,80
tv 22,7,43008
xvv 216,48,76
tv 24,8,36864
xvv 220,48,80
wl 7
tv 26,8,43008
xvv 224,52,76
tv 28,7,36928
dm 3,8,29,1024
xvv 228,52,80
tv 30,7,43072
xvv 232,56,76
tv 32,8,36928
xvv 236,56,80
wl 7
tv 34,8,43072
xvv 240,60,76
tv 36,7,36992
dm 4,8,29,2048
xvv 244,60,80
tv 38,7,43136
xvv 248,64,76
tv 40,8,36992
s_mov_b32 s28, 11264
xvv 252,64,80
wl 7
wv 13
tv 42,8,43136
xvv 160,20,84
tv 44,7,39936
buffer_load_dwordx4 v[108:111], v15, s[12:15], s28 offen sc1
xvv 164,20,88
tv 46,7,46080
xvv 168,24,84
tv 48,8,39936
xvv 172,24,88
wl 7
tv 50,8,46080
xvv 176,28,84
tv 52,7,40000
buffer_load_dwordx4 v[112:115], v16, s[12:15], s28 offen sc1
xvv 180,28,88
tv 54,7,46144
xvv 184,32,84
tv 56,8,40000
xvv 188,32,88
wl 7
tv 58,8,46144
xvv 192,36,84
tv 60,7,40064
xvv 196,36,88
tv 62,7,46208
xvv 200,40,84
tv 64,8,40064
s_add_u32 m0, s26, 24576
xvv 204,40,88
wl 7
tv 66,8,46208
wv 12
s_barrier
xvv 208,44,84
s_mov_b32 s29, 1179648
tv 20,7,49152
dm 2,8,29,0
xvv 212,44,88
tv 22,7,55296
xvv 216,48,84
tv 24,8,49152
xvv 220,48,88
wl 7
tv 26,8,55296
xvv 224,52,84
tv 28,7,49216
dm 3,8,29,1024
xvv 228,52,88
tv 30,7,55360
xvv 232,56,84
tv 32,8,49216
xvv 236,56,88
wl 7
tv 34,8,55360
xvv 240,60,84
tv 36,7,49280
dm 4,8,29,2048
xvv 244,60,88
tv 38,7,55424
xvv 248,64,84
tv 40,8,49280
s_mov_b32 s28, 12288
xvv 252,64,88
wl 7
wv 13
tv 42,8,55424
xvv 160,20,92
tv 44,7,52224
buffer_load_dwordx4 v[68:71], v15, s[12:15], s28 offen sc1
xvv 164,20,96
tv 46,7,58368
xvv 168,24,92
tv 48,8,52224
xvv 172,24,96
wl 7
tv 50,8,58368
xvv 176,28,92
tv 52,7,52288
buffer_load_dwordx4 v[72:75], v16, s[12:15], s28 offen sc1
xvv 180,28,96
tv 54,7,58432
xvv 184,32,92
tv 56,8,52288
xvv 188,32,96
wl 7
tv 58,8,58432
xvv 192,36,92
tv 60,7,52352
xvv 196,36,96
tv 62,7,58496
xvv 200,40,92
tv 64,8,52352
s_add_u32 m0, s26, 36864
xvv 204,40,96
wl 7
tv 66,8,58496
wv 12
s_barrier
xvv 208,44,92
s_mov_b32 s29, 1277952
tv 20,7,0
dm 2,8,29,0
xvv 212,44,96
tv 22,7,6144
xvv 216,48,92
tv 24,8,0
xvv 220,48,96
wl 7
tv 26,8,6144
xvv 224,52,92
tv 28,7,64
dm 3,8,29,1024
xvv 228,52,96
tv 30,7,6208
xvv 232,56,92
tv 32,8,64
xvv 236,56,96
wl 7
tv 34,8,6208
xvv 240,60,92
tv 36,7,128
dm 4,8,29,2048
xvv 244,60,96
tv 38,7,6272
xvv 248,64,92
tv 40,8,128
s_mov_b32 s28, 13312
xvv 252,64,96
wl 7
wv 13
tv 42,8,6272
xvv 160,20,100
tv 44,7,3072
buffer_load_dwordx4 v[76:79], v15, s[12:15], s28 offen sc1
xvv 164,20,104
tv 46,7,9216
xvv 168,24,100
tv 48,8,3072
xvv 172,24,104
wl 7
tv 50,8,9216
xvv 176,28,100
tv 52,7,3136
buffer_load_dwordx4 v[80:83], v16, s[12:15], s28 offen sc1
xvv 180,28,104
tv 54,7,9280
xvv 184,32,100
tv 56,8,3136
xvv 188,32,104
wl 7
tv 58,8,9280
xvv 192,36,100
tv 60,7,3200
xvv 196,36,104
tv 62,7,9344
xvv 200,40,100
tv 64,8,3200
s_add_u32 m0, s26, 49152
xvv 204,40,104
wl 7
tv 66,8,9344
wv 12
s_barrier
xvv 208,44,100
s_mov_b32 s29, 1376256
tv 20,7,12288
dm 2,8,29,0
xvv 212,44,104
tv 22,7,18432
xvv 216,48,100
tv 24,8,12288
xvv 220,48,104
wl 7
tv 26,8,18432
xvv 224,52,100
tv 28,7,12352
dm 3,8,29,1024
xvv 228,52,104
tv 30,7,18496
xvv 232,56,100
tv 32,8,12352
xvv 236,56,104
wl 7
tv 34,8,18496
xvv 240,60,100
tv 36,7,12416
dm 4,8,29,2048
xvv 244,60,104
tv 38,7,18560
xvv 248,64,100
tv 40,8,12416
s_mov_b32 s28, 14336
xvv 252,64,104
wl 7
wv 13
tv 42,8,18560
xvv 160,20,108
tv 44,7,15360
buffer_load_dwordx4 v[84:87], v15, s[12:15], s28 offen sc1
xvv 164,20,112
tv 46,7,21504
xvv 168,24,108
tv 48,8,15360
xvv 172,24,112
wl 7
tv 50,8,21504
xvv 176,28,108
tv 52,7,15424
buffer_load_dwordx4 v[88:91], v16, s[12:15], s28 offen sc1
xvv 180,28,112
tv 54,7,21568
xvv 184,32,108
tv 56,8,15424
xvv 188,32,112
wl 7
tv 58,8,21568
xvv 192,36,108
tv 60,7,15488
xvv 196,36,112
tv 62,7,21632
xvv 200,40,108
tv 64,8,15488
s_add_u32 m0, s26, 0
xvv 204,40,112
wl 7
tv 66,8,21632
wv 12
s_barrier
xvv 208,44,108
s_mov_b32 s29, 1474560
tv 20,7,24576
dm 2,8,29,0
xvv 212,44,112
tv 22,7,30720
xvv 216,48,108
tv 24,8,24576
xvv 220,48,112
wl 7
tv 26,8,30720
xvv 224,52,108
tv 28,7,24640
dm 3,8,29,1024
xvv 228,52,112
tv 30,7,30784
xvv 232,56,108
tv 32,8,24640
xvv 236,56,112
wl 7
tv 34,8,30784
xvv 240,60,108
tv 36,7,24704
dm 4,8,29,2048
xvv 244,60,112
tv 38,7,30848
xvv 248,64,108
tv 40,8,24704
s_mov_b32 s28, 15360
xvv 252,64,112
wl 7
wv 13
tv 42,8,30848
xvv 160,20,68
tv 44,7,27648
buffer_load_dwordx4 v[92:95], v15, s[12:15], s28 offen sc1
xvv 164,20,72
tv 46,7,33792
xvv 168,24,68
tv 48,8,27648
xvv 172,24,72
wl 7
tv 50,8,33792
xvv 176,28,68
tv 52,7,27712
buffer_load_dwordx4 v[96:99], v16, s[12:15], s28 offen sc1
xvv 180,28,72
tv 54,7,33856
xvv 184,32,68
tv 56,8,27712
xvv 188,32,72
wl 7
tv 58,8,33856
xvv 192,36,68
tv 60,7,27776
xvv 196,36,72
tv 62,7,33920
xvv 200,40,68
tv 64,8,27776
s_add_u32 m0, s26, 12288
xvv 204,40,72
wl 7
tv 66,8,33920
wv 12
s_barrier
xvv 208,44,68
s_mov_b32 s29, 1572864
tv 20,7,36864
dm 2,8,29,0
xvv 212,44,72
tv 22,7,43008
xvv 216,48,68
tv 24,8,36864
xvv 220,48,72
wl 7
tv 26,8,43008
xvv 224,52,68
tv 28,7,36928
dm 3,8,29,1024
xvv 228,52,72
tv 30,7,43072
xvv 232,56,68
tv 32,8,36928
xvv 236,56,72
wl 7
tv 34,8,43072
xvv 240,60,68
tv 36,7,36992
dm 4,8,29,2048
xvv 244,60,72
tv 38,7,43136
xvv 248,64,68
tv 40,8,36992
s_mov_b32 s28, 16384
xvv 252,64,72
wl 7
wv 13
tv 42,8,43136
xvv 160,20,76
tv 44,7,39936
buffer_load_dwordx4 v[100:103], v15, s[12:15], s28 offen sc1
xvv 164,20,80
tv 46,7,46080
xvv 168,24,76
tv 48,8,39936
xvv 172,24,80
wl 7
tv 50,8,46080
xvv 176,28,76
tv 52,7,40000
buffer_load_dwordx4 v[104:107], v16, s[12:15], s28 offen sc1
xvv 180,28,80
tv 54,7,46144
xvv 184,32,76
tv 56,8,40000
xvv 188,32,80
wl 7
tv 58,8,46144
xvv 192,36,76
tv 60,7,40064
xvv 196,36,80
tv 62,7,46208
xvv 200,40,76
tv 64,8,40064
s_add_u32 m0, s26, 24576
xvv 204,40,80
wl 7
tv 66,8,46208
wv 12
s_barrier
xvv 208,44,76
s_mov_b32 s29, 1671168
tv 20,7,49152
dm 2,8,29,0
xvv 212,44,80
tv 22,7,55296
xvv 216,48,76
tv 24,8,49152
xvv 220,48,80
wl 7
tv 26,8,55296
xvv 224,52,76
tv 28,7,49216
dm 3,8,29,1024
xvv 228,52,80
tv 30,7,55360
xvv 232,56,76
tv 32,8,49216
xvv 236,56,80
wl 7
tv 34,8,55360
xvv 240,60,76
tv 36,7,49280
dm 4,8,29,2048
xvv 244,60,80
tv 38,7,55424
xvv 248,64,76
tv 40,8,49280
s_mov_b32 s28, 17408
xvv 252,64,80
wl 7
wv 13
tv 42,8,55424
xvv 160,20,84
tv 44,7,52224
buffer_load_dwordx4 v[108:111], v15, s[12:15], s28 offen sc1
xvv 164,20,88
tv 46,7,58368
xvv 168,24,84
tv 48,8,52224
xvv 172,24,88
wl 7
tv 50,8,58368
xvv 176,28,84
tv 52,7,52288
buffer_load_dwordx4 v[112:115], v16, s[12:15], s28 offen sc1
xvv 180,28,88
tv 54,7,58432
xvv 184,32,84
tv 56,8,52288
xvv 188,32,88
wl 7
tv 58,8,58432
xvv 192,36,84
tv 60,7,52352
xvv 196,36,88
tv 62,7,58496
xvv 200,40,84
tv 64,8,52352
s_add_u32 m0, s26, 36864
xvv 204,40,88
wl 7
tv 66,8,58496
wv 12
s_barrier
xvv 208,44,84
s_mov_b32 s29, 1769472
tv 20,7,0
dm 2,8,29,0
xvv 212,44,88
tv 22,7,6144
xvv 216,48,84
tv 24,8,0
xvv 220,48,88
wl 7
tv 26,8,6144
xvv 224,52,84
tv 28,7,64
dm 3,8,29,1024
xvv 228,52,88
tv 30,7,6208
xvv 232,56,84
tv 32,8,64
xvv 236,56,88
wl 7
tv 34,8,6208
xvv 240,60,84
tv 36,7,128
dm 4,8,29,2048
xvv 244,60,88
tv 38,7,6272
xvv 248,64,84
tv 40,8,128
s_mov_b32 s28, 18432
xvv 252,64,88
wl 7
wv 13
tv 42,8,6272
xvv 160,20,92
tv 44,7,3072
buffer_load_dwordx4 v[68:71], v15, s[12:15], s28 offen sc1
xvv 164,20,96
tv 46,7,9216
xvv 168,24,92
tv 48,8,3072
xvv 172,24,96
wl 7
tv 50,8,9216
xvv 176,28,92
tv 52,7,3136
buffer_load_dwordx4 v[72:75], v16, s[12:15], s28 offen sc1
xvv 180,28,96
tv 54,7,9280
xvv 184,32,92
tv 56,8,3136
xvv 188,32,96
wl 7
tv 58,8,9280
xvv 192,36,92
tv 60,7,3200
xvv 196,36,96
tv 62,7,9344
xvv 200,40,92
tv 64,8,3200
s_add_u32 m0, s26, 49152
xvv 204,40,96
wl 7
tv 66,8,9344
wv 12
s_barrier
xvv 208,44,92
s_mov_b32 s29, 1867776
tv 20,7,12288
dm 2,8,29,0
xvv 212,44,96
tv 22,7,18432
xvv 216,48,92
tv 24,8,12288
xvv 220,48,96
wl 7
tv 26,8,18432
xvv 224,52,92
tv 28,7,12352
dm 3,8,29,1024
xvv 228,52,96
tv 30,7,18496
xvv 232,56,92
tv 32,8,12352
xvv 236,56,96
wl 7
tv 34,8,18496
xvv 240,60,92
tv 36,7,12416
dm 4,8,29,2048
xvv 244,60,96
tv 38,7,18560
xvv 248,64,92
tv 40,8,12416
s_mov_b32 s28, 19456
xvv 252,64,96
wl 7
wv 13
tv 42,8,18560
xvv 160,20,100
tv 44,7,15360
buffer_load_dwordx4 v[76:79], v15, s[12:15], s28 offen sc1
xvv 164,20,104
tv 46,7,21504
xvv 168,24,100
tv 48,8,15360
xvv 172,24,104
wl 7
tv 50,8,21504
xvv 176,28,100
tv 52,7,15424
buffer_load_dwordx4 v[80:83], v16, s[12:15], s28 offen sc1
xvv 180,28,104
tv 54,7,21568
xvv 184,32,100
tv 56,8,15424
xvv 188,32,104
wl 7
tv 58,8,21568
xvv 192,36,100
tv 60,7,15488
xvv 196,36,104
tv 62,7,21632
xvv 200,40,100
tv 64,8,15488
xvv 204,40,104
wl 7
tv 66,8,21632
wv 12
s_barrier
xvv 208,44,100
tv 20,7,24576
xvv 212,44,104
tv 22,7,30720
xvv 216,48,100
tv 24,8,24576
xvv 220,48,104
wl 7
tv 26,8,30720
xvv 224,52,100
tv 28,7,24640
xvv 228,52,104
tv 30,7,30784
xvv 232,56,100
tv 32,8,24640
xvv 236,56,104
wl 7
tv 34,8,30784
xvv 240,60,100
tv 36,7,24704
xvv 244,60,104
tv 38,7,30848
xvv 248,64,100
tv 40,8,24704
xvv 252,64,104
wl 7
wv 10
tv 42,8,30848
xvv 160,20,108
tv 44,7,27648
xvv 164,20,112
tv 46,7,33792
xvv 168,24,108
tv 48,8,27648
xvv 172,24,112
wl 7
tv 50,8,33792
xvv 176,28,108
tv 52,7,27712
xvv 180,28,112
tv 54,7,33856
xvv 184,32,108
tv 56,8,27712
xvv 188,32,112
wl 7
tv 58,8,33856
xvv 192,36,108
tv 60,7,27776
xvv 196,36,112
tv 62,7,33920
xvv 200,40,108
tv 64,8,27776
xvv 204,40,112
wl 7
tv 66,8,33920
wv 7
s_barrier
xvv 208,44,108
tv 20,7,36864
xvv 212,44,112
tv 22,7,43008
xvv 216,48,108
tv 24,8,36864
xvv 220,48,112
wl 7
tv 26,8,43008
xvv 224,52,108
tv 28,7,36928
xvv 228,52,112
tv 30,7,43072
xvv 232,56,108
tv 32,8,36928
xvv 236,56,112
wl 7
tv 34,8,43072
xvv 240,60,108
tv 36,7,36992
xvv 244,60,112
tv 38,7,43136
xvv 248,64,108
tv 40,8,36992
xvv 252,64,112
wl 7
wv 5
tv 42,8,43136
xvv 160,20,68
tv 44,7,39936
xvv 164,20,72
tv 46,7,46080
xvv 168,24,68
tv 48,8,39936
xvv 172,24,72
wl 7
tv 50,8,46080
xvv 176,28,68
tv 52,7,40000
xvv 180,28,72
tv 54,7,46144
xvv 184,32,68
tv 56,8,40000
xvv 188,32,72
wl 7
tv 58,8,46144
xvv 192,36,68
tv 60,7,40064
xvv 196,36,72
tv 62,7,46208
xvv 200,40,68
tv 64,8,40064
xvv 204,40,72
wl 7
tv 66,8,46208
wv 2
s_barrier
xvv 208,44,68
tv 20,7,49152
xvv 212,44,72
tv 22,7,55296
xvv 216,48,68
tv 24,8,49152
xvv 220,48,72
wl 7
tv 26,8,55296
xvv 224,52,68
tv 28,7,49216
xvv 228,52,72
tv 30,7,55360
xvv 232,56,68
tv 32,8,49216
xvv 236,56,72
wl 7
tv 34,8,55360
xvv 240,60,68
tv 36,7,49280
xvv 244,60,72
tv 38,7,55424
xvv 248,64,68
tv 40,8,49280
xvv 252,64,72
wl 7
wv 0
tv 42,8,55424
xvv 160,20,76
tv 44,7,52224
xvv 164,20,80
tv 46,7,58368
xvv 168,24,76
tv 48,8,52224
xvv 172,24,80
wl 7
tv 50,8,58368
xvv 176,28,76
tv 52,7,52288
xvv 180,28,80
tv 54,7,58432
xvv 184,32,76
tv 56,8,52288
xvv 188,32,80
wl 7
tv 58,8,58432
xvv 192,36,76
tv 60,7,52352
xvv 196,36,80
tv 62,7,58496
xvv 200,40,76
tv 64,8,52352
xvv 204,40,80
wl 7
tv 66,8,58496
xvv 208,44,76
xvv 212,44,80
xvv 216,48,76
xvv 220,48,80
wl 4
xvv 224,52,76
xvv 228,52,80
xvv 232,56,76
xvv 236,56,80
wl 0
xvv 240,60,76
xvv 244,60,80
xvv 248,64,76
xvv 252,64,80
s_mov_b32 s28, 0
v_max_f32 v160, 0, v160
v_max_f32 v161, 0, v161
v_max_f32 v162, 0, v162
v_max_f32 v163, 0, v163
v_mul_f32 v160, v160, v208
v_mul_f32 v161, v161, v209
v_mul_f32 v162, v162, v210
v_mul_f32 v163, v163, v211
cv 20,160,161
cv 21,162,163
v_max_f32 v168, 0, v168
v_max_f32 v169, 0, v169
v_max_f32 v170, 0, v170
v_max_f32 v171, 0, v171
v_mul_f32 v168, v168, v216
v_mul_f32 v169, v169, v217
v_mul_f32 v170, v170, v218
v_mul_f32 v171, v171, v219
cv 22,168,169
cv 23,170,171
buffer_store_dwordx4 v[20:23], v17, s[12:15], s28 offen sc1
v_max_f32 v164, 0, v164
v_max_f32 v165, 0, v165
v_max_f32 v166, 0, v166
v_max_f32 v167, 0, v167
v_mul_f32 v164, v164, v212
v_mul_f32 v165, v165, v213
v_mul_f32 v166, v166, v214
v_mul_f32 v167, v167, v215
cv 24,164,165
cv 25,166,167
v_max_f32 v172, 0, v172
v_max_f32 v173, 0, v173
v_max_f32 v174, 0, v174
v_max_f32 v175, 0, v175
v_mul_f32 v172, v172, v220
v_mul_f32 v173, v173, v221
v_mul_f32 v174, v174, v222
v_mul_f32 v175, v175, v223
cv 26,172,173
cv 27,174,175
buffer_store_dwordx4 v[24:27], v18, s[12:15], s28 offen sc1
s_mov_b32 s28, 1024
v_max_f32 v176, 0, v176
v_max_f32 v177, 0, v177
v_max_f32 v178, 0, v178
v_max_f32 v179, 0, v179
v_mul_f32 v176, v176, v224
v_mul_f32 v177, v177, v225
v_mul_f32 v178, v178, v226
v_mul_f32 v179, v179, v227
cv 28,176,177
cv 29,178,179
v_max_f32 v184, 0, v184
v_max_f32 v185, 0, v185
v_max_f32 v186, 0, v186
v_max_f32 v187, 0, v187
v_mul_f32 v184, v184, v232
v_mul_f32 v185, v185, v233
v_mul_f32 v186, v186, v234
v_mul_f32 v187, v187, v235
cv 30,184,185
cv 31,186,187
buffer_store_dwordx4 v[28:31], v17, s[12:15], s28 offen sc1
v_max_f32 v180, 0, v180
v_max_f32 v181, 0, v181
v_max_f32 v182, 0, v182
v_max_f32 v183, 0, v183
v_mul_f32 v180, v180, v228
v_mul_f32 v181, v181, v229
v_mul_f32 v182, v182, v230
v_mul_f32 v183, v183, v231
cv 32,180,181
cv 33,182,183
v_max_f32 v188, 0, v188
v_max_f32 v189, 0, v189
v_max_f32 v190, 0, v190
v_max_f32 v191, 0, v191
v_mul_f32 v188, v188, v236
v_mul_f32 v189, v189, v237
v_mul_f32 v190, v190, v238
v_mul_f32 v191, v191, v239
cv 34,188,189
cv 35,190,191
buffer_store_dwordx4 v[32:35], v18, s[12:15], s28 offen sc1
s_mov_b32 s28, 2048
v_max_f32 v192, 0, v192
v_max_f32 v193, 0, v193
v_max_f32 v194, 0, v194
v_max_f32 v195, 0, v195
v_mul_f32 v192, v192, v240
v_mul_f32 v193, v193, v241
v_mul_f32 v194, v194, v242
v_mul_f32 v195, v195, v243
cv 36,192,193
cv 37,194,195
v_max_f32 v200, 0, v200
v_max_f32 v201, 0, v201
v_max_f32 v202, 0, v202
v_max_f32 v203, 0, v203
v_mul_f32 v200, v200, v248
v_mul_f32 v201, v201, v249
v_mul_f32 v202, v202, v250
v_mul_f32 v203, v203, v251
cv 38,200,201
cv 39,202,203
buffer_store_dwordx4 v[36:39], v17, s[12:15], s28 offen sc1
v_max_f32 v196, 0, v196
v_max_f32 v197, 0, v197
v_max_f32 v198, 0, v198
v_max_f32 v199, 0, v199
v_mul_f32 v196, v196, v244
v_mul_f32 v197, v197, v245
v_mul_f32 v198, v198, v246
v_mul_f32 v199, v199, v247
cv 40,196,197
cv 41,198,199
v_max_f32 v204, 0, v204
v_max_f32 v205, 0, v205
v_max_f32 v206, 0, v206
v_max_f32 v207, 0, v207
v_mul_f32 v204, v204, v252
v_mul_f32 v205, v205, v253
v_mul_f32 v206, v206, v254
v_mul_f32 v207, v207, v255
cv 42,204,205
cv 43,206,207
buffer_store_dwordx4 v[40:43], v18, s[12:15], s28 offen sc1
s_lshr_b32 s30, s20, 1
s_lshl_b32 s30, s30, 2
s_add_u32 s30, s30, s22
s_lshl_b32 s31, s21, 1
s_and_b32 s3, s20, 1
s_add_u32 s31, s31, s3
v_lshlrev_b32 v2, 4, v0
v_add_u32 v6, 4096, v2
v_lshrrev_b32 v111, 2, v0
v_mul_u32_u24 v111, 160, v111
v_and_b32 v112, 3, v0
v_lshlrev_b32 v112, 3, v112
v_add_u32 v7, v111, v112
s_mul_i32 s26, s23, 30720
v_add_u32 v7, s26, v7
s_lshl_b32 s24, s31, 2
s_mul_i32 s3, s24, 49152
s_mul_i32 s25, s23, 12288
s_add_u32 s3, s3, s25
s_add_u32 s3, s3, 71303168
v_lshlrev_b32 v10, 4, v0
v_add_u32 v112, s3, v10
s_mul_i32 s27, s23, 61440
s_mul_i32 s3, s30, 245760
s_add_u32 s27, s27, s3
s_add_u32 s27, s27, 79691776
s_mov_b32 s32, s54
s_mov_b32 s33, s55
s_mov_b32 s34, 2621440
s_mov_b32 s35, 0x20000
wv 0
s_barrier
s_cmp_lg_u32 s23, 0
s_cbranch_scc1 KT_A2
s_lshl_b32 s3, s21, 7
s_add_u32 s3, s3, 200704
v_mov_b32 v250, s3
v_mov_b32 v251, 1
s_mov_b64 exec, 1
buffer_atomic_add v251, v250, s[12:15], 0 offen sc1
s_mov_b64 exec, -1
KT_A2:
s_add_u32 m0, s26, 0
s_add_u32 s29, s27, 0
buffer_load_dwordx4 v2, s[12:15], s29 offen offset:0 sc1 lds
buffer_load_dwordx4 v2, s[12:15], s29 offen offset:1024 sc1 lds
buffer_load_dwordx4 v2, s[12:15], s29 offen offset:2048 sc1 lds
buffer_load_dwordx4 v2, s[12:15], s29 offen offset:3072 sc1 lds
s_add_u32 m0, s26, 4096
s_nop 0
buffer_load_dwordx4 v6, s[12:15], s29 offen sc1 lds
s_add_u32 m0, s26, 5120
s_add_u32 s29, s27, 5120
buffer_load_dwordx4 v2, s[12:15], s29 offen offset:0 sc1 lds
buffer_load_dwordx4 v2, s[12:15], s29 offen offset:1024 sc1 lds
buffer_load_dwordx4 v2, s[12:15], s29 offen offset:2048 sc1 lds
buffer_load_dwordx4 v2, s[12:15], s29 offen offset:3072 sc1 lds
s_add_u32 m0, s26, 9216
s_nop 0
buffer_load_dwordx4 v6, s[12:15], s29 offen sc1 lds
s_add_u32 m0, s26, 10240
s_add_u32 s29, s27, 10240
buffer_load_dwordx4 v2, s[12:15], s29 offen offset:0 sc1 lds
buffer_load_dwordx4 v2, s[12:15], s29 offen offset:1024 sc1 lds
buffer_load_dwordx4 v2, s[12:15], s29 offen offset:2048 sc1 lds
buffer_load_dwordx4 v2, s[12:15], s29 offen offset:3072 sc1 lds
s_add_u32 m0, s26, 14336
s_nop 0
buffer_load_dwordx4 v6, s[12:15], s29 offen sc1 lds
s_cmp_lg_u32 s23, 0
s_cbranch_scc1 KT_B2
s_mov_b64 exec, 1
s_mov_b32 s25, 0
KT_P2:
buffer_load_dword v251, v250, s[12:15], 0 offen sc1
wv 0
v_cmp_gt_u32 vcc, 16, v251
s_add_u32 s25, s25, 1
s_nop 3
s_and_b64 vcc, vcc, exec
s_cbranch_scc0 KT_D2
s_sleep 1
s_cmp_lt_u32 s25, 16384
s_cbranch_scc1 KT_P2
KT_D2:
s_mov_b64 exec, -1
KT_B2:
wl 0
s_barrier
v_add_u32 v15, 0, v112
v_add_u32 v16, 49152, v112
v_add_u32 v17, 98304, v112
v_add_u32 v18, 147456, v112
s_mov_b32 s28, 0
buffer_load_dwordx4 v[52:55], v15, s[12:15], s28 offen sc1
buffer_load_dwordx4 v[56:59], v16, s[12:15], s28 offen sc1
buffer_load_dwordx4 v[60:63], v17, s[12:15], s28 offen sc1
buffer_load_dwordx4 v[64:67], v18, s[12:15], s28 offen sc1
s_mov_b32 s28, 1024
buffer_load_dwordx4 v[68:71], v15, s[12:15], s28 offen sc1
buffer_load_dwordx4 v[72:75], v16, s[12:15], s28 offen sc1
buffer_load_dwordx4 v[76:79], v17, s[12:15], s28 offen sc1
buffer_load_dwordx4 v[80:83], v18, s[12:15], s28 offen sc1
s_mov_b32 s28, 2048
buffer_load_dwordx4 v[84:87], v15, s[12:15], s28 offen sc1
buffer_load_dwordx4 v[88:91], v16, s[12:15], s28 offen sc1
buffer_load_dwordx4 v[92:95], v17, s[12:15], s28 offen sc1
buffer_load_dwordx4 v[96:99], v18, s[12:15], s28 offen sc1
s_add_u32 s3, s24, s23
s_mul_i32 s36, s3, 20480
s_add_u32 s36, s36, 58720256
s_mul_i32 s3, s30, 5
s_add_u32 s3, s3, 0
s_lshr_b32 s37, s3, 1
s_lshl_b32 s37, s37, 10
s_and_b32 s3, s3, 1
s_lshl_b32 s3, s3, 3
s_add_u32 s37, s37, s3
s_add_u32 s37, s37, s36
buffer_load_dwordx2 v[116:117], v10, s[12:15], s37 offen sc1
s_mul_i32 s3, s30, 5
s_add_u32 s3, s3, 1
s_lshr_b32 s37, s3, 1
s_lshl_b32 s37, s37, 10
s_and_b32 s3, s3, 1
s_lshl_b32 s3, s3, 3
s_add_u32 s37, s37, s3
s_add_u32 s37, s37, s36
buffer_load_dwordx2 v[118:119], v10, s[12:15], s37 offen sc1
s_mul_i32 s3, s30, 5
s_add_u32 s3, s3, 2
s_lshr_b32 s37, s3, 1
s_lshl_b32 s37, s37, 10
s_and_b32 s3, s3, 1
s_lshl_b32 s3, s3, 3
s_add_u32 s37, s37, s3
s_add_u32 s37, s37, s36
buffer_load_dwordx2 v[120:121], v10, s[12:15], s37 offen sc1
s_mul_i32 s3, s30, 5
s_add_u32 s3, s3, 3
s_lshr_b32 s37, s3, 1
s_lshl_b32 s37, s37, 10
s_and_b32 s3, s3, 1
s_lshl_b32 s3, s3, 3
s_add_u32 s37, s37, s3
s_add_u32 s37, s37, s36
buffer_load_dwordx2 v[122:123], v10, s[12:15], s37 offen sc1
s_mul_i32 s3, s30, 5
s_add_u32 s3, s3, 4
s_lshr_b32 s37, s3, 1
s_lshl_b32 s37, s37, 10
s_and_b32 s3, s3, 1
s_lshl_b32 s3, s3, 3
s_add_u32 s37, s37, s3
s_add_u32 s37, s37, s36
buffer_load_dwordx2 v[124:125], v10, s[12:15], s37 offen sc1
v_lshrrev_b32 v11, 4, v0
v_lshlrev_b32 v13, 4, v11
s_mul_i32 s3, s30, 320
s_add_u32 s3, s3, 138240
v_add_u32 v13, s3, v13
ds_read_b128 v[128:131], v13 offset:0
ds_read_b128 v[132:135], v13 offset:64
ds_read_b128 v[136:139], v13 offset:128
ds_read_b128 v[140:143], v13 offset:192
ds_read_b128 v[144:147], v13 offset:256
v_and_b32 v12, 15, v0
s_lshl_b32 s3, s31, 6
s_lshl_b32 s25, s23, 4
s_add_u32 s3, s3, s25
v_add_u32 v12, s3, v12
v_mul_u32_u24 v12, 1280, v12
v_lshlrev_b32 v11, 3, v11
v_add_u32 v12, v12, v11
s_mul_i32 s3, s30, 160
v_add_u32 v14, s3, v12
wv 27
tv 20,7,0
tv 22,7,2560
tv 24,7,32
tv 26,7,2592
tv 28,7,64
tv 30,7,2624
tv 32,7,96
tv 34,7,2656
wl 6
wv 13
v_mfma_f32_16x16x32_bf16 v[176:179], v[20:23], v[52:55], 0
s_add_u32 m0, s26, 15360
tv 36,7,128
s_add_u32 s29, s27, 15360
buffer_load_dwordx4 v2, s[12:15], s29 offen offset:0 sc1 lds
v_mfma_f32_16x16x32_bf16 v[180:183], v[20:23], v[56:59], 0
tv 38,7,2688
v_mfma_f32_16x16x32_bf16 v[184:187], v[20:23], v[60:63], 0
buffer_load_dwordx4 v2, s[12:15], s29 offen offset:1024 sc1 lds
v_mfma_f32_16x16x32_bf16 v[188:191], v[20:23], v[64:67], 0
wl 6
v_mfma_f32_16x16x32_bf16 v[192:195], v[24:27], v[52:55], 0
tv 40,7,5120
buffer_load_dwordx4 v2, s[12:15], s29 offen offset:2048 sc1 lds
v_mfma_f32_16x16x32_bf16 v[196:199], v[24:27], v[56:59], 0
tv 42,7,7680
v_mfma_f32_16x16x32_bf16 v[200:203], v[24:27], v[60:63], 0
buffer_load_dwordx4 v2, s[12:15], s29 offen offset:3072 sc1 lds
s_add_u32 m0, s26, 19456
v_mfma_f32_16x16x32_bf16 v[204:207], v[24:27], v[64:67], 0
wl 6
v_mfma_f32_16x16x32_bf16 v[208:211], v[28:31], v[52:55], 0
tv 44,7,5152
buffer_load_dwordx4 v6, s[12:15], s29 offen sc1 lds
v_mfma_f32_16x16x32_bf16 v[212:215], v[28:31], v[56:59], 0
tv 46,7,7712
s_add_u32 m0, s26, 20480
v_mfma_f32_16x16x32_bf16 v[216:219], v[28:31], v[60:63], 0
s_add_u32 s29, s27, 20480
buffer_load_dwordx4 v2, s[12:15], s29 offen offset:0 sc1 lds
v_mfma_f32_16x16x32_bf16 v[220:223], v[28:31], v[64:67], 0
wl 6
v_mfma_f32_16x16x32_bf16 v[224:227], v[32:35], v[52:55], 0
tv 48,7,5184
buffer_load_dwordx4 v2, s[12:15], s29 offen offset:1024 sc1 lds
v_mfma_f32_16x16x32_bf16 v[228:231], v[32:35], v[56:59], 0
tv 50,7,7744
v_mfma_f32_16x16x32_bf16 v[232:235], v[32:35], v[60:63], 0
buffer_load_dwordx4 v2, s[12:15], s29 offen offset:2048 sc1 lds
v_mfma_f32_16x16x32_bf16 v[236:239], v[32:35], v[64:67], 0
wl 6
v_mfma_f32_16x16x32_bf16 v[240:243], v[36:39], v[52:55], 0
tv 20,7,5216
buffer_load_dwordx4 v2, s[12:15], s29 offen offset:3072 sc1 lds
v_mfma_f32_16x16x32_bf16 v[244:247], v[36:39], v[56:59], 0
tv 22,7,7776
s_add_u32 m0, s26, 24576
v_mfma_f32_16x16x32_bf16 v[248:251], v[36:39], v[60:63], 0
buffer_load_dwordx4 v6, s[12:15], s29 offen sc1 lds
s_mov_b32 s28, 3072
v_mfma_f32_16x16x32_bf16 v[252:255], v[36:39], v[64:67], 0
wl 6
wv 19
xvv 176,40,68
tv 24,7,5248
buffer_load_dwordx4 v[100:103], v15, s[12:15], s28 offen sc1
xvv 180,40,72
tv 26,7,7808
xvv 184,40,76
buffer_load_dwordx4 v[104:107], v16, s[12:15], s28 offen sc1
xvv 188,40,80
wl 6
xvv 192,44,68
tv 28,7,10240
buffer_load_dwordx4 v[108:111], v17, s[12:15], s28 offen sc1
xvv 196,44,72
tv 30,7,12800
xvv 200,44,76
buffer_load_dwordx4 v[112:115], v18, s[12:15], s28 offen sc1
s_add_u32 m0, s26, 25600
xvv 204,44,80
wl 6
s_add_u32 s29, s27, 25600
xvv 208,48,68
tv 32,7,10272
buffer_load_dwordx4 v2, s[12:15], s29 offen offset:0 sc1 lds
xvv 212,48,72
tv 34,7,12832
xvv 216,48,76
buffer_load_dwordx4 v2, s[12:15], s29 offen offset:1024 sc1 lds
xvv 220,48,80
wl 6
xvv 224,20,68
tv 36,7,10304
buffer_load_dwordx4 v2, s[12:15], s29 offen offset:2048 sc1 lds
xvv 228,20,72
tv 38,7,12864
xvv 232,20,76
buffer_load_dwordx4 v2, s[12:15], s29 offen offset:3072 sc1 lds
s_add_u32 m0, s26, 29696
xvv 236,20,80
wl 6
xvv 240,24,68
tv 40,7,10336
buffer_load_dwordx4 v6, s[12:15], s29 offen sc1 lds
xvv 244,24,72
tv 42,7,12896
xvv 248,24,76
s_mov_b32 s28, 4096
xvv 252,24,80
wl 6
wv 24
xvv 176,28,84
tv 44,7,10368
buffer_load_dwordx4 v[52:55], v15, s[12:15], s28 offen sc1
xvv 180,28,88
tv 46,7,12928
xvv 184,28,92
buffer_load_dwordx4 v[56:59], v16, s[12:15], s28 offen sc1
xvv 188,28,96
wl 6
wv 16
xvv 192,32,84
tv 48,7,15360
buffer_load_dwordx4 v[60:63], v17, s[12:15], s28 offen sc1
xvv 196,32,88
tv 50,7,17920
xvv 200,32,92
buffer_load_dwordx4 v[64:67], v18, s[12:15], s28 offen sc1
s_add_u32 m0, s26, 0
xvv 204,32,96
wl 6
s_add_u32 s29, s27, 30720
xvv 208,36,84
tv 20,7,15392
buffer_load_dwordx4 v2, s[12:15], s29 offen offset:0 sc1 lds
xvv 212,36,88
tv 22,7,17952
xvv 216,36,92
buffer_load_dwordx4 v2, s[12:15], s29 offen offset:1024 sc1 lds
xvv 220,36,96
wl 6
xvv 224,40,84
tv 24,7,15424
buffer_load_dwordx4 v2, s[12:15], s29 offen offset:2048 sc1 lds
xvv 228,40,88
tv 26,7,17984
xvv 232,40,92
buffer_load_dwordx4 v2, s[12:15], s29 offen offset:3072 sc1 lds
s_add_u32 m0, s26, 4096
xvv 236,40,96
wl 6
xvv 240,44,84
tv 28,7,15456
buffer_load_dwordx4 v6, s[12:15], s29 offen sc1 lds
xvv 244,44,88
tv 30,7,18016
xvv 248,44,92
s_mov_b32 s28, 5120
xvv 252,44,96
wl 6
wv 14
xvv 176,48,100
tv 32,7,15488
buffer_load_dwordx4 v[68:71], v15, s[12:15], s28 offen sc1
xvv 180,48,104
tv 34,7,18048
xvv 184,48,108
buffer_load_dwordx4 v[72:75], v16, s[12:15], s28 offen sc1
xvv 188,48,112
wl 6
xvv 192,20,100
tv 36,7,20480
buffer_load_dwordx4 v[76:79], v17, s[12:15], s28 offen sc1
xvv 196,20,104
tv 38,7,23040
xvv 200,20,108
buffer_load_dwordx4 v[80:83], v18, s[12:15], s28 offen sc1
s_add_u32 m0, s26, 5120
xvv 204,20,112
wl 6
s_add_u32 s29, s27, 35840
xvv 208,24,100
tv 40,7,20512
buffer_load_dwordx4 v2, s[12:15], s29 offen offset:0 sc1 lds
xvv 212,24,104
tv 42,7,23072
xvv 216,24,108
buffer_load_dwordx4 v2, s[12:15], s29 offen offset:1024 sc1 lds
xvv 220,24,112
wl 6
xvv 224,28,100
tv 44,7,20544
buffer_load_dwordx4 v2, s[12:15], s29 offen offset:2048 sc1 lds
xvv 228,28,104
tv 46,7,23104
xvv 232,28,108
buffer_load_dwordx4 v2, s[12:15], s29 offen offset:3072 sc1 lds
s_add_u32 m0, s26, 9216
xvv 236,28,112
wl 6
xvv 240,32,100
tv 48,7,20576
buffer_load_dwordx4 v6, s[12:15], s29 offen sc1 lds
xvv 244,32,104
tv 50,7,23136
xvv 248,32,108
s_mov_b32 s28, 6144
xvv 252,32,112
wl 6
wv 14
xvv 176,36,52
tv 20,7,20608
buffer_load_dwordx4 v[84:87], v15, s[12:15], s28 offen sc1
xvv 180,36,56
tv 22,7,23168
xvv 184,36,60
buffer_load_dwordx4 v[88:91], v16, s[12:15], s28 offen sc1
xvv 188,36,64
wl 6
xvv 192,40,52
tv 24,7,25600
buffer_load_dwordx4 v[92:95], v17, s[12:15], s28 offen sc1
xvv 196,40,56
tv 26,7,28160
xvv 200,40,60
buffer_load_dwordx4 v[96:99], v18, s[12:15], s28 offen sc1
s_add_u32 m0, s26, 10240
xvv 204,40,64
wl 6
s_add_u32 s29, s27, 40960
xvv 208,44,52
tv 28,7,25632
buffer_load_dwordx4 v2, s[12:15], s29 offen offset:0 sc1 lds
xvv 212,44,56
tv 30,7,28192
xvv 216,44,60
buffer_load_dwordx4 v2, s[12:15], s29 offen offset:1024 sc1 lds
xvv 220,44,64
wl 6
xvv 224,48,52
tv 32,7,25664
buffer_load_dwordx4 v2, s[12:15], s29 offen offset:2048 sc1 lds
xvv 228,48,56
tv 34,7,28224
xvv 232,48,60
buffer_load_dwordx4 v2, s[12:15], s29 offen offset:3072 sc1 lds
s_add_u32 m0, s26, 14336
xvv 236,48,64
wl 6
xvv 240,20,52
tv 36,7,25696
buffer_load_dwordx4 v6, s[12:15], s29 offen sc1 lds
xvv 244,20,56
tv 38,7,28256
xvv 248,20,60
s_mov_b32 s28, 7168
xvv 252,20,64
wl 6
wv 14
xvv 176,24,68
tv 40,7,25728
buffer_load_dwordx4 v[100:103], v15, s[12:15], s28 offen sc1
xvv 180,24,72
tv 42,7,28288
xvv 184,24,76
buffer_load_dwordx4 v[104:107], v16, s[12:15], s28 offen sc1
xvv 188,24,80
wl 6
xvv 192,28,68
tv 44,7,0
buffer_load_dwordx4 v[108:111], v17, s[12:15], s28 offen sc1
xvv 196,28,72
tv 46,7,2560
xvv 200,28,76
buffer_load_dwordx4 v[112:115], v18, s[12:15], s28 offen sc1
s_add_u32 m0, s26, 15360
xvv 204,28,80
wl 6
s_add_u32 s29, s27, 46080
xvv 208,32,68
tv 48,7,32
buffer_load_dwordx4 v2, s[12:15], s29 offen offset:0 sc1 lds
xvv 212,32,72
tv 50,7,2592
xvv 216,32,76
buffer_load_dwordx4 v2, s[12:15], s29 offen offset:1024 sc1 lds
xvv 220,32,80
wl 6
xvv 224,36,68
tv 20,7,64
buffer_load_dwordx4 v2, s[12:15], s29 offen offset:2048 sc1 lds
xvv 228,36,72
tv 22,7,2624
xvv 232,36,76
buffer_load_dwordx4 v2, s[12:15], s29 offen offset:3072 sc1 lds
s_add_u32 m0, s26, 19456
xvv 236,36,80
wl 6
xvv 240,40,68
tv 24,7,96
buffer_load_dwordx4 v6, s[12:15], s29 offen sc1 lds
xvv 244,40,72
tv 26,7,2656
xvv 248,40,76
s_mov_b32 s28, 8192
xvv 252,40,80
wl 6
wv 14
xvv 176,44,84
tv 28,7,128
buffer_load_dwordx4 v[52:55], v15, s[12:15], s28 offen sc1
xvv 180,44,88
tv 30,7,2688
xvv 184,44,92
buffer_load_dwordx4 v[56:59], v16, s[12:15], s28 offen sc1
xvv 188,44,96
wl 6
xvv 192,48,84
tv 32,7,5120
buffer_load_dwordx4 v[60:63], v17, s[12:15], s28 offen sc1
xvv 196,48,88
tv 34,7,7680
xvv 200,48,92
buffer_load_dwordx4 v[64:67], v18, s[12:15], s28 offen sc1
s_add_u32 m0, s26, 20480
xvv 204,48,96
wl 6
s_add_u32 s29, s27, 51200
xvv 208,20,84
tv 36,7,5152
buffer_load_dwordx4 v2, s[12:15], s29 offen offset:0 sc1 lds
xvv 212,20,88
tv 38,7,7712
xvv 216,20,92
buffer_load_dwordx4 v2, s[12:15], s29 offen offset:1024 sc1 lds
xvv 220,20,96
wl 6
xvv 224,24,84
tv 40,7,5184
buffer_load_dwordx4 v2, s[12:15], s29 offen offset:2048 sc1 lds
xvv 228,24,88
tv 42,7,7744
xvv 232,24,92
buffer_load_dwordx4 v2, s[12:15], s29 offen offset:3072 sc1 lds
s_add_u32 m0, s26, 24576
xvv 236,24,96
wl 6
xvv 240,28,84
tv 44,7,5216
buffer_load_dwordx4 v6, s[12:15], s29 offen sc1 lds
xvv 244,28,88
tv 46,7,7776
xvv 248,28,92
s_mov_b32 s28, 9216
xvv 252,28,96
wl 6
wv 14
xvv 176,32,100
tv 48,7,5248
buffer_load_dwordx4 v[68:71], v15, s[12:15], s28 offen sc1
xvv 180,32,104
tv 50,7,7808
xvv 184,32,108
buffer_load_dwordx4 v[72:75], v16, s[12:15], s28 offen sc1
xvv 188,32,112
wl 6
xvv 192,36,100
tv 20,7,10240
buffer_load_dwordx4 v[76:79], v17, s[12:15], s28 offen sc1
xvv 196,36,104
tv 22,7,12800
xvv 200,36,108
buffer_load_dwordx4 v[80:83], v18, s[12:15], s28 offen sc1
s_add_u32 m0, s26, 25600
xvv 204,36,112
wl 6
s_add_u32 s29, s27, 56320
xvv 208,40,100
tv 24,7,10272
buffer_load_dwordx4 v2, s[12:15], s29 offen offset:0 sc1 lds
xvv 212,40,104
tv 26,7,12832
xvv 216,40,108
buffer_load_dwordx4 v2, s[12:15], s29 offen offset:1024 sc1 lds
xvv 220,40,112
wl 6
xvv 224,44,100
tv 28,7,10304
buffer_load_dwordx4 v2, s[12:15], s29 offen offset:2048 sc1 lds
xvv 228,44,104
tv 30,7,12864
xvv 232,44,108
buffer_load_dwordx4 v2, s[12:15], s29 offen offset:3072 sc1 lds
s_add_u32 m0, s26, 29696
xvv 236,44,112
wl 6
xvv 240,48,100
tv 32,7,10336
buffer_load_dwordx4 v6, s[12:15], s29 offen sc1 lds
xvv 244,48,104
tv 34,7,12896
xvv 248,48,108
s_mov_b32 s28, 10240
xvv 252,48,112
wl 6
wv 14
xvv 176,20,52
tv 36,7,10368
buffer_load_dwordx4 v[84:87], v15, s[12:15], s28 offen sc1
xvv 180,20,56
tv 38,7,12928
xvv 184,20,60
buffer_load_dwordx4 v[88:91], v16, s[12:15], s28 offen sc1
xvv 188,20,64
wl 6
xvv 192,24,52
tv 40,7,15360
buffer_load_dwordx4 v[92:95], v17, s[12:15], s28 offen sc1
xvv 196,24,56
tv 42,7,17920
xvv 200,24,60
buffer_load_dwordx4 v[96:99], v18, s[12:15], s28 offen sc1
xvv 204,24,64
wl 6
xvv 208,28,52
tv 44,7,15392
xvv 212,28,56
tv 46,7,17952
xvv 216,28,60
xvv 220,28,64
wl 6
xvv 224,32,52
tv 48,7,15424
xvv 228,32,56
tv 50,7,17984
xvv 232,32,60
xvv 236,32,64
wl 6
xvv 240,36,52
tv 20,7,15456
xvv 244,36,56
tv 22,7,18016
xvv 248,36,60
s_mov_b32 s28, 11264
xvv 252,36,64
wl 6
wv 9
xvv 176,40,68
tv 24,7,15488
buffer_load_dwordx4 v[100:103], v15, s[12:15], s28 offen sc1
xvv 180,40,72
tv 26,7,18048
xvv 184,40,76
buffer_load_dwordx4 v[104:107], v16, s[12:15], s28 offen sc1
xvv 188,40,80
wl 6
xvv 192,44,68
tv 28,7,20480
buffer_load_dwordx4 v[108:111], v17, s[12:15], s28 offen sc1
xvv 196,44,72
tv 30,7,23040
xvv 200,44,76
buffer_load_dwordx4 v[112:115], v18, s[12:15], s28 offen sc1
xvv 204,44,80
wl 6
xvv 208,48,68
tv 32,7,20512
xvv 212,48,72
tv 34,7,23072
xvv 216,48,76
xvv 220,48,80
wl 6
xvv 224,20,68
tv 36,7,20544
xvv 228,20,72
tv 38,7,23104
xvv 232,20,76
xvv 236,20,80
wl 6
xvv 240,24,68
tv 40,7,20576
xvv 244,24,72
tv 42,7,23136
xvv 248,24,76
xvv 252,24,80
wl 6
wv 4
xvv 176,28,84
tv 44,7,20608
xvv 180,28,88
tv 46,7,23168
xvv 184,28,92
xvv 188,28,96
wl 6
xvv 192,32,84
tv 48,7,25600
xvv 196,32,88
tv 50,7,28160
xvv 200,32,92
xvv 204,32,96
wl 6
xvv 208,36,84
tv 20,7,25632
xvv 212,36,88
tv 22,7,28192
xvv 216,36,92
xvv 220,36,96
wl 6
xvv 224,40,84
tv 24,7,25664
xvv 228,40,88
tv 26,7,28224
xvv 232,40,92
xvv 236,40,96
wl 6
xvv 240,44,84
tv 28,7,25696
xvv 244,44,88
tv 30,7,28256
xvv 248,44,92
xvv 252,44,96
wl 6
wv 0
xvv 176,48,100
tv 32,7,25728
xvv 180,48,104
tv 34,7,28288
xvv 184,48,108
xvv 188,48,112
wl 6
xvv 192,20,100
xvv 196,20,104
xvv 200,20,108
xvv 204,20,112
wl 4
xvv 208,24,100
xvv 212,24,104
xvv 216,24,108
xvv 220,24,112
wl 2
xvv 224,28,100
xvv 228,28,104
xvv 232,28,108
xvv 236,28,112
wl 0
xvv 240,32,100
xvv 244,32,104
xvv 248,32,108
xvv 252,32,112
s_barrier
s_mul_i32 s3, s23, 20480
v_add_u32 v11, s3, v10
ds_write_b128 v11, v[176:179] offset:0
ds_write_b128 v11, v[192:195] offset:1024
ds_write_b128 v11, v[208:211] offset:2048
ds_write_b128 v11, v[224:227] offset:3072
ds_write_b128 v11, v[240:243] offset:4096
ds_write_b128 v11, v[180:183] offset:5120
ds_write_b128 v11, v[196:199] offset:6144
ds_write_b128 v11, v[212:215] offset:7168
ds_write_b128 v11, v[228:231] offset:8192
ds_write_b128 v11, v[244:247] offset:9216
ds_write_b128 v11, v[184:187] offset:10240
ds_write_b128 v11, v[200:203] offset:11264
ds_write_b128 v11, v[216:219] offset:12288
ds_write_b128 v11, v[232:235] offset:13312
ds_write_b128 v11, v[248:251] offset:14336
ds_write_b128 v11, v[188:191] offset:15360
ds_write_b128 v11, v[204:207] offset:16384
ds_write_b128 v11, v[220:223] offset:17408
ds_write_b128 v11, v[236:239] offset:18432
ds_write_b128 v11, v[252:255] offset:19456
wl 0
s_barrier
s_mul_i32 s3, s23, 5120
v_add_u32 v11, s3, v10
v_add_u32 v13, 40960, v11
ds_read_b128 v[20:23], v11 offset:0
ds_read_b128 v[24:27], v11 offset:1024
ds_read_b128 v[28:31], v11 offset:2048
ds_read_b128 v[32:35], v11 offset:3072
ds_read_b128 v[36:39], v11 offset:4096
ds_read_b128 v[40:43], v11 offset:20480
ds_read_b128 v[44:47], v11 offset:21504
ds_read_b128 v[48:51], v11 offset:22528
ds_read_b128 v[52:55], v11 offset:23552
ds_read_b128 v[56:59], v11 offset:24576
ds_read_b128 v[60:63], v13 offset:0
ds_read_b128 v[64:67], v13 offset:1024
ds_read_b128 v[68:71], v13 offset:2048
ds_read_b128 v[72:75], v13 offset:3072
ds_read_b128 v[76:79], v13 offset:4096
ds_read_b128 v[80:83], v13 offset:20480
ds_read_b128 v[84:87], v13 offset:21504
ds_read_b128 v[88:91], v13 offset:22528
ds_read_b128 v[92:95], v13 offset:23552
ds_read_b128 v[96:99], v13 offset:24576
wl 14
v_add_f32 v20, v20, v40
v_add_f32 v21, v21, v41
v_add_f32 v22, v22, v42
v_add_f32 v23, v23, v43
wl 9
v_add_f32 v20, v20, v60
v_add_f32 v21, v21, v61
v_add_f32 v22, v22, v62
v_add_f32 v23, v23, v63
wl 4
v_add_f32 v20, v20, v80
v_add_f32 v21, v21, v81
v_add_f32 v22, v22, v82
v_add_f32 v23, v23, v83
v_lshlrev_b32 v148, 16, v116
v_and_b32 v149, 0xffff0000, v116
v_lshlrev_b32 v150, 16, v117
v_and_b32 v151, 0xffff0000, v117
v_fma_f32 v20, v20, v128, v148
v_fma_f32 v21, v21, v129, v149
v_fma_f32 v22, v22, v130, v150
v_fma_f32 v23, v23, v131, v151
cv 20,20,21
cv 21,22,23
buffer_store_dwordx2 v[20:21], v14, s[32:35], 0 offen offset:0
v_add_f32 v24, v24, v44
v_add_f32 v25, v25, v45
v_add_f32 v26, v26, v46
v_add_f32 v27, v27, v47
v_add_f32 v24, v24, v64
v_add_f32 v25, v25, v65
v_add_f32 v26, v26, v66
v_add_f32 v27, v27, v67
wl 3
v_add_f32 v24, v24, v84
v_add_f32 v25, v25, v85
v_add_f32 v26, v26, v86
v_add_f32 v27, v27, v87
v_lshlrev_b32 v148, 16, v118
v_and_b32 v149, 0xffff0000, v118
v_lshlrev_b32 v150, 16, v119
v_and_b32 v151, 0xffff0000, v119
v_fma_f32 v24, v24, v132, v148
v_fma_f32 v25, v25, v133, v149
v_fma_f32 v26, v26, v134, v150
v_fma_f32 v27, v27, v135, v151
cv 24,24,25
cv 25,26,27
buffer_store_dwordx2 v[24:25], v14, s[32:35], 0 offen offset:32
v_add_f32 v28, v28, v48
v_add_f32 v29, v29, v49
v_add_f32 v30, v30, v50
v_add_f32 v31, v31, v51
v_add_f32 v28, v28, v68
v_add_f32 v29, v29, v69
v_add_f32 v30, v30, v70
v_add_f32 v31, v31, v71
wl 2
v_add_f32 v28, v28, v88
v_add_f32 v29, v29, v89
v_add_f32 v30, v30, v90
v_add_f32 v31, v31, v91
v_lshlrev_b32 v148, 16, v120
v_and_b32 v149, 0xffff0000, v120
v_lshlrev_b32 v150, 16, v121
v_and_b32 v151, 0xffff0000, v121
v_fma_f32 v28, v28, v136, v148
v_fma_f32 v29, v29, v137, v149
v_fma_f32 v30, v30, v138, v150
v_fma_f32 v31, v31, v139, v151
cv 28,28,29
cv 29,30,31
buffer_store_dwordx2 v[28:29], v14, s[32:35], 0 offen offset:64
v_add_f32 v32, v32, v52
v_add_f32 v33, v33, v53
v_add_f32 v34, v34, v54
v_add_f32 v35, v35, v55
v_add_f32 v32, v32, v72
v_add_f32 v33, v33, v73
v_add_f32 v34, v34, v74
v_add_f32 v35, v35, v75
wl 1
v_add_f32 v32, v32, v92
v_add_f32 v33, v33, v93
v_add_f32 v34, v34, v94
v_add_f32 v35, v35, v95
v_lshlrev_b32 v148, 16, v122
v_and_b32 v149, 0xffff0000, v122
v_lshlrev_b32 v150, 16, v123
v_and_b32 v151, 0xffff0000, v123
v_fma_f32 v32, v32, v140, v148
v_fma_f32 v33, v33, v141, v149
v_fma_f32 v34, v34, v142, v150
v_fma_f32 v35, v35, v143, v151
cv 32,32,33
cv 33,34,35
buffer_store_dwordx2 v[32:33], v14, s[32:35], 0 offen offset:96
v_add_f32 v36, v36, v56
v_add_f32 v37, v37, v57
v_add_f32 v38, v38, v58
v_add_f32 v39, v39, v59
v_add_f32 v36, v36, v76
v_add_f32 v37, v37, v77
v_add_f32 v38, v38, v78
v_add_f32 v39, v39, v79
wl 0
v_add_f32 v36, v36, v96
v_add_f32 v37, v37, v97
v_add_f32 v38, v38, v98
v_add_f32 v39, v39, v99
v_lshlrev_b32 v148, 16, v124
v_and_b32 v149, 0xffff0000, v124
v_lshlrev_b32 v150, 16, v125
v_and_b32 v151, 0xffff0000, v125
v_fma_f32 v36, v36, v144, v148
v_fma_f32 v37, v37, v145, v149
v_fma_f32 v38, v38, v146, v150
v_fma_f32 v39, v39, v147, v151
cv 36,36,37
cv 37,38,39
buffer_store_dwordx2 v[36:37], v14, s[32:35], 0 offen offset:128
KT_END:
s_endpgm
K_TEXT_END:
K2_SAFE:
wv 0
s_barrier
s_lshl_b32 s3, s26, 6
v_add_u32 v0, s3, v0
s_load_dwordx2 s[4:5], s[0:1], 24
s_load_dwordx2 s[6:7], s[0:1], 104
s_load_dwordx4 s[44:47], s[0:1], 8
s_load_dwordx2 s[68:69], s[0:1], 32
s_load_dwordx4 s[72:75], s[0:1], 48
s_load_dwordx2 s[70:71], s[0:1], 64
v_lshrrev_b32 v2, 6, v0
v_and_b32 v0, 63, v0
v_readfirstlane_b32 s26, v2
s_and_b32 s24, s2, 7
s_lshl_b32 s24, s24, 2
s_lshr_b32 s3, s2, 3
s_and_b32 s3, s3, 3
s_add_u32 s24, s24, s3
s_lshr_b32 s25, s2, 5
v_lshrrev_b32 v60, 3, v0
v_and_b32 v61, 7, v0
v_lshrrev_b32 v62, 4, v0
v_lshlrev_b32 v63, 1, v62
v_xor_b32 v63, v63, v61
v_lshlrev_b32 v63, 4, v63
s_lshl_b32 s3, s26, 3
v_add_u32 v1, s3, v60
s_mov_b32 s37, 12288
v_mul_lo_u32 v1, v1, s37
v_add_u32 v1, v1, v63
v_add_u32 v1, 4096, v1
v_add_u32 v2, -896, v1
v_add_u32 v3, -1792, v1
s_lshl_b32 s3, s25, 4
s_lshl_b32 s37, s26, 2
s_add_u32 s38, s3, s37
s_mul_i32 s3, s38, 20480
s_add_u32 s3, s3, 262144
v_lshlrev_b32 v23, 4, v0
v_add_u32 v23, s3, v23
v_add_u32 v24, 20480, v23
v_add_u32 v25, 40960, v23
v_add_u32 v26, 61440, v23
s_mul_i32 s27, s26, 3072
s_mul_i32 s3, s24, 384
wl 0
wl 0
s_add_u32 s8, s4, s3
s_addc_u32 s9, s5, 0
s_sub_u32 s8, s8, 4096
s_subb_u32 s9, s9, 0
s_sub_u32 s10, 7868416, s3
s_mov_b32 s11, 0x20000
s_mov_b32 s20, s6
s_mov_b32 s21, s7
s_mov_b32 s22, 268435456
s_mov_b32 s23, 0x20000
s_mov_b32 s31, 0
buffer_load_dwordx4 a[0:3], v23, s[20:23], s31 offen
buffer_load_dwordx4 a[4:7], v24, s[20:23], s31 offen
buffer_load_dwordx4 a[8:11], v25, s[20:23], s31 offen
buffer_load_dwordx4 a[12:15], v26, s[20:23], s31 offen
s_add_u32 m0, s27, 0
s_mov_b32 s30, 0
dm 1,8,30,0
dm 2,8,30,1024
dm 3,8,30,2048
v_lshrrev_b32 v60, 2, v0
v_and_b32 v60, 3, v60
v_and_b32 v61, 3, v0
v_lshlrev_b32 v61, 3, v61
v_and_b32 v11, 1, v62
v_lshlrev_b32 v11, 2, v11
v_add_u32 v11, v11, v60
v_lshrrev_b32 v12, 1, v11
v_lshlrev_b32 v11, 7, v11
v_lshrrev_b32 v13, 1, v62
v_mul_u32_u24 v13, 3072, v13
v_add_u32 v11, v11, v13
v_add_u32 v11, v11, v61
v_lshlrev_b32 v12, 5, v12
v_xor_b32 v63, 96, v12
v_add_u32 v14, v11, v63
v_xor_b32 v63, 64, v12
v_add_u32 v13, v11, v63
v_xor_b32 v63, 32, v12
v_add_u32 v63, v11, v63
v_add_u32 v11, v11, v12
v_mov_b32 v12, v63
v_lshrrev_b32 v19, 1, v62
v_lshlrev_b32 v19, 2, v19
v_add_u32 v19, v19, v60
v_lshrrev_b32 v20, 1, v19
v_and_b32 v20, 1, v20
v_and_b32 v21, 1, v62
v_lshlrev_b32 v22, 1, v21
v_or_b32 v20, v20, v22
v_lshlrev_b32 v20, 5, v20
v_lshlrev_b32 v19, 7, v19
v_lshlrev_b32 v21, 10, v21
v_add_u32 v19, v19, v21
v_add_u32 v19, v19, v61
v_add_u32 v19, 98304, v19
v_xor_b32 v63, 96, v20
v_add_u32 v22, v19, v63
v_xor_b32 v63, 64, v20
v_add_u32 v21, v19, v63
v_xor_b32 v63, 32, v20
v_add_u32 v63, v19, v63
v_add_u32 v19, v19, v20
v_mov_b32 v20, v63
s_add_u32 s28, s27, 36864
s_lshl_b32 s29, s26, 12
s_add_u32 s29, s29, 98304
s_mul_i32 s3, s24, 786432
s_add_u32 s3, s3, 585728
s_add_u32 s12, s44, s3
s_addc_u32 s13, s45, 0
s_mov_b32 s14, 200704
s_mov_b32 s15, 0x20000
s_add_u32 s16, s46, s3
s_addc_u32 s17, s47, 0
s_mov_b32 s18, 200704
s_mov_b32 s19, 0x20000
s_mov_b32 s52, s68
s_mov_b32 s53, s69
s_mov_b32 s54, 7864320
s_mov_b32 s55, 0x20000
s_mov_b32 s56, s72
s_mov_b32 s57, s73
s_mov_b32 s58, 1966080
s_mov_b32 s59, 0x20000
s_mov_b32 s60, s74
s_mov_b32 s61, s75
s_mov_b32 s62, 1966080
s_mov_b32 s63, 0x20000
s_mov_b32 s64, s70
s_mov_b32 s65, s71
s_mov_b32 s66, 1966080
s_mov_b32 s67, 0x20000
s_add_u32 m0, s27, 12288
s_mov_b32 s30, 393216
dm 1,8,30,0
dm 2,8,30,1024
dm 3,8,30,2048
s_mov_b32 s31, 1024
buffer_load_dwordx4 a[16:19], v23, s[20:23], s31 offen
buffer_load_dwordx4 a[20:23], v24, s[20:23], s31 offen
buffer_load_dwordx4 a[24:27], v25, s[20:23], s31 offen
buffer_load_dwordx4 a[28:31], v26, s[20:23], s31 offen
s_add_u32 m0, s27, 24576
s_mov_b32 s30, 786432
dm 1,8,30,0
dm 2,8,30,1024
dm 3,8,30,2048
s_add_u32 m0, s27, 36864
s_mov_b32 s30, 1179648
dm 1,8,30,0
dm 2,8,30,1024
dm 3,8,30,2048
wv 13
s_barrier
ta 192,11,0
ta 194,11,6144
ta 196,12,0
ta 198,12,6144
ta 200,13,0
ta 202,13,6144
ta 204,14,0
ta 206,14,6144
wl 6
v_mfma_f32_16x16x32_bf16 v[64:67], a[192:195], a[0:3], 0
s_mov_b32 s31, 2048
ta 208,11,1024
v_lshrrev_b32 v56, 3, v0
v_mfma_f32_16x16x32_bf16 v[68:71], a[192:195], a[4:7], 0
ta 210,11,7168
v_and_b32 v57, 7, v0
v_mfma_f32_16x16x32_bf16 v[72:75], a[192:195], a[8:11], 0
buffer_load_dwordx4 a[32:35], v23, s[20:23], s31 offen
v_lshrrev_b32 v58, 4, v0
v_mfma_f32_16x16x32_bf16 v[76:79], a[192:195], a[12:15], 0
wl 6
s_lshl_b32 s3, s26, 3
v_add_u32 v4, s3, v56
v_mfma_f32_16x16x32_bf16 v[80:83], a[196:199], a[0:3], 0
ta 212,12,1024
v_lshrrev_b32 v59, 1, v4
v_mfma_f32_16x16x32_bf16 v[84:87], a[196:199], a[4:7], 0
ta 214,12,7168
v_and_b32 v59, 7, v59
v_mfma_f32_16x16x32_bf16 v[88:91], a[196:199], a[8:11], 0
buffer_load_dwordx4 a[36:39], v24, s[20:23], s31 offen
v_xor_b32 v59, v59, v57
v_mfma_f32_16x16x32_bf16 v[92:95], a[196:199], a[12:15], 0
wl 6
v_lshlrev_b32 v59, 4, v59
v_mul_u32_u24 v4, 384, v4
v_mfma_f32_16x16x32_bf16 v[96:99], a[200:203], a[0:3], 0
ta 216,13,1024
v_add_u32 v4, v4, v59
v_mfma_f32_16x16x32_bf16 v[100:103], a[200:203], a[4:7], 0
ta 218,13,7168
v_add_u32 v4, 4096, v4
v_mfma_f32_16x16x32_bf16 v[104:107], a[200:203], a[8:11], 0
buffer_load_dwordx4 a[40:43], v25, s[20:23], s31 offen
v_add_u32 v5, -896, v4
v_mfma_f32_16x16x32_bf16 v[108:111], a[200:203], a[12:15], 0
wl 6
v_add_u32 v6, -1792, v4
v_and_b32 v59, 1, v58
v_mfma_f32_16x16x32_bf16 v[112:115], a[204:207], a[0:3], 0
ta 220,14,1024
v_lshlrev_b32 v59, 1, v59
v_mfma_f32_16x16x32_bf16 v[116:119], a[204:207], a[4:7], 0
ta 222,14,7168
v_xor_b32 v59, v59, v57
v_mfma_f32_16x16x32_bf16 v[120:123], a[204:207], a[8:11], 0
buffer_load_dwordx4 a[44:47], v26, s[20:23], s31 offen
s_lshl_b32 s3, s26, 5
v_mfma_f32_16x16x32_bf16 v[124:127], a[204:207], a[12:15], 0
wl 6
v_add_u32 v7, s3, v56
v_mul_u32_u24 v7, 384, v7
v_mfma_f32_16x16x32_bf16 v[128:131], a[208:211], a[0:3], 0
ta 224,11,2048
v_add_u32 v7, 4096, v7
v_mfma_f32_16x16x32_bf16 v[132:135], a[208:211], a[4:7], 0
ta 226,11,8192
v_xor_b32 v8, 4, v59
v_mfma_f32_16x16x32_bf16 v[136:139], a[208:211], a[8:11], 0
v_lshlrev_b32 v8, 4, v8
v_lshlrev_b32 v59, 4, v59
v_mfma_f32_16x16x32_bf16 v[140:143], a[208:211], a[12:15], 0
wl 6
v_add_u32 v8, v8, v7
v_add_u32 v7, v7, v59
v_mfma_f32_16x16x32_bf16 v[144:147], a[212:215], a[0:3], 0
ta 228,12,2048
v_add_u32 v9, 4096, v7
v_mfma_f32_16x16x32_bf16 v[148:151], a[212:215], a[4:7], 0
ta 230,12,8192
v_add_u32 v10, 6144, v8
v_mfma_f32_16x16x32_bf16 v[152:155], a[212:215], a[8:11], 0
v_add_u32 v8, 2048, v8
v_and_b32 v56, 31, v0
v_mfma_f32_16x16x32_bf16 v[156:159], a[212:215], a[12:15], 0
wl 6
v_lshrrev_b32 v57, 3, v56
v_mul_u32_u24 v57, 3072, v57
v_mfma_f32_16x16x32_bf16 v[160:163], a[216:219], a[0:3], 0
ta 232,13,2048
v_and_b32 v59, 7, v56
v_mfma_f32_16x16x32_bf16 v[164:167], a[216:219], a[4:7], 0
ta 234,13,8192
v_lshlrev_b32 v59, 7, v59
v_mfma_f32_16x16x32_bf16 v[168:171], a[216:219], a[8:11], 0
v_add_u32 v57, v57, v59
v_add_u32 v57, 36864, v57
v_mfma_f32_16x16x32_bf16 v[172:175], a[216:219], a[12:15], 0
wl 6
v_lshrrev_b32 v56, 1, v56
v_and_b32 v56, 7, v56
v_mfma_f32_16x16x32_bf16 v[176:179], a[220:223], a[0:3], 0
ta 236,14,2048
v_lshrrev_b32 v59, 5, v0
v_mfma_f32_16x16x32_bf16 v[180:183], a[220:223], a[4:7], 0
ta 238,14,8192
s_add_u32 m0, s27, 49152
v_mfma_f32_16x16x32_bf16 v[184:187], a[220:223], a[8:11], 0
s_mov_b32 s30, 1572864
v_xor_b32 v56, v56, v59
v_xor_b32 v59, 0, v56
v_mfma_f32_16x16x32_bf16 v[188:191], a[220:223], a[12:15], 0
wl 6
wv 14
s_barrier
v_mfma_f32_16x16x32_bf16 v[192:195], a[224:227], a[0:3], 0
ta 240,11,12288
v_lshlrev_b32 v59, 4, v59
v_mfma_f32_16x16x32_bf16 v[196:199], a[224:227], a[4:7], 0
ta 242,11,18432
v_add_u32 v15, v57, v59
v_mfma_f32_16x16x32_bf16 v[200:203], a[224:227], a[8:11], 0
dm 1,8,30,0
v_xor_b32 v59, 2, v56
v_mfma_f32_16x16x32_bf16 v[204:207], a[224:227], a[12:15], 0
wl 6
v_lshlrev_b32 v59, 4, v59
v_add_u32 v16, v57, v59
v_mfma_f32_16x16x32_bf16 v[208:211], a[228:231], a[0:3], 0
ta 244,12,12288
v_xor_b32 v59, 4, v56
v_mfma_f32_16x16x32_bf16 v[212:215], a[228:231], a[4:7], 0
ta 246,12,18432
v_lshlrev_b32 v59, 4, v59
v_mfma_f32_16x16x32_bf16 v[216:219], a[228:231], a[8:11], 0
dm 2,8,30,1024
v_add_u32 v17, v57, v59
v_mfma_f32_16x16x32_bf16 v[220:223], a[228:231], a[12:15], 0
wl 6
v_xor_b32 v59, 6, v56
v_lshlrev_b32 v59, 4, v59
v_mfma_f32_16x16x32_bf16 v[224:227], a[232:235], a[0:3], 0
ta 248,13,12288
v_add_u32 v18, v57, v59
v_mfma_f32_16x16x32_bf16 v[228:231], a[232:235], a[4:7], 0
ta 250,13,18432
v_lshlrev_b32 v27, 7, v0
v_mfma_f32_16x16x32_bf16 v[232:235], a[232:235], a[8:11], 0
dm 3,8,30,2048
v_mov_b32 v59, 0x7ff00000
v_mfma_f32_16x16x32_bf16 v[236:239], a[232:235], a[12:15], 0
wl 6
v_cmp_gt_u32 vcc, 16, v0
v_mfma_f32_16x16x32_bf16 v[240:243], a[236:239], a[0:3], 0
ta 252,14,12288
v_mfma_f32_16x16x32_bf16 v[244:247], a[236:239], a[4:7], 0
ta 254,14,18432
s_mov_b32 s31, 3072
v_mfma_f32_16x16x32_bf16 v[248:251], a[236:239], a[8:11], 0
s_nop 1
v_cndmask_b32 v27, v59, v27, vcc
v_mfma_f32_16x16x32_bf16 v[252:255], a[236:239], a[12:15], 0
wl 6
wv 13
s_mul_i32 s96, s25, 24576
xaa 64,240,16
ta 192,11,13312
s_mul_i32 s99, s26, 6144
xaa 68,240,20
ta 194,11,19456
s_add_u32 s96, s96, s99
xaa 72,240,24
buffer_load_dwordx4 a[0:3], v23, s[20:23], s31 offen
s_add_u32 s96, s96, 4096
xaa 76,240,28
wl 6
s_lshl_b32 s99, s2, 2
s_add_u32 s99, s99, s26
xaa 80,244,16
ta 196,12,13312
s_mul_i32 s98, s99, 1920
xaa 84,244,20
ta 198,12,19456
s_and_b32 s97, s2, 3
xaa 88,244,24
buffer_load_dwordx4 a[4:7], v24, s[20:23], s31 offen
s_mul_i32 s97, s97, 1966080
xaa 92,244,28
wl 6
s_lshr_b32 s99, s2, 3
s_lshl_b32 s99, s99, 2
xaa 96,248,16
ta 200,13,13312
s_add_u32 s99, s99, s26
xaa 100,248,20
ta 202,13,19456
s_mul_i32 s99, s99, 15360
xaa 104,248,24
buffer_load_dwordx4 a[8:11], v25, s[20:23], s31 offen
s_add_u32 s97, s97, s99
xaa 108,248,28
wl 6
xaa 112,252,16
ta 204,14,13312
xaa 116,252,20
ta 206,14,19456
xaa 120,252,24
buffer_load_dwordx4 a[12:15], v26, s[20:23], s31 offen
xaa 124,252,28
wl 6
xaa 128,192,16
ta 208,11,14336
xaa 132,192,20
ta 210,11,20480
xaa 136,192,24
xaa 140,192,28
wl 6
xaa 144,196,16
ta 212,12,14336
xaa 148,196,20
ta 214,12,20480
xaa 152,196,24
xaa 156,196,28
wl 6
xaa 160,200,16
ta 216,13,14336
xaa 164,200,20
ta 218,13,20480
xaa 168,200,24
xaa 172,200,28
wl 6
xaa 176,204,16
ta 220,14,14336
xaa 180,204,20
ta 222,14,20480
s_add_u32 m0, s27, 0
xaa 184,204,24
s_mov_b32 s30, 1966080
xaa 188,204,28
wl 6
wv 14
s_barrier
xaa 192,208,16
ta 224,11,24576
xaa 196,208,20
ta 226,11,30720
xaa 200,208,24
dm 1,8,30,0
xaa 204,208,28
wl 6
xaa 208,212,16
ta 228,12,24576
xaa 212,212,20
ta 230,12,30720
xaa 216,212,24
dm 2,8,30,1024
xaa 220,212,28
wl 6
xaa 224,216,16
ta 232,13,24576
xaa 228,216,20
ta 234,13,30720
xaa 232,216,24
dm 3,8,30,2048
xaa 236,216,28
wl 6
xaa 240,220,16
ta 236,14,24576
xaa 244,220,20
ta 238,14,30720
s_mov_b32 s31, 4096
xaa 248,220,24
xaa 252,220,28
wl 6
wv 10
xaa 64,224,32
ta 240,11,25600
xaa 68,224,36
ta 242,11,31744
xaa 72,224,40
buffer_load_dwordx4 a[16:19], v23, s[20:23], s31 offen
xaa 76,224,44
wl 6
xaa 80,228,32
ta 244,12,25600
xaa 84,228,36
ta 246,12,31744
xaa 88,228,40
buffer_load_dwordx4 a[20:23], v24, s[20:23], s31 offen
xaa 92,228,44
wl 6
xaa 96,232,32
ta 248,13,25600
xaa 100,232,36
ta 250,13,31744
xaa 104,232,40
buffer_load_dwordx4 a[24:27], v25, s[20:23], s31 offen
xaa 108,232,44
wl 6
xaa 112,236,32
ta 252,14,25600
xaa 116,236,36
ta 254,14,31744
xaa 120,236,40
buffer_load_dwordx4 a[28:31], v26, s[20:23], s31 offen
xaa 124,236,44
wl 6
xaa 128,240,32
ta 192,11,26624
xaa 132,240,36
ta 194,11,32768
xaa 136,240,40
xaa 140,240,44
wl 6
xaa 144,244,32
ta 196,12,26624
xaa 148,244,36
ta 198,12,32768
xaa 152,244,40
xaa 156,244,44
wl 6
xaa 160,248,32
ta 200,13,26624
xaa 164,248,36
ta 202,13,32768
xaa 168,248,40
xaa 172,248,44
wl 6
xaa 176,252,32
ta 204,14,26624
xaa 180,252,36
ta 206,14,32768
s_add_u32 m0, s27, 12288
xaa 184,252,40
s_mov_b32 s30, 2359296
xaa 188,252,44
wl 6
s_barrier
xaa 192,192,32
ta 208,11,36864
xaa 196,192,36
ta 210,11,43008
xaa 200,192,40
dm 1,8,30,0
xaa 204,192,44
wl 6
xaa 208,196,32
ta 212,12,36864
xaa 212,196,36
ta 214,12,43008
xaa 216,196,40
dm 2,8,30,1024
xaa 220,196,44
wl 6
xaa 224,200,32
ta 216,13,36864
xaa 228,200,36
ta 218,13,43008
xaa 232,200,40
dm 3,8,30,2048
xaa 236,200,44
wl 6
xaa 240,204,32
ta 220,14,36864
xaa 244,204,36
ta 222,14,43008
s_mov_b32 s31, 5120
xaa 248,204,40
xaa 252,204,44
wl 6
wv 10
xaa 64,208,0
ta 224,11,37888
xaa 68,208,4
ta 226,11,44032
xaa 72,208,8
buffer_load_dwordx4 a[32:35], v23, s[20:23], s31 offen
xaa 76,208,12
wl 6
xaa 80,212,0
ta 228,12,37888
xaa 84,212,4
ta 230,12,44032
xaa 88,212,8
buffer_load_dwordx4 a[36:39], v24, s[20:23], s31 offen
xaa 92,212,12
wl 6
xaa 96,216,0
ta 232,13,37888
xaa 100,216,4
ta 234,13,44032
xaa 104,216,8
buffer_load_dwordx4 a[40:43], v25, s[20:23], s31 offen
xaa 108,216,12
wl 6
xaa 112,220,0
ta 236,14,37888
xaa 116,220,4
ta 238,14,44032
xaa 120,220,8
buffer_load_dwordx4 a[44:47], v26, s[20:23], s31 offen
xaa 124,220,12
wl 6
xaa 128,224,0
ta 240,11,38912
xaa 132,224,4
ta 242,11,45056
xaa 136,224,8
xaa 140,224,12
wl 6
xaa 144,228,0
ta 244,12,38912
xaa 148,228,4
ta 246,12,45056
xaa 152,228,8
xaa 156,228,12
wl 6
xaa 160,232,0
ta 248,13,38912
xaa 164,232,4
ta 250,13,45056
xaa 168,232,8
xaa 172,232,12
wl 6
xaa 176,236,0
ta 252,14,38912
xaa 180,236,4
ta 254,14,45056
s_add_u32 m0, s27, 24576
xaa 184,236,8
s_mov_b32 s30, 2752512
xaa 188,236,12
wl 6
s_barrier
xaa 192,240,0
ta 192,11,49152
xaa 196,240,4
ta 194,11,55296
xaa 200,240,8
dm 1,8,30,0
xaa 204,240,12
wl 6
xaa 208,244,0
ta 196,12,49152
xaa 212,244,4
ta 198,12,55296
xaa 216,244,8
dm 2,8,30,1024
xaa 220,244,12
wl 6
xaa 224,248,0
ta 200,13,49152
xaa 228,248,4
ta 202,13,55296
xaa 232,248,8
dm 3,8,30,2048
xaa 236,248,12
wl 6
xaa 240,252,0
ta 204,14,49152
xaa 244,252,4
ta 206,14,55296
s_mov_b32 s31, 6144
xaa 248,252,8
xaa 252,252,12
wl 6
wv 10
xaa 64,192,16
ta 208,11,50176
xaa 68,192,20
ta 210,11,56320
xaa 72,192,24
buffer_load_dwordx4 a[0:3], v23, s[20:23], s31 offen
xaa 76,192,28
wl 6
xaa 80,196,16
ta 212,12,50176
xaa 84,196,20
ta 214,12,56320
xaa 88,196,24
buffer_load_dwordx4 a[4:7], v24, s[20:23], s31 offen
xaa 92,196,28
wl 6
xaa 96,200,16
ta 216,13,50176
xaa 100,200,20
ta 218,13,56320
xaa 104,200,24
buffer_load_dwordx4 a[8:11], v25, s[20:23], s31 offen
xaa 108,200,28
wl 6
xaa 112,204,16
ta 220,14,50176
xaa 116,204,20
ta 222,14,56320
xaa 120,204,24
buffer_load_dwordx4 a[12:15], v26, s[20:23], s31 offen
xaa 124,204,28
wl 6
xaa 128,208,16
ta 224,11,51200
xaa 132,208,20
ta 226,11,57344
xaa 136,208,24
xaa 140,208,28
wl 6
xaa 144,212,16
ta 228,12,51200
xaa 148,212,20
ta 230,12,57344
xaa 152,212,24
xaa 156,212,28
wl 6
xaa 160,216,16
ta 232,13,51200
xaa 164,216,20
ta 234,13,57344
xaa 168,216,24
xaa 172,216,28
wl 6
xaa 176,220,16
ta 236,14,51200
xaa 180,220,20
ta 238,14,57344
s_add_u32 m0, s27, 36864
xaa 184,220,24
s_mov_b32 s30, 3145728
xaa 188,220,28
wl 6
s_barrier
xaa 192,224,16
ta 240,11,0
xaa 196,224,20
ta 242,11,6144
xaa 200,224,24
dm 1,8,30,0
xaa 204,224,28
wl 6
xaa 208,228,16
ta 244,12,0
xaa 212,228,20
ta 246,12,6144
xaa 216,228,24
dm 2,8,30,1024
xaa 220,228,28
wl 6
xaa 224,232,16
ta 248,13,0
xaa 228,232,20
ta 250,13,6144
xaa 232,232,24
dm 3,8,30,2048
xaa 236,232,28
wl 6
xaa 240,236,16
ta 252,14,0
xaa 244,236,20
ta 254,14,6144
s_mov_b32 s31, 7168
xaa 248,236,24
xaa 252,236,28
wl 6
wv 10
xaa 64,240,32
ta 192,11,1024
xaa 68,240,36
ta 194,11,7168
xaa 72,240,40
buffer_load_dwordx4 a[16:19], v23, s[20:23], s31 offen
xaa 76,240,44
wl 6
xaa 80,244,32
ta 196,12,1024
xaa 84,244,36
ta 198,12,7168
xaa 88,244,40
buffer_load_dwordx4 a[20:23], v24, s[20:23], s31 offen
xaa 92,244,44
wl 6
xaa 96,248,32
ta 200,13,1024
xaa 100,248,36
ta 202,13,7168
xaa 104,248,40
buffer_load_dwordx4 a[24:27], v25, s[20:23], s31 offen
xaa 108,248,44
wl 6
xaa 112,252,32
ta 204,14,1024
xaa 116,252,36
ta 206,14,7168
xaa 120,252,40
buffer_load_dwordx4 a[28:31], v26, s[20:23], s31 offen
xaa 124,252,44
wl 6
xaa 128,192,32
ta 208,11,2048
xaa 132,192,36
ta 210,11,8192
xaa 136,192,40
xaa 140,192,44
wl 6
xaa 144,196,32
ta 212,12,2048
xaa 148,196,36
ta 214,12,8192
xaa 152,196,40
xaa 156,196,44
wl 6
xaa 160,200,32
ta 216,13,2048
xaa 164,200,36
ta 218,13,8192
xaa 168,200,40
xaa 172,200,44
wl 6
xaa 176,204,32
ta 220,14,2048
xaa 180,204,36
ta 222,14,8192
s_add_u32 m0, s27, 49152
xaa 184,204,40
s_mov_b32 s30, 3538944
xaa 188,204,44
wl 6
s_barrier
xaa 192,208,32
ta 224,11,12288
xaa 196,208,36
ta 226,11,18432
xaa 200,208,40
dm 1,8,30,0
xaa 204,208,44
wl 6
xaa 208,212,32
ta 228,12,12288
xaa 212,212,36
ta 230,12,18432
xaa 216,212,40
dm 2,8,30,1024
xaa 220,212,44
wl 6
xaa 224,216,32
ta 232,13,12288
xaa 228,216,36
ta 234,13,18432
xaa 232,216,40
dm 3,8,30,2048
xaa 236,216,44
wl 6
xaa 240,220,32
ta 236,14,12288
xaa 244,220,36
ta 238,14,18432
s_mov_b32 s31, 8192
xaa 248,220,40
xaa 252,220,44
wl 6
wv 10
xaa 64,224,0
ta 240,11,13312
xaa 68,224,4
ta 242,11,19456
xaa 72,224,8
buffer_load_dwordx4 a[32:35], v23, s[20:23], s31 offen
xaa 76,224,12
wl 6
xaa 80,228,0
ta 244,12,13312
xaa 84,228,4
ta 246,12,19456
xaa 88,228,8
buffer_load_dwordx4 a[36:39], v24, s[20:23], s31 offen
xaa 92,228,12
wl 6
xaa 96,232,0
ta 248,13,13312
xaa 100,232,4
ta 250,13,19456
xaa 104,232,8
buffer_load_dwordx4 a[40:43], v25, s[20:23], s31 offen
xaa 108,232,12
wl 6
xaa 112,236,0
ta 252,14,13312
xaa 116,236,4
ta 254,14,19456
xaa 120,236,8
buffer_load_dwordx4 a[44:47], v26, s[20:23], s31 offen
xaa 124,236,12
wl 6
xaa 128,240,0
ta 192,11,14336
xaa 132,240,4
ta 194,11,20480
xaa 136,240,8
xaa 140,240,12
wl 6
xaa 144,244,0
ta 196,12,14336
xaa 148,244,4
ta 198,12,20480
xaa 152,244,8
xaa 156,244,12
wl 6
xaa 160,248,0
ta 200,13,14336
xaa 164,248,4
ta 202,13,20480
xaa 168,248,8
xaa 172,248,12
wl 6
xaa 176,252,0
ta 204,14,14336
xaa 180,252,4
ta 206,14,20480
s_add_u32 m0, s27, 0
xaa 184,252,8
s_mov_b32 s30, 3932160
xaa 188,252,12
wl 6
s_barrier
xaa 192,192,0
ta 208,11,24576
xaa 196,192,4
ta 210,11,30720
xaa 200,192,8
dm 1,8,30,0
xaa 204,192,12
wl 6
xaa 208,196,0
ta 212,12,24576
xaa 212,196,4
ta 214,12,30720
xaa 216,196,8
dm 2,8,30,1024
xaa 220,196,12
wl 6
xaa 224,200,0
ta 216,13,24576
xaa 228,200,4
ta 218,13,30720
xaa 232,200,8
dm 3,8,30,2048
xaa 236,200,12
wl 6
xaa 240,204,0
ta 220,14,24576
xaa 244,204,4
ta 222,14,30720
s_mov_b32 s31, 9216
xaa 248,204,8
xaa 252,204,12
wl 6
wv 10
xaa 64,208,16
ta 224,11,25600
xaa 68,208,20
ta 226,11,31744
xaa 72,208,24
buffer_load_dwordx4 a[0:3], v23, s[20:23], s31 offen
xaa 76,208,28
wl 6
xaa 80,212,16
ta 228,12,25600
xaa 84,212,20
ta 230,12,31744
xaa 88,212,24
buffer_load_dwordx4 a[4:7], v24, s[20:23], s31 offen
xaa 92,212,28
wl 6
xaa 96,216,16
ta 232,13,25600
xaa 100,216,20
ta 234,13,31744
xaa 104,216,24
buffer_load_dwordx4 a[8:11], v25, s[20:23], s31 offen
xaa 108,216,28
wl 6
xaa 112,220,16
ta 236,14,25600
xaa 116,220,20
ta 238,14,31744
xaa 120,220,24
buffer_load_dwordx4 a[12:15], v26, s[20:23], s31 offen
xaa 124,220,28
wl 6
xaa 128,224,16
ta 240,11,26624
xaa 132,224,20
ta 242,11,32768
xaa 136,224,24
xaa 140,224,28
wl 6
xaa 144,228,16
ta 244,12,26624
xaa 148,228,20
ta 246,12,32768
xaa 152,228,24
xaa 156,228,28
wl 6
xaa 160,232,16
ta 248,13,26624
xaa 164,232,20
ta 250,13,32768
xaa 168,232,24
xaa 172,232,28
wl 6
xaa 176,236,16
ta 252,14,26624
xaa 180,236,20
ta 254,14,32768
s_add_u32 m0, s27, 12288
xaa 184,236,24
s_mov_b32 s30, 4325376
xaa 188,236,28
wl 6
s_barrier
xaa 192,240,16
ta 192,11,36864
xaa 196,240,20
ta 194,11,43008
xaa 200,240,24
dm 1,8,30,0
xaa 204,240,28
wl 6
xaa 208,244,16
ta 196,12,36864
xaa 212,244,20
ta 198,12,43008
xaa 216,244,24
dm 2,8,30,1024
xaa 220,244,28
wl 6
xaa 224,248,16
ta 200,13,36864
xaa 228,248,20
ta 202,13,43008
xaa 232,248,24
dm 3,8,30,2048
xaa 236,248,28
wl 6
xaa 240,252,16
ta 204,14,36864
xaa 244,252,20
ta 206,14,43008
s_mov_b32 s31, 10240
xaa 248,252,24
xaa 252,252,28
wl 6
wv 10
xaa 64,192,32
ta 208,11,37888
xaa 68,192,36
ta 210,11,44032
xaa 72,192,40
buffer_load_dwordx4 a[16:19], v23, s[20:23], s31 offen
xaa 76,192,44
wl 6
xaa 80,196,32
ta 212,12,37888
xaa 84,196,36
ta 214,12,44032
xaa 88,196,40
buffer_load_dwordx4 a[20:23], v24, s[20:23], s31 offen
xaa 92,196,44
wl 6
xaa 96,200,32
ta 216,13,37888
xaa 100,200,36
ta 218,13,44032
xaa 104,200,40
buffer_load_dwordx4 a[24:27], v25, s[20:23], s31 offen
xaa 108,200,44
wl 6
xaa 112,204,32
ta 220,14,37888
xaa 116,204,36
ta 222,14,44032
xaa 120,204,40
buffer_load_dwordx4 a[28:31], v26, s[20:23], s31 offen
xaa 124,204,44
wl 6
xaa 128,208,32
ta 224,11,38912
xaa 132,208,36
ta 226,11,45056
xaa 136,208,40
xaa 140,208,44
wl 6
xaa 144,212,32
ta 228,12,38912
xaa 148,212,36
ta 230,12,45056
xaa 152,212,40
xaa 156,212,44
wl 6
xaa 160,216,32
ta 232,13,38912
xaa 164,216,36
ta 234,13,45056
xaa 168,216,40
xaa 172,216,44
wl 6
xaa 176,220,32
ta 236,14,38912
xaa 180,220,36
ta 238,14,45056
s_add_u32 m0, s27, 24576
xaa 184,220,40
s_mov_b32 s30, 4718592
xaa 188,220,44
wl 6
s_barrier
xaa 192,224,32
ta 240,11,49152
xaa 196,224,36
ta 242,11,55296
xaa 200,224,40
dm 1,8,30,0
xaa 204,224,44
wl 6
xaa 208,228,32
ta 244,12,49152
xaa 212,228,36
ta 246,12,55296
xaa 216,228,40
dm 2,8,30,1024
xaa 220,228,44
wl 6
xaa 224,232,32
ta 248,13,49152
xaa 228,232,36
ta 250,13,55296
xaa 232,232,40
dm 3,8,30,2048
xaa 236,232,44
wl 6
xaa 240,236,32
ta 252,14,49152
xaa 244,236,36
ta 254,14,55296
s_mov_b32 s31, 11264
xaa 248,236,40
xaa 252,236,44
wl 6
wv 10
xaa 64,240,0
ta 192,11,50176
xaa 68,240,4
ta 194,11,56320
xaa 72,240,8
buffer_load_dwordx4 a[32:35], v23, s[20:23], s31 offen
xaa 76,240,12
wl 6
xaa 80,244,0
ta 196,12,50176
xaa 84,244,4
ta 198,12,56320
xaa 88,244,8
buffer_load_dwordx4 a[36:39], v24, s[20:23], s31 offen
xaa 92,244,12
wl 6
xaa 96,248,0
ta 200,13,50176
xaa 100,248,4
ta 202,13,56320
xaa 104,248,8
buffer_load_dwordx4 a[40:43], v25, s[20:23], s31 offen
xaa 108,248,12
wl 6
xaa 112,252,0
ta 204,14,50176
xaa 116,252,4
ta 206,14,56320
xaa 120,252,8
buffer_load_dwordx4 a[44:47], v26, s[20:23], s31 offen
xaa 124,252,12
wl 6
xaa 128,192,0
ta 208,11,51200
xaa 132,192,4
ta 210,11,57344
xaa 136,192,8
xaa 140,192,12
wl 6
xaa 144,196,0
ta 212,12,51200
xaa 148,196,4
ta 214,12,57344
xaa 152,196,8
xaa 156,196,12
wl 6
xaa 160,200,0
ta 216,13,51200
xaa 164,200,4
ta 218,13,57344
xaa 168,200,8
xaa 172,200,12
wl 6
xaa 176,204,0
ta 220,14,51200
xaa 180,204,4
ta 222,14,57344
s_add_u32 m0, s27, 36864
xaa 184,204,8
s_mov_b32 s30, 5111808
xaa 188,204,12
wl 6
s_barrier
xaa 192,208,0
ta 224,11,0
xaa 196,208,4
ta 226,11,6144
xaa 200,208,8
dm 1,8,30,0
xaa 204,208,12
wl 6
xaa 208,212,0
ta 228,12,0
xaa 212,212,4
ta 230,12,6144
xaa 216,212,8
dm 2,8,30,1024
xaa 220,212,12
wl 6
xaa 224,216,0
ta 232,13,0
xaa 228,216,4
ta 234,13,6144
xaa 232,216,8
dm 3,8,30,2048
xaa 236,216,12
wl 6
xaa 240,220,0
ta 236,14,0
xaa 244,220,4
ta 238,14,6144
s_mov_b32 s31, 12288
xaa 248,220,8
xaa 252,220,12
wl 6
wv 10
xaa 64,224,16
ta 240,11,1024
xaa 68,224,20
ta 242,11,7168
xaa 72,224,24
buffer_load_dwordx4 a[0:3], v23, s[20:23], s31 offen
xaa 76,224,28
wl 6
xaa 80,228,16
ta 244,12,1024
xaa 84,228,20
ta 246,12,7168
xaa 88,228,24
buffer_load_dwordx4 a[4:7], v24, s[20:23], s31 offen
xaa 92,228,28
wl 6
xaa 96,232,16
ta 248,13,1024
xaa 100,232,20
ta 250,13,7168
xaa 104,232,24
buffer_load_dwordx4 a[8:11], v25, s[20:23], s31 offen
xaa 108,232,28
wl 6
xaa 112,236,16
ta 252,14,1024
xaa 116,236,20
ta 254,14,7168
xaa 120,236,24
buffer_load_dwordx4 a[12:15], v26, s[20:23], s31 offen
xaa 124,236,28
wl 6
xaa 128,240,16
ta 192,11,2048
xaa 132,240,20
ta 194,11,8192
xaa 136,240,24
xaa 140,240,28
wl 6
xaa 144,244,16
ta 196,12,2048
xaa 148,244,20
ta 198,12,8192
xaa 152,244,24
xaa 156,244,28
wl 6
xaa 160,248,16
ta 200,13,2048
xaa 164,248,20
ta 202,13,8192
xaa 168,248,24
xaa 172,248,28
wl 6
xaa 176,252,16
ta 204,14,2048
xaa 180,252,20
ta 206,14,8192
s_add_u32 m0, s27, 49152
xaa 184,252,24
s_mov_b32 s30, 5505024
xaa 188,252,28
wl 6
s_barrier
xaa 192,192,16
ta 208,11,12288
xaa 196,192,20
ta 210,11,18432
xaa 200,192,24
dm 1,8,30,0
xaa 204,192,28
wl 6
xaa 208,196,16
ta 212,12,12288
xaa 212,196,20
ta 214,12,18432
xaa 216,196,24
dm 2,8,30,1024
xaa 220,196,28
wl 6
xaa 224,200,16
ta 216,13,12288
xaa 228,200,20
ta 218,13,18432
xaa 232,200,24
dm 3,8,30,2048
xaa 236,200,28
wl 6
xaa 240,204,16
ta 220,14,12288
xaa 244,204,20
ta 222,14,18432
s_mov_b32 s31, 13312
xaa 248,204,24
xaa 252,204,28
wl 6
wv 10
xaa 64,208,32
ta 224,11,13312
xaa 68,208,36
ta 226,11,19456
xaa 72,208,40
buffer_load_dwordx4 a[16:19], v23, s[20:23], s31 offen
xaa 76,208,44
wl 6
xaa 80,212,32
ta 228,12,13312
xaa 84,212,36
ta 230,12,19456
xaa 88,212,40
buffer_load_dwordx4 a[20:23], v24, s[20:23], s31 offen
xaa 92,212,44
wl 6
xaa 96,216,32
ta 232,13,13312
xaa 100,216,36
ta 234,13,19456
xaa 104,216,40
buffer_load_dwordx4 a[24:27], v25, s[20:23], s31 offen
xaa 108,216,44
wl 6
xaa 112,220,32
ta 236,14,13312
xaa 116,220,36
ta 238,14,19456
xaa 120,220,40
buffer_load_dwordx4 a[28:31], v26, s[20:23], s31 offen
xaa 124,220,44
wl 6
xaa 128,224,32
ta 240,11,14336
xaa 132,224,36
ta 242,11,20480
xaa 136,224,40
xaa 140,224,44
wl 6
xaa 144,228,32
ta 244,12,14336
xaa 148,228,36
ta 246,12,20480
xaa 152,228,40
xaa 156,228,44
wl 6
xaa 160,232,32
ta 248,13,14336
xaa 164,232,36
ta 250,13,20480
xaa 168,232,40
xaa 172,232,44
wl 6
xaa 176,236,32
ta 252,14,14336
xaa 180,236,36
ta 254,14,20480
s_add_u32 m0, s27, 0
xaa 184,236,40
s_mov_b32 s30, 5898240
xaa 188,236,44
wl 6
s_barrier
xaa 192,240,32
ta 192,11,24576
xaa 196,240,36
ta 194,11,30720
xaa 200,240,40
dm 1,8,30,0
xaa 204,240,44
wl 6
xaa 208,244,32
ta 196,12,24576
xaa 212,244,36
ta 198,12,30720
xaa 216,244,40
dm 2,8,30,1024
xaa 220,244,44
wl 6
xaa 224,248,32
ta 200,13,24576
xaa 228,248,36
ta 202,13,30720
xaa 232,248,40
dm 3,8,30,2048
xaa 236,248,44
wl 6
xaa 240,252,32
ta 204,14,24576
xaa 244,252,36
ta 206,14,30720
s_mov_b32 s31, 14336
xaa 248,252,40
xaa 252,252,44
wl 6
wv 10
xaa 64,192,0
ta 208,11,25600
xaa 68,192,4
ta 210,11,31744
xaa 72,192,8
buffer_load_dwordx4 a[32:35], v23, s[20:23], s31 offen
xaa 76,192,12
wl 6
xaa 80,196,0
ta 212,12,25600
xaa 84,196,4
ta 214,12,31744
xaa 88,196,8
buffer_load_dwordx4 a[36:39], v24, s[20:23], s31 offen
xaa 92,196,12
wl 6
xaa 96,200,0
ta 216,13,25600
xaa 100,200,4
ta 218,13,31744
xaa 104,200,8
buffer_load_dwordx4 a[40:43], v25, s[20:23], s31 offen
xaa 108,200,12
wl 6
xaa 112,204,0
ta 220,14,25600
xaa 116,204,4
ta 222,14,31744
xaa 120,204,8
buffer_load_dwordx4 a[44:47], v26, s[20:23], s31 offen
xaa 124,204,12
wl 6
xaa 128,208,0
ta 224,11,26624
xaa 132,208,4
ta 226,11,32768
xaa 136,208,8
xaa 140,208,12
wl 6
xaa 144,212,0
ta 228,12,26624
xaa 148,212,4
ta 230,12,32768
xaa 152,212,8
xaa 156,212,12
wl 6
xaa 160,216,0
ta 232,13,26624
xaa 164,216,4
ta 234,13,32768
xaa 168,216,8
xaa 172,216,12
wl 6
xaa 176,220,0
ta 236,14,26624
xaa 180,220,4
ta 238,14,32768
s_add_u32 m0, s27, 12288
xaa 184,220,8
s_mov_b32 s30, 6291456
xaa 188,220,12
wl 6
s_barrier
xaa 192,224,0
ta 240,11,36864
xaa 196,224,4
ta 242,11,43008
xaa 200,224,8
dm 1,8,30,0
xaa 204,224,12
wl 6
xaa 208,228,0
ta 244,12,36864
xaa 212,228,4
ta 246,12,43008
xaa 216,228,8
dm 2,8,30,1024
xaa 220,228,12
wl 6
xaa 224,232,0
ta 248,13,36864
xaa 228,232,4
ta 250,13,43008
xaa 232,232,8
dm 3,8,30,2048
xaa 236,232,12
wl 6
xaa 240,236,0
ta 252,14,36864
xaa 244,236,4
ta 254,14,43008
s_mov_b32 s31, 15360
xaa 248,236,8
xaa 252,236,12
wl 6
wv 10
xaa 64,240,16
ta 192,11,37888
xaa 68,240,20
ta 194,11,44032
xaa 72,240,24
buffer_load_dwordx4 a[0:3], v23, s[20:23], s31 offen
xaa 76,240,28
wl 6
xaa 80,244,16
ta 196,12,37888
xaa 84,244,20
ta 198,12,44032
xaa 88,244,24
buffer_load_dwordx4 a[4:7], v24, s[20:23], s31 offen
xaa 92,244,28
wl 6
xaa 96,248,16
ta 200,13,37888
xaa 100,248,20
ta 202,13,44032
xaa 104,248,24
buffer_load_dwordx4 a[8:11], v25, s[20:23], s31 offen
xaa 108,248,28
wl 6
xaa 112,252,16
ta 204,14,37888
xaa 116,252,20
ta 206,14,44032
xaa 120,252,24
buffer_load_dwordx4 a[12:15], v26, s[20:23], s31 offen
xaa 124,252,28
wl 6
xaa 128,192,16
ta 208,11,38912
xaa 132,192,20
ta 210,11,45056
xaa 136,192,24
xaa 140,192,28
wl 6
xaa 144,196,16
ta 212,12,38912
xaa 148,196,20
ta 214,12,45056
xaa 152,196,24
xaa 156,196,28
wl 6
xaa 160,200,16
ta 216,13,38912
xaa 164,200,20
ta 218,13,45056
xaa 168,200,24
xaa 172,200,28
wl 6
xaa 176,204,16
ta 220,14,38912
xaa 180,204,20
ta 222,14,45056
s_add_u32 m0, s27, 24576
xaa 184,204,24
s_mov_b32 s30, 6684672
xaa 188,204,28
wl 6
s_barrier
xaa 192,208,16
ta 224,11,49152
xaa 196,208,20
ta 226,11,55296
xaa 200,208,24
dm 1,8,30,0
xaa 204,208,28
wl 6
xaa 208,212,16
ta 228,12,49152
xaa 212,212,20
ta 230,12,55296
xaa 216,212,24
dm 2,8,30,1024
xaa 220,212,28
wl 6
xaa 224,216,16
ta 232,13,49152
xaa 228,216,20
ta 234,13,55296
xaa 232,216,24
dm 3,8,30,2048
xaa 236,216,28
wl 6
xaa 240,220,16
ta 236,14,49152
xaa 244,220,20
ta 238,14,55296
s_mov_b32 s31, 16384
xaa 248,220,24
xaa 252,220,28
wl 6
wv 10
xaa 64,224,32
ta 240,11,50176
xaa 68,224,36
ta 242,11,56320
xaa 72,224,40
buffer_load_dwordx4 a[16:19], v23, s[20:23], s31 offen
xaa 76,224,44
wl 6
xaa 80,228,32
ta 244,12,50176
xaa 84,228,36
ta 246,12,56320
xaa 88,228,40
buffer_load_dwordx4 a[20:23], v24, s[20:23], s31 offen
xaa 92,228,44
wl 6
xaa 96,232,32
ta 248,13,50176
xaa 100,232,36
ta 250,13,56320
xaa 104,232,40
buffer_load_dwordx4 a[24:27], v25, s[20:23], s31 offen
xaa 108,232,44
wl 6
xaa 112,236,32
ta 252,14,50176
xaa 116,236,36
ta 254,14,56320
xaa 120,236,40
buffer_load_dwordx4 a[28:31], v26, s[20:23], s31 offen
xaa 124,236,44
wl 6
xaa 128,240,32
ta 192,11,51200
xaa 132,240,36
ta 194,11,57344
xaa 136,240,40
xaa 140,240,44
wl 6
xaa 144,244,32
ta 196,12,51200
xaa 148,244,36
ta 198,12,57344
xaa 152,244,40
xaa 156,244,44
wl 6
xaa 160,248,32
ta 200,13,51200
xaa 164,248,36
ta 202,13,57344
xaa 168,248,40
xaa 172,248,44
wl 6
xaa 176,252,32
ta 204,14,51200
xaa 180,252,36
ta 206,14,57344
s_add_u32 m0, s27, 36864
xaa 184,252,40
s_mov_b32 s30, 7077888
xaa 188,252,44
wl 6
s_barrier
xaa 192,192,32
ta 208,11,0
xaa 196,192,36
ta 210,11,6144
xaa 200,192,40
dm 1,8,30,0
xaa 204,192,44
wl 6
xaa 208,196,32
ta 212,12,0
xaa 212,196,36
ta 214,12,6144
xaa 216,196,40
dm 2,8,30,1024
xaa 220,196,44
wl 6
xaa 224,200,32
ta 216,13,0
xaa 228,200,36
ta 218,13,6144
xaa 232,200,40
dm 3,8,30,2048
xaa 236,200,44
wl 6
xaa 240,204,32
ta 220,14,0
xaa 244,204,36
ta 222,14,6144
s_mov_b32 s31, 17408
xaa 248,204,40
xaa 252,204,44
wl 6
wv 10
xaa 64,208,0
ta 224,11,1024
xaa 68,208,4
ta 226,11,7168
xaa 72,208,8
buffer_load_dwordx4 a[32:35], v23, s[20:23], s31 offen
xaa 76,208,12
wl 6
xaa 80,212,0
ta 228,12,1024
xaa 84,212,4
ta 230,12,7168
xaa 88,212,8
buffer_load_dwordx4 a[36:39], v24, s[20:23], s31 offen
xaa 92,212,12
wl 6
xaa 96,216,0
ta 232,13,1024
xaa 100,216,4
ta 234,13,7168
xaa 104,216,8
buffer_load_dwordx4 a[40:43], v25, s[20:23], s31 offen
xaa 108,216,12
wl 6
xaa 112,220,0
ta 236,14,1024
xaa 116,220,4
ta 238,14,7168
xaa 120,220,8
buffer_load_dwordx4 a[44:47], v26, s[20:23], s31 offen
xaa 124,220,12
wl 6
xaa 128,224,0
ta 240,11,2048
xaa 132,224,4
ta 242,11,8192
xaa 136,224,8
xaa 140,224,12
wl 6
xaa 144,228,0
ta 244,12,2048
xaa 148,228,4
ta 246,12,8192
xaa 152,228,8
xaa 156,228,12
wl 6
xaa 160,232,0
ta 248,13,2048
xaa 164,232,4
ta 250,13,8192
xaa 168,232,8
xaa 172,232,12
wl 6
xaa 176,236,0
ta 252,14,2048
xaa 180,236,4
ta 254,14,8192
s_add_u32 m0, s27, 49152
xaa 184,236,8
s_mov_b32 s30, 7471104
xaa 188,236,12
wl 6
s_barrier
xaa 192,240,0
ta 192,11,12288
xaa 196,240,4
ta 194,11,18432
xaa 200,240,8
dm 1,8,30,0
xaa 204,240,12
wl 6
xaa 208,244,0
ta 196,12,12288
xaa 212,244,4
ta 198,12,18432
xaa 216,244,8
dm 2,8,30,1024
xaa 220,244,12
wl 6
xaa 224,248,0
ta 200,13,12288
xaa 228,248,4
ta 202,13,18432
xaa 232,248,8
dm 3,8,30,2048
xaa 236,248,12
wl 6
xaa 240,252,0
ta 204,14,12288
xaa 244,252,4
ta 206,14,18432
s_mov_b32 s31, 18432
xaa 248,252,8
xaa 252,252,12
wl 6
wv 10
xaa 64,192,16
ta 208,11,13312
xaa 68,192,20
ta 210,11,19456
xaa 72,192,24
buffer_load_dwordx4 a[0:3], v23, s[20:23], s31 offen
xaa 76,192,28
wl 6
xaa 80,196,16
ta 212,12,13312
xaa 84,196,20
ta 214,12,19456
xaa 88,196,24
buffer_load_dwordx4 a[4:7], v24, s[20:23], s31 offen
xaa 92,196,28
wl 6
xaa 96,200,16
ta 216,13,13312
xaa 100,200,20
ta 218,13,19456
xaa 104,200,24
buffer_load_dwordx4 a[8:11], v25, s[20:23], s31 offen
xaa 108,200,28
wl 6
xaa 112,204,16
ta 220,14,13312
xaa 116,204,20
ta 222,14,19456
s_add_u32 m0, s28, 24576
xaa 120,204,24
buffer_load_dwordx4 a[12:15], v26, s[20:23], s31 offen
s_mov_b32 s30, 0
xaa 124,204,28
wl 6
xaa 128,208,16
ta 224,11,14336
xaa 132,208,20
ta 226,11,20480
xaa 136,208,24
dm 4,12,30,0
xaa 140,208,28
wl 6
xaa 144,212,16
ta 228,12,14336
xaa 148,212,20
ta 230,12,20480
xaa 152,212,24
dm 5,12,30,1024
xaa 156,212,28
wl 6
xaa 160,216,16
ta 232,13,14336
xaa 164,216,20
ta 234,13,20480
xaa 168,216,24
dm 6,12,30,2048
xaa 172,216,28
wl 6
xaa 176,220,16
ta 236,14,14336
xaa 180,220,20
ta 238,14,20480
xaa 184,220,24
xaa 188,220,28
wl 6
s_barrier
xaa 192,224,16
ta 240,11,24576
xaa 196,224,20
ta 242,11,30720
xaa 200,224,24
xaa 204,224,28
wl 6
xaa 208,228,16
ta 244,12,24576
xaa 212,228,20
ta 246,12,30720
xaa 216,228,24
xaa 220,228,28
wl 6
xaa 224,232,16
ta 248,13,24576
xaa 228,232,20
ta 250,13,30720
xaa 232,232,24
xaa 236,232,28
wl 6
xaa 240,236,16
ta 252,14,24576
xaa 244,236,20
ta 254,14,30720
s_mov_b32 s31, 19456
xaa 248,236,24
xaa 252,236,28
wl 6
wv 10
xaa 64,240,32
ta 192,11,25600
xaa 68,240,36
ta 194,11,31744
xaa 72,240,40
buffer_load_dwordx4 a[16:19], v23, s[20:23], s31 offen
xaa 76,240,44
wl 6
xaa 80,244,32
ta 196,12,25600
xaa 84,244,36
ta 198,12,31744
xaa 88,244,40
buffer_load_dwordx4 a[20:23], v24, s[20:23], s31 offen
xaa 92,244,44
wl 6
xaa 96,248,32
ta 200,13,25600
xaa 100,248,36
ta 202,13,31744
xaa 104,248,40
buffer_load_dwordx4 a[24:27], v25, s[20:23], s31 offen
xaa 108,248,44
wl 6
xaa 112,252,32
ta 204,14,25600
xaa 116,252,36
ta 206,14,31744
s_add_u32 m0, s28, 36864
xaa 120,252,40
buffer_load_dwordx4 a[28:31], v26, s[20:23], s31 offen
s_mov_b32 s30, 12288
xaa 124,252,44
wl 6
xaa 128,192,32
ta 208,11,26624
xaa 132,192,36
ta 210,11,32768
xaa 136,192,40
dm 4,12,30,0
xaa 140,192,44
wl 6
xaa 144,196,32
ta 212,12,26624
xaa 148,196,36
ta 214,12,32768
xaa 152,196,40
dm 5,12,30,1024
xaa 156,196,44
wl 6
xaa 160,200,32
ta 216,13,26624
xaa 164,200,36
ta 218,13,32768
xaa 168,200,40
dm 6,12,30,2048
xaa 172,200,44
wl 6
xaa 176,204,32
ta 220,14,26624
xaa 180,204,36
ta 222,14,32768
xaa 184,204,40
xaa 188,204,44
wl 6
s_barrier
xaa 192,208,32
ta 224,11,36864
xaa 196,208,36
ta 226,11,43008
xaa 200,208,40
xaa 204,208,44
wl 6
xaa 208,212,32
ta 228,12,36864
xaa 212,212,36
ta 230,12,43008
xaa 216,212,40
xaa 220,212,44
wl 6
xaa 224,216,32
ta 232,13,36864
xaa 228,216,36
ta 234,13,43008
xaa 232,216,40
xaa 236,216,44
wl 6
xaa 240,220,32
ta 236,14,36864
xaa 244,220,36
ta 238,14,43008
xaa 248,220,40
xaa 252,220,44
wl 6
wv 10
xaa 64,224,0
ta 240,11,37888
xaa 68,224,4
ta 242,11,44032
xaa 72,224,8
xaa 76,224,12
wl 6
xaa 80,228,0
ta 244,12,37888
xaa 84,228,4
ta 246,12,44032
s_add_u32 m0, s28, 49152
xaa 88,228,8
s_mov_b32 s30, 24576
xaa 92,228,12
wl 6
xaa 96,232,0
ta 248,13,37888
xaa 100,232,4
ta 250,13,44032
xaa 104,232,8
dm 4,12,30,0
xaa 108,232,12
wl 6
xaa 112,236,0
ta 252,14,37888
xaa 116,236,4
ta 254,14,44032
xaa 120,236,8
dm 5,12,30,1024
xaa 124,236,12
wl 6
xaa 128,240,0
ta 192,11,38912
xaa 132,240,4
ta 194,11,45056
xaa 136,240,8
dm 6,12,30,2048
xaa 140,240,12
wl 6
xaa 144,244,0
ta 196,12,38912
xaa 148,244,4
ta 198,12,45056
xaa 152,244,8
xaa 156,244,12
wl 6
xaa 160,248,0
ta 200,13,38912
xaa 164,248,4
ta 202,13,45056
xaa 168,248,8
xaa 172,248,12
wl 6
xaa 176,252,0
ta 204,14,38912
xaa 180,252,4
ta 206,14,45056
xaa 184,252,8
xaa 188,252,12
wl 6
s_barrier
xaa 192,192,0
ta 208,11,49152
xaa 196,192,4
ta 210,11,55296
xaa 200,192,8
xaa 204,192,12
wl 6
xaa 208,196,0
ta 212,12,49152
xaa 212,196,4
ta 214,12,55296
xaa 216,196,8
xaa 220,196,12
wl 6
xaa 224,200,0
ta 216,13,49152
xaa 228,200,4
ta 218,13,55296
xaa 232,200,8
xaa 236,200,12
wl 6
xaa 240,204,0
ta 220,14,49152
xaa 244,204,4
ta 222,14,55296
xaa 248,204,8
xaa 252,204,12
wl 6
wv 6
xaa 64,208,16
ta 224,11,50176
xaa 68,208,20
ta 226,11,56320
xaa 72,208,24
xaa 76,208,28
wl 6
xaa 80,212,16
ta 228,12,50176
xaa 84,212,20
ta 230,12,56320
cv 64,64,65
xaa 88,212,24
cv 65,66,67
cv 66,68,69
xaa 92,212,28
wl 6
cv 67,70,71
cv 68,72,73
xaa 96,216,16
ta 232,13,50176
cv 69,74,75
xaa 100,216,20
ta 234,13,56320
cv 70,76,77
xaa 104,216,24
cv 71,78,79
xaa 108,216,28
wl 6
sw 64,66
xaa 112,220,16
ta 236,14,50176
xaa 116,220,20
ta 238,14,56320
xaa 120,220,24
sw 65,67
xaa 124,220,28
wl 6
sw 68,70
xaa 128,224,16
ta 240,11,51200
xaa 132,224,20
ta 242,11,57344
xaa 136,224,24
sw 69,71
xaa 140,224,28
wl 6
cv 72,80,81
cv 73,82,83
xaa 144,228,16
ta 244,12,51200
cv 74,84,85
xaa 148,228,20
ta 246,12,57344
cv 75,86,87
xaa 152,228,24
cv 76,88,89
cv 77,90,91
xaa 156,228,28
wl 6
cv 78,92,93
cv 79,94,95
xaa 160,232,16
ta 248,13,51200
xaa 164,232,20
ta 250,13,57344
xaa 168,232,24
sw 72,74
xaa 172,232,28
wl 6
sw 73,75
xaa 176,236,16
ta 252,14,51200
xaa 180,236,20
ta 254,14,57344
s_add_u32 m0, s28, 0
xaa 184,236,24
s_mov_b32 s30, 36864
sw 76,78
xaa 188,236,28
wl 6
s_barrier
xaa 192,240,16
ra 192,15,24576
xaa 196,240,20
dm 4,12,30,0
xaa 200,240,24
sw 77,79
xaa 204,240,28
wl 5
cv 80,96,97
cv 81,98,99
xaa 208,244,16
ra 196,16,24576
cv 82,100,101
xaa 212,244,20
dm 5,12,30,1024
cv 83,102,103
xaa 216,244,24
cv 84,104,105
cv 85,106,107
xaa 220,244,28
wl 4
cv 86,108,109
cv 87,110,111
xaa 224,248,16
ra 200,17,24576
xaa 228,248,20
dm 6,12,30,2048
xaa 232,248,24
sw 80,82
xaa 236,248,28
wl 3
sw 81,83
xaa 240,252,16
ra 204,18,24576
xaa 244,252,20
sw 84,86
xaa 248,252,24
sw 85,87
xaa 252,252,28
wl 3
cv 88,112,113
cv 89,114,115
v_mfma_f32_32x32x16_bf16 v[28:43], a[192:195], v[64:67], 0
ra 208,15,25600
cv 90,116,117
cv 91,118,119
cv 92,120,121
cv 93,122,123
cv 94,124,125
v_mfma_f32_32x32x16_bf16 v[44:59], a[192:195], v[68:71], 0
wl 3
cv 95,126,127
sw 88,90
sw 89,91
yav 28,196,72
ra 212,16,25600
sw 92,94
sw 93,95
cv 96,128,129
yav 44,196,76
wl 3
cv 97,130,131
cv 98,132,133
cv 99,134,135
cv 100,136,137
cv 101,138,139
cv 102,140,141
yav 28,200,80
ra 216,17,25600
cv 103,142,143
sw 96,98
sw 97,99
yav 44,200,84
wl 3
sw 100,102
sw 101,103
cv 104,144,145
cv 105,146,147
yav 28,204,88
ra 220,18,25600
cv 106,148,149
cv 107,150,151
cv 108,152,153
cv 109,154,155
cv 110,156,157
yav 44,204,92
wl 3
cv 111,158,159
sw 104,106
sw 105,107
yav 28,208,96
ra 224,15,26624
sw 108,110
sw 109,111
cv 112,160,161
yav 44,208,100
wl 3
cv 113,162,163
cv 114,164,165
cv 115,166,167
cv 116,168,169
cv 117,170,171
cv 118,172,173
yav 28,212,104
ra 228,16,26624
cv 119,174,175
sw 112,114
sw 113,115
sw 116,118
sw 117,119
yav 44,212,108
wl 3
cv 120,176,177
cv 121,178,179
cv 122,180,181
cv 123,182,183
cv 124,184,185
cv 125,186,187
yav 28,216,112
ra 232,17,26624
cv 126,188,189
cv 127,190,191
sw 120,122
sw 121,123
sw 124,126
sw 125,127
yav 44,216,116
wl 3
s_add_u32 m0, s28, 12288
s_mov_b32 s30, 49152
cv 128,192,193
cv 129,194,195
cv 130,196,197
cv 131,198,199
yav 28,220,120
ra 236,18,26624
cv 132,200,201
cv 133,202,203
cv 134,204,205
cv 135,206,207
sw 128,130
sw 129,131
sw 132,134
sw 133,135
yav 44,220,124
wl 3
wv 6
s_barrier
cv 136,208,209
cv 137,210,211
cv 138,212,213
cv 139,214,215
yav 28,224,128
ra 240,15,36864
dm 4,12,30,0
cv 140,216,217
cv 141,218,219
cv 142,220,221
cv 143,222,223
sw 136,138
sw 137,139
sw 140,142
sw 141,143
yav 44,224,132
wl 3
cv 144,224,225
cv 145,226,227
cv 146,228,229
cv 147,230,231
cv 148,232,233
cv 149,234,235
yav 28,228,136
ra 244,16,36864
cv 150,236,237
cv 151,238,239
sw 144,146
sw 145,147
sw 148,150
sw 149,151
yav 44,228,140
wl 3
cv 152,240,241
cv 153,242,243
cv 154,244,245
cv 155,246,247
cv 156,248,249
cv 157,250,251
yav 28,232,144
ra 248,17,36864
dm 5,12,30,1024
cv 158,252,253
cv 159,254,255
sw 152,154
sw 153,155
sw 156,158
sw 157,159
v_mov_b32 v60, 0x3f803f80
v_mov_b32 v61, 0x3f803f80
v_mov_b32 v62, 0x3f803f80
v_mov_b32 v63, 0x3f803f80
s_mul_i32 s32, s38, 176128
s_mul_i32 s33, s24, 6144
s_add_u32 s32, s32, s33
s_add_u32 s32, s32, 3932160
v_add_u32 v23, s32, v23
v_add_u32 v24, s32, v24
v_add_u32 v24, 176128, v24
v_add_u32 v25, s32, v25
v_add_u32 v25, 352256, v25
v_add_u32 v26, s32, v26
v_add_u32 v26, 528384, v26
yav 44,232,148
wl 3
yav 28,236,152
ra 252,18,36864
yav 44,236,156
wl 3
v_mfma_f32_32x32x16_bf16 v[192:207], a[240:243], v[64:67], 0
ra 192,15,37888
dm 6,12,30,2048
v_mfma_f32_32x32x16_bf16 v[208:223], a[240:243], v[68:71], 0
wl 3
s_nop 3
v_max_f32 v2, v28, v29
v_max3_f32 v2, v2, v30, v31
v_max3_f32 v2, v2, v32, v33
v_max3_f32 v2, v2, v34, v35
v_max3_f32 v2, v2, v36, v37
v_max3_f32 v2, v2, v38, v39
yav 192,244,72
ra 196,16,37888
v_max3_f32 v2, v2, v40, v41
v_max3_f32 v2, v2, v42, v43
v_max_f32 v3, v44, v45
v_max3_f32 v3, v3, v46, v47
v_max3_f32 v3, v3, v48, v49
yav 208,244,76
wl 3
v_max3_f32 v3, v3, v50, v51
v_max3_f32 v3, v3, v52, v53
v_max3_f32 v3, v3, v54, v55
v_max3_f32 v3, v3, v56, v57
v_max3_f32 v3, v3, v58, v59
yav 192,248,80
ra 200,17,37888
yav 208,248,84
wl 3
yav 192,252,88
ra 204,18,37888
yav 208,252,92
wl 3
yav 192,192,96
ra 208,15,38912
yav 208,192,100
wl 3
yav 192,196,104
ra 212,16,38912
yav 208,196,108
wl 3
yav 192,200,112
ra 216,17,38912
yav 208,200,116
wl 3
s_add_u32 m0, s28, 24576
s_mov_b32 s30, 61440
yav 192,204,120
ra 220,18,38912
yav 208,204,124
wl 3
wv 6
s_barrier
yav 192,208,128
ra 224,15,49152
dm 4,12,30,0
yav 208,208,132
wl 3
yav 192,212,136
ra 228,16,49152
yav 208,212,140
wl 3
yav 192,216,144
ra 232,17,49152
dm 5,12,30,1024
yav 208,216,148
wl 3
yav 192,220,152
ra 236,18,49152
yav 208,220,156
wl 3
v_mfma_f32_32x32x16_bf16 v[160:175], a[224:227], v[64:67], 0
ra 240,15,50176
dm 6,12,30,2048
v_mfma_f32_32x32x16_bf16 v[176:191], a[224:227], v[68:71], 0
wl 3
s_nop 3
v_max3_f32 v2, v2, v192, v193
v_max3_f32 v2, v2, v194, v195
v_max3_f32 v2, v2, v196, v197
v_max3_f32 v2, v2, v198, v199
v_max3_f32 v2, v2, v200, v201
v_max3_f32 v2, v2, v202, v203
yav 160,228,72
ra 244,16,50176
v_max3_f32 v2, v2, v204, v205
v_max3_f32 v2, v2, v206, v207
v_max3_f32 v3, v3, v208, v209
v_max3_f32 v3, v3, v210, v211
v_max3_f32 v3, v3, v212, v213
yav 176,228,76
wl 3
v_max3_f32 v3, v3, v214, v215
v_max3_f32 v3, v3, v216, v217
v_max3_f32 v3, v3, v218, v219
v_max3_f32 v3, v3, v220, v221
v_max3_f32 v3, v3, v222, v223
yav 160,232,80
ra 248,17,50176
yav 176,232,84
wl 3
yav 160,236,88
ra 252,18,50176
yav 176,236,92
wl 3
yav 160,240,96
ra 192,15,51200
yav 176,240,100
wl 3
yav 160,244,104
ra 196,16,51200
yav 176,244,108
wl 3
yav 160,248,112
ra 200,17,51200
yav 176,248,116
wl 3
s_add_u32 m0, s28, 36864
s_mov_b32 s30, 73728
yav 160,252,120
ra 204,18,51200
yav 176,252,124
wl 3
wv 6
s_barrier
yav 160,192,128
ra 208,15,0
dm 4,12,30,0
yav 176,192,132
wl 3
yav 160,196,136
ra 212,16,0
yav 176,196,140
wl 3
yav 160,200,144
ra 216,17,0
dm 5,12,30,1024
yav 176,200,148
wl 3
yav 160,204,152
ra 220,18,0
yav 176,204,156
wl 3
v_mfma_f32_32x32x16_bf16 v[192:207], a[208:211], v[64:67], 0
ra 224,15,1024
dm 6,12,30,2048
v_mfma_f32_32x32x16_bf16 v[208:223], a[208:211], v[68:71], 0
wl 3
s_nop 3
v_max3_f32 v2, v2, v160, v161
v_max3_f32 v2, v2, v162, v163
v_max3_f32 v2, v2, v164, v165
v_max3_f32 v2, v2, v166, v167
v_max3_f32 v2, v2, v168, v169
v_max3_f32 v2, v2, v170, v171
yav 192,212,72
ra 228,16,1024
v_max3_f32 v2, v2, v172, v173
v_max3_f32 v2, v2, v174, v175
v_max3_f32 v3, v3, v176, v177
v_max3_f32 v3, v3, v178, v179
v_max3_f32 v3, v3, v180, v181
yav 208,212,76
wl 3
v_max3_f32 v3, v3, v182, v183
v_max3_f32 v3, v3, v184, v185
v_max3_f32 v3, v3, v186, v187
v_max3_f32 v3, v3, v188, v189
v_max3_f32 v3, v3, v190, v191
yav 192,216,80
ra 232,17,1024
yav 208,216,84
wl 3
yav 192,220,88
ra 236,18,1024
yav 208,220,92
wl 3
yav 192,224,96
ra 240,15,2048
yav 208,224,100
wl 3
yav 192,228,104
ra 244,16,2048
yav 208,228,108
wl 3
yav 192,232,112
ra 248,17,2048
yav 208,232,116
wl 3
s_add_u32 m0, s28, 49152
s_mov_b32 s30, 86016
yav 192,236,120
ra 252,18,2048
yav 208,236,124
wl 3
wv 6
s_barrier
yav 192,240,128
ra 192,15,12288
dm 4,12,30,0
yav 208,240,132
wl 3
yav 192,244,136
ra 196,16,12288
yav 208,244,140
wl 3
yav 192,248,144
ra 200,17,12288
dm 5,12,30,1024
yav 208,248,148
wl 3
yav 192,252,152
ra 204,18,12288
yav 208,252,156
wl 3
v_mfma_f32_32x32x16_bf16 v[160:175], a[192:195], v[64:67], 0
ra 208,15,13312
dm 6,12,30,2048
v_mfma_f32_32x32x16_bf16 v[176:191], a[192:195], v[68:71], 0
wl 3
s_nop 3
v_max3_f32 v2, v2, v192, v193
v_max3_f32 v2, v2, v194, v195
v_max3_f32 v2, v2, v196, v197
v_max3_f32 v2, v2, v198, v199
v_max3_f32 v2, v2, v200, v201
v_max3_f32 v2, v2, v202, v203
yav 160,196,72
ra 212,16,13312
v_max3_f32 v2, v2, v204, v205
v_max3_f32 v2, v2, v206, v207
v_max3_f32 v3, v3, v208, v209
v_max3_f32 v3, v3, v210, v211
v_max3_f32 v3, v3, v212, v213
yav 176,196,76
wl 3
v_max3_f32 v3, v3, v214, v215
v_max3_f32 v3, v3, v216, v217
v_max3_f32 v3, v3, v218, v219
v_max3_f32 v3, v3, v220, v221
v_max3_f32 v3, v3, v222, v223
yav 160,200,80
ra 216,17,13312
yav 176,200,84
wl 3
yav 160,204,88
ra 220,18,13312
yav 176,204,92
wl 3
yav 160,208,96
ra 224,15,14336
yav 176,208,100
wl 3
yav 160,212,104
ra 228,16,14336
yav 176,212,108
wl 3
yav 160,216,112
ra 232,17,14336
yav 176,216,116
wl 3
s_add_u32 m0, s28, 0
s_mov_b32 s30, 98304
yav 160,220,120
ra 236,18,14336
yav 176,220,124
wl 3
wv 6
s_barrier
yav 160,224,128
ra 240,15,24576
dm 4,12,30,0
yav 176,224,132
wl 3
yav 160,228,136
ra 244,16,24576
yav 176,228,140
wl 3
yav 160,232,144
ra 248,17,24576
dm 5,12,30,1024
yav 176,232,148
wl 3
yav 160,236,152
ra 252,18,24576
yav 176,236,156
wl 3
v_mfma_f32_32x32x16_bf16 v[192:207], a[240:243], v[64:67], 0
ra 192,15,25600
dm 6,12,30,2048
v_mfma_f32_32x32x16_bf16 v[208:223], a[240:243], v[68:71], 0
wl 3
s_nop 3
v_max3_f32 v2, v2, v160, v161
v_max3_f32 v2, v2, v162, v163
v_max3_f32 v2, v2, v164, v165
v_max3_f32 v2, v2, v166, v167
v_max3_f32 v2, v2, v168, v169
v_max3_f32 v2, v2, v170, v171
yav 192,244,72
ra 196,16,25600
v_max3_f32 v2, v2, v172, v173
v_max3_f32 v2, v2, v174, v175
v_max3_f32 v3, v3, v176, v177
v_max3_f32 v3, v3, v178, v179
v_max3_f32 v3, v3, v180, v181
yav 208,244,76
wl 3
v_max3_f32 v3, v3, v182, v183
v_max3_f32 v3, v3, v184, v185
v_max3_f32 v3, v3, v186, v187
v_max3_f32 v3, v3, v188, v189
v_max3_f32 v3, v3, v190, v191
yav 192,248,80
ra 200,17,25600
yav 208,248,84
wl 3
yav 192,252,88
ra 204,18,25600
yav 208,252,92
wl 3
yav 192,192,96
ra 208,15,26624
yav 208,192,100
wl 3
yav 192,196,104
ra 212,16,26624
yav 208,196,108
wl 3
yav 192,200,112
ra 216,17,26624
yav 208,200,116
wl 3
s_add_u32 m0, s28, 12288
s_mov_b32 s30, 110592
yav 192,204,120
ra 220,18,26624
yav 208,204,124
wl 3
wv 6
s_barrier
yav 192,208,128
ra 224,15,36864
dm 4,12,30,0
yav 208,208,132
wl 3
yav 192,212,136
ra 228,16,36864
yav 208,212,140
wl 3
yav 192,216,144
ra 232,17,36864
dm 5,12,30,1024
yav 208,216,148
wl 3
yav 192,220,152
ra 236,18,36864
yav 208,220,156
wl 3
v_mfma_f32_32x32x16_bf16 v[160:175], a[224:227], v[64:67], 0
ra 240,15,37888
dm 6,12,30,2048
v_mfma_f32_32x32x16_bf16 v[176:191], a[224:227], v[68:71], 0
wl 3
s_nop 3
v_max3_f32 v2, v2, v192, v193
v_max3_f32 v2, v2, v194, v195
v_max3_f32 v2, v2, v196, v197
v_max3_f32 v2, v2, v198, v199
v_max3_f32 v2, v2, v200, v201
v_max3_f32 v2, v2, v202, v203
yav 160,228,72
ra 244,16,37888
v_max3_f32 v2, v2, v204, v205
v_max3_f32 v2, v2, v206, v207
v_max3_f32 v3, v3, v208, v209
v_max3_f32 v3, v3, v210, v211
v_max3_f32 v3, v3, v212, v213
yav 176,228,76
wl 3
v_max3_f32 v3, v3, v214, v215
v_max3_f32 v3, v3, v216, v217
v_max3_f32 v3, v3, v218, v219
v_max3_f32 v3, v3, v220, v221
v_max3_f32 v3, v3, v222, v223
yav 160,232,80
ra 248,17,37888
yav 176,232,84
wl 3
yav 160,236,88
ra 252,18,37888
yav 176,236,92
wl 3
yav 160,240,96
ra 192,15,38912
yav 176,240,100
wl 3
yav 160,244,104
ra 196,16,38912
yav 176,244,108
wl 3
yav 160,248,112
ra 200,17,38912
yav 176,248,116
wl 3
s_add_u32 m0, s28, 24576
s_mov_b32 s30, 122880
yav 160,252,120
ra 204,18,38912
yav 176,252,124
wl 3
wv 6
s_barrier
yav 160,192,128
ra 208,15,49152
dm 4,12,30,0
yav 176,192,132
wl 3
yav 160,196,136
ra 212,16,49152
yav 176,196,140
wl 3
yav 160,200,144
ra 216,17,49152
dm 5,12,30,1024
yav 176,200,148
wl 3
yav 160,204,152
ra 220,18,49152
yav 176,204,156
wl 3
v_mfma_f32_32x32x16_bf16 v[192:207], a[208:211], v[64:67], 0
ra 224,15,50176
dm 6,12,30,2048
v_mfma_f32_32x32x16_bf16 v[208:223], a[208:211], v[68:71], 0
wl 3
s_nop 3
v_max3_f32 v2, v2, v160, v161
v_max3_f32 v2, v2, v162, v163
v_max3_f32 v2, v2, v164, v165
v_max3_f32 v2, v2, v166, v167
v_max3_f32 v2, v2, v168, v169
v_max3_f32 v2, v2, v170, v171
yav 192,212,72
ra 228,16,50176
v_max3_f32 v2, v2, v172, v173
v_max3_f32 v2, v2, v174, v175
v_max3_f32 v3, v3, v176, v177
v_max3_f32 v3, v3, v178, v179
v_max3_f32 v3, v3, v180, v181
yav 208,212,76
wl 3
v_max3_f32 v3, v3, v182, v183
v_max3_f32 v3, v3, v184, v185
v_max3_f32 v3, v3, v186, v187
v_max3_f32 v3, v3, v188, v189
v_max3_f32 v3, v3, v190, v191
yav 192,216,80
ra 232,17,50176
yav 208,216,84
wl 3
yav 192,220,88
ra 236,18,50176
yav 208,220,92
wl 3
yav 192,224,96
ra 240,15,51200
yav 208,224,100
wl 3
yav 192,228,104
ra 244,16,51200
yav 208,228,108
wl 3
yav 192,232,112
ra 248,17,51200
yav 208,232,116
wl 3
s_add_u32 m0, s28, 36864
s_mov_b32 s30, 135168
yav 192,236,120
ra 252,18,51200
yav 208,236,124
wl 3
wv 6
s_barrier
yav 192,240,128
ra 192,15,0
dm 4,12,30,0
yav 208,240,132
wl 3
yav 192,244,136
ra 196,16,0
yav 208,244,140
wl 3
yav 192,248,144
ra 200,17,0
dm 5,12,30,1024
yav 208,248,148
wl 3
yav 192,252,152
ra 204,18,0
yav 208,252,156
wl 3
v_mfma_f32_32x32x16_bf16 v[160:175], a[192:195], v[64:67], 0
ra 208,15,1024
dm 6,12,30,2048
v_mfma_f32_32x32x16_bf16 v[176:191], a[192:195], v[68:71], 0
wl 3
s_nop 3
v_max3_f32 v2, v2, v192, v193
v_max3_f32 v2, v2, v194, v195
v_max3_f32 v2, v2, v196, v197
v_max3_f32 v2, v2, v198, v199
v_max3_f32 v2, v2, v200, v201
v_max3_f32 v2, v2, v202, v203
yav 160,196,72
ra 212,16,1024
v_max3_f32 v2, v2, v204, v205
v_max3_f32 v2, v2, v206, v207
v_max3_f32 v3, v3, v208, v209
v_max3_f32 v3, v3, v210, v211
v_max3_f32 v3, v3, v212, v213
yav 176,196,76
wl 3
v_max3_f32 v3, v3, v214, v215
v_max3_f32 v3, v3, v216, v217
v_max3_f32 v3, v3, v218, v219
v_max3_f32 v3, v3, v220, v221
v_max3_f32 v3, v3, v222, v223
yav 160,200,80
ra 216,17,1024
yav 176,200,84
wl 3
yav 160,204,88
ra 220,18,1024
yav 176,204,92
wl 3
yav 160,208,96
ra 224,15,2048
yav 176,208,100
wl 3
yav 160,212,104
ra 228,16,2048
yav 176,212,108
wl 3
yav 160,216,112
ra 232,17,2048
yav 176,216,116
wl 3
s_add_u32 m0, s28, 49152
s_mov_b32 s30, 147456
yav 160,220,120
ra 236,18,2048
yav 176,220,124
wl 3
wv 6
s_barrier
yav 160,224,128
ra 240,15,12288
dm 4,12,30,0
yav 176,224,132
wl 3
yav 160,228,136
ra 244,16,12288
yav 176,228,140
wl 3
yav 160,232,144
ra 248,17,12288
dm 5,12,30,1024
yav 176,232,148
wl 3
yav 160,236,152
ra 252,18,12288
yav 176,236,156
wl 3
v_mfma_f32_32x32x16_bf16 v[192:207], a[240:243], v[64:67], 0
ra 192,15,13312
dm 6,12,30,2048
v_mfma_f32_32x32x16_bf16 v[208:223], a[240:243], v[68:71], 0
wl 3
s_nop 3
v_max3_f32 v2, v2, v160, v161
v_max3_f32 v2, v2, v162, v163
v_max3_f32 v2, v2, v164, v165
v_max3_f32 v2, v2, v166, v167
v_max3_f32 v2, v2, v168, v169
v_max3_f32 v2, v2, v170, v171
yav 192,244,72
ra 196,16,13312
v_max3_f32 v2, v2, v172, v173
v_max3_f32 v2, v2, v174, v175
v_max3_f32 v3, v3, v176, v177
v_max3_f32 v3, v3, v178, v179
v_max3_f32 v3, v3, v180, v181
yav 208,244,76
wl 3
v_max3_f32 v3, v3, v182, v183
v_max3_f32 v3, v3, v184, v185
v_max3_f32 v3, v3, v186, v187
v_max3_f32 v3, v3, v188, v189
v_max3_f32 v3, v3, v190, v191
yav 192,248,80
ra 200,17,13312
yav 208,248,84
wl 3
yav 192,252,88
ra 204,18,13312
yav 208,252,92
wl 3
yav 192,192,96
ra 208,15,14336
yav 208,192,100
wl 3
yav 192,196,104
ra 212,16,14336
yav 208,196,108
wl 3
yav 192,200,112
ra 216,17,14336
yav 208,200,116
wl 3
s_add_u32 m0, s28, 0
s_mov_b32 s30, 159744
yav 192,204,120
ra 220,18,14336
yav 208,204,124
wl 3
wv 6
s_barrier
yav 192,208,128
ra 224,15,24576
dm 4,12,30,0
yav 208,208,132
wl 3
yav 192,212,136
ra 228,16,24576
yav 208,212,140
wl 3
yav 192,216,144
ra 232,17,24576
dm 5,12,30,1024
yav 208,216,148
wl 3
yav 192,220,152
ra 236,18,24576
yav 208,220,156
wl 3
v_mfma_f32_32x32x16_bf16 v[160:175], a[224:227], v[64:67], 0
ra 240,15,25600
dm 6,12,30,2048
v_mfma_f32_32x32x16_bf16 v[176:191], a[224:227], v[68:71], 0
wl 3
s_nop 3
v_max3_f32 v2, v2, v192, v193
v_max3_f32 v2, v2, v194, v195
v_max3_f32 v2, v2, v196, v197
v_max3_f32 v2, v2, v198, v199
v_max3_f32 v2, v2, v200, v201
v_max3_f32 v2, v2, v202, v203
yav 160,228,72
ra 244,16,25600
v_max3_f32 v2, v2, v204, v205
v_max3_f32 v2, v2, v206, v207
v_max3_f32 v3, v3, v208, v209
v_max3_f32 v3, v3, v210, v211
v_max3_f32 v3, v3, v212, v213
yav 176,228,76
wl 3
v_max3_f32 v3, v3, v214, v215
v_max3_f32 v3, v3, v216, v217
v_max3_f32 v3, v3, v218, v219
v_max3_f32 v3, v3, v220, v221
v_max3_f32 v3, v3, v222, v223
yav 160,232,80
ra 248,17,25600
yav 176,232,84
wl 3
yav 160,236,88
ra 252,18,25600
yav 176,236,92
wl 3
yav 160,240,96
ra 192,15,26624
yav 176,240,100
wl 3
yav 160,244,104
ra 196,16,26624
yav 176,244,108
wl 3
yav 160,248,112
ra 200,17,26624
yav 176,248,116
wl 3
s_add_u32 m0, s28, 12288
s_mov_b32 s30, 172032
yav 160,252,120
ra 204,18,26624
yav 176,252,124
wl 3
wv 6
s_barrier
yav 160,192,128
ra 208,15,36864
dm 4,12,30,0
yav 176,192,132
wl 3
yav 160,196,136
ra 212,16,36864
yav 176,196,140
wl 3
yav 160,200,144
ra 216,17,36864
dm 5,12,30,1024
yav 176,200,148
wl 3
yav 160,204,152
ra 220,18,36864
yav 176,204,156
wl 3
v_mfma_f32_32x32x16_bf16 v[192:207], a[208:211], v[64:67], 0
ra 224,15,37888
dm 6,12,30,2048
v_mfma_f32_32x32x16_bf16 v[208:223], a[208:211], v[68:71], 0
wl 3
s_nop 3
v_max3_f32 v2, v2, v160, v161
v_max3_f32 v2, v2, v162, v163
v_max3_f32 v2, v2, v164, v165
v_max3_f32 v2, v2, v166, v167
v_max3_f32 v2, v2, v168, v169
v_max3_f32 v2, v2, v170, v171
yav 192,212,72
ra 228,16,37888
v_max3_f32 v2, v2, v172, v173
v_max3_f32 v2, v2, v174, v175
v_max3_f32 v3, v3, v176, v177
v_max3_f32 v3, v3, v178, v179
v_max3_f32 v3, v3, v180, v181
yav 208,212,76
wl 3
v_max3_f32 v3, v3, v182, v183
v_max3_f32 v3, v3, v184, v185
v_max3_f32 v3, v3, v186, v187
v_max3_f32 v3, v3, v188, v189
v_max3_f32 v3, v3, v190, v191
yav 192,216,80
ra 232,17,37888
yav 208,216,84
wl 3
yav 192,220,88
ra 236,18,37888
yav 208,220,92
wl 3
yav 192,224,96
ra 240,15,38912
yav 208,224,100
wl 3
yav 192,228,104
ra 244,16,38912
yav 208,228,108
wl 3
yav 192,232,112
ra 248,17,38912
yav 208,232,116
wl 3
s_add_u32 m0, s28, 24576
s_mov_b32 s30, 184320
yav 192,236,120
ra 252,18,38912
yav 208,236,124
wl 3
wv 6
s_barrier
yav 192,240,128
ra 192,15,49152
dm 4,12,30,0
yav 208,240,132
wl 3
yav 192,244,136
ra 196,16,49152
yav 208,244,140
wl 3
yav 192,248,144
ra 200,17,49152
dm 5,12,30,1024
yav 208,248,148
wl 3
yav 192,252,152
ra 204,18,49152
yav 208,252,156
wl 3
v_mfma_f32_32x32x16_bf16 v[160:175], a[192:195], v[64:67], 0
ra 208,15,50176
dm 6,12,30,2048
v_mfma_f32_32x32x16_bf16 v[176:191], a[192:195], v[68:71], 0
wl 3
s_nop 3
v_max3_f32 v2, v2, v192, v193
v_max3_f32 v2, v2, v194, v195
v_max3_f32 v2, v2, v196, v197
v_max3_f32 v2, v2, v198, v199
v_max3_f32 v2, v2, v200, v201
v_max3_f32 v2, v2, v202, v203
yav 160,196,72
ra 212,16,50176
v_max3_f32 v2, v2, v204, v205
v_max3_f32 v2, v2, v206, v207
v_max3_f32 v3, v3, v208, v209
v_max3_f32 v3, v3, v210, v211
v_max3_f32 v3, v3, v212, v213
yav 176,196,76
wl 3
v_max3_f32 v3, v3, v214, v215
v_max3_f32 v3, v3, v216, v217
v_max3_f32 v3, v3, v218, v219
v_max3_f32 v3, v3, v220, v221
v_max3_f32 v3, v3, v222, v223
yav 160,200,80
ra 216,17,50176
yav 176,200,84
wl 3
yav 160,204,88
ra 220,18,50176
yav 176,204,92
wl 3
yav 160,208,96
ra 224,15,51200
yav 176,208,100
wl 3
yav 160,212,104
ra 228,16,51200
yav 176,212,108
wl 3
yav 160,216,112
ra 232,17,51200
yav 176,216,116
wl 3
s_add_u32 m0, s28, 36864
s_mov_b32 s30, 0
yav 160,220,120
ra 236,18,51200
yav 176,220,124
wl 3
wv 6
s_barrier
yav 160,224,128
ra 240,15,0
dm 4,12,30,0
yav 176,224,132
wl 3
yav 160,228,136
ra 244,16,0
yav 176,228,140
wl 3
yav 160,232,144
ra 248,17,0
dm 5,12,30,1024
yav 176,232,148
wl 3
yav 160,236,152
ra 252,18,0
yav 176,236,156
wl 3
v_mfma_f32_32x32x16_bf16 v[192:207], a[240:243], v[64:67], 0
ra 192,15,1024
dm 6,12,30,2048
v_mfma_f32_32x32x16_bf16 v[208:223], a[240:243], v[68:71], 0
wl 3
s_nop 3
v_max3_f32 v2, v2, v160, v161
v_max3_f32 v2, v2, v162, v163
v_max3_f32 v2, v2, v164, v165
v_max3_f32 v2, v2, v166, v167
v_max3_f32 v2, v2, v168, v169
v_max3_f32 v2, v2, v170, v171
yav 192,244,72
ra 196,16,1024
v_max3_f32 v2, v2, v172, v173
v_max3_f32 v2, v2, v174, v175
v_max3_f32 v3, v3, v176, v177
v_max3_f32 v3, v3, v178, v179
v_max3_f32 v3, v3, v180, v181
yav 208,244,76
wl 3
v_max3_f32 v3, v3, v182, v183
v_max3_f32 v3, v3, v184, v185
v_max3_f32 v3, v3, v186, v187
v_max3_f32 v3, v3, v188, v189
v_max3_f32 v3, v3, v190, v191
yav 192,248,80
ra 200,17,1024
yav 208,248,84
wl 3
yav 192,252,88
ra 204,18,1024
yav 208,252,92
wl 3
yav 192,192,96
ra 208,15,2048
yav 208,192,100
wl 3
yav 192,196,104
ra 212,16,2048
yav 208,196,108
wl 3
yav 192,200,112
ra 216,17,2048
yav 208,200,116
wl 3
s_add_u32 m0, s28, 49152
s_mov_b32 s30, 12288
yav 192,204,120
ra 220,18,2048
yav 208,204,124
wl 3
wv 6
s_barrier
yav 192,208,128
ra 224,15,12288
dm 4,12,30,0
yav 208,208,132
wl 3
yav 192,212,136
ra 228,16,12288
yav 208,212,140
wl 3
yav 192,216,144
ra 232,17,12288
dm 5,12,30,1024
yav 208,216,148
wl 3
yav 192,220,152
ra 236,18,12288
yav 208,220,156
wl 3
v_mfma_f32_32x32x16_bf16 v[160:175], a[224:227], v[64:67], 0
ra 240,15,13312
dm 6,12,30,2048
v_mfma_f32_32x32x16_bf16 v[176:191], a[224:227], v[68:71], 0
wl 3
s_nop 3
v_max3_f32 v2, v2, v192, v193
v_max3_f32 v2, v2, v194, v195
v_max3_f32 v2, v2, v196, v197
v_max3_f32 v2, v2, v198, v199
v_max3_f32 v2, v2, v200, v201
v_max3_f32 v2, v2, v202, v203
yav 160,228,72
ra 244,16,13312
v_max3_f32 v2, v2, v204, v205
v_max3_f32 v2, v2, v206, v207
v_max3_f32 v3, v3, v208, v209
v_max3_f32 v3, v3, v210, v211
v_max3_f32 v3, v3, v212, v213
yav 176,228,76
wl 3
v_max3_f32 v3, v3, v214, v215
v_max3_f32 v3, v3, v216, v217
v_max3_f32 v3, v3, v218, v219
v_max3_f32 v3, v3, v220, v221
v_max3_f32 v3, v3, v222, v223
yav 160,232,80
ra 248,17,13312
yav 176,232,84
wl 3
yav 160,236,88
ra 252,18,13312
yav 176,236,92
wl 3
yav 160,240,96
ra 192,15,14336
yav 176,240,100
wl 3
yav 160,244,104
ra 196,16,14336
yav 176,244,108
wl 3
yav 160,248,112
ra 200,17,14336
yav 176,248,116
wl 3
s_add_u32 m0, s28, 0
s_mov_b32 s30, 24576
yav 160,252,120
ra 204,18,14336
yav 176,252,124
wl 3
wv 6
s_barrier
yav 160,192,128
ra 208,15,24576
dm 4,12,30,0
yav 176,192,132
wl 3
yav 160,196,136
ra 212,16,24576
yav 176,196,140
wl 3
yav 160,200,144
ra 216,17,24576
dm 5,12,30,1024
yav 176,200,148
wl 3
yav 160,204,152
ra 220,18,24576
yav 176,204,156
wl 3
v_mfma_f32_32x32x16_bf16 v[192:207], a[208:211], v[64:67], 0
ra 224,15,25600
dm 6,12,30,2048
v_mfma_f32_32x32x16_bf16 v[208:223], a[208:211], v[68:71], 0
wl 3
s_nop 3
v_max3_f32 v2, v2, v160, v161
v_max3_f32 v2, v2, v162, v163
v_max3_f32 v2, v2, v164, v165
v_max3_f32 v2, v2, v166, v167
v_max3_f32 v2, v2, v168, v169
v_max3_f32 v2, v2, v170, v171
yav 192,212,72
ra 228,16,25600
v_max3_f32 v2, v2, v172, v173
v_max3_f32 v2, v2, v174, v175
v_max3_f32 v3, v3, v176, v177
v_max3_f32 v3, v3, v178, v179
v_max3_f32 v3, v3, v180, v181
yav 208,212,76
wl 3
v_max3_f32 v3, v3, v182, v183
v_max3_f32 v3, v3, v184, v185
v_max3_f32 v3, v3, v186, v187
v_max3_f32 v3, v3, v188, v189
v_max3_f32 v3, v3, v190, v191
yav 192,216,80
ra 232,17,25600
yav 208,216,84
wl 3
yav 192,220,88
ra 236,18,25600
yav 208,220,92
wl 3
yav 192,224,96
ra 240,15,26624
yav 208,224,100
wl 3
yav 192,228,104
ra 244,16,26624
yav 208,228,108
wl 3
yav 192,232,112
ra 248,17,26624
yav 208,232,116
wl 3
s_add_u32 m0, s28, 12288
s_mov_b32 s30, 36864
yav 192,236,120
ra 252,18,26624
yav 208,236,124
wl 3
wv 6
s_barrier
yav 192,240,128
ra 192,15,36864
dm 4,12,30,0
yav 208,240,132
wl 3
yav 192,244,136
ra 196,16,36864
yav 208,244,140
wl 3
yav 192,248,144
ra 200,17,36864
dm 5,12,30,1024
yav 208,248,148
wl 3
yav 192,252,152
ra 204,18,36864
yav 208,252,156
wl 3
v_mfma_f32_32x32x16_bf16 v[160:175], a[192:195], v[64:67], 0
ra 208,15,37888
dm 6,12,30,2048
v_mfma_f32_32x32x16_bf16 v[176:191], a[192:195], v[68:71], 0
wl 3
s_nop 3
v_max3_f32 v2, v2, v192, v193
v_max3_f32 v2, v2, v194, v195
v_max3_f32 v2, v2, v196, v197
v_max3_f32 v2, v2, v198, v199
v_max3_f32 v2, v2, v200, v201
v_max3_f32 v2, v2, v202, v203
yav 160,196,72
ra 212,16,37888
v_max3_f32 v2, v2, v204, v205
v_max3_f32 v2, v2, v206, v207
v_max3_f32 v3, v3, v208, v209
v_max3_f32 v3, v3, v210, v211
v_max3_f32 v3, v3, v212, v213
yav 176,196,76
wl 3
v_max3_f32 v3, v3, v214, v215
v_max3_f32 v3, v3, v216, v217
v_max3_f32 v3, v3, v218, v219
v_max3_f32 v3, v3, v220, v221
v_max3_f32 v3, v3, v222, v223
v_mov_b32 v1, v2
yav 160,200,80
ra 216,17,37888
s_nop 1
v_permlane32_swap_b32 v2, v1
yav 176,200,84
wl 3
s_nop 1
v_max_f32 v2, v2, v1
v_mov_b32 v1, v3
yav 160,204,88
ra 220,18,37888
s_nop 1
v_permlane32_swap_b32 v3, v1
yav 176,204,92
wl 3
s_nop 1
v_max_f32 v3, v3, v1
yav 160,208,96
ra 224,15,38912
yav 176,208,100
wl 3
yav 160,212,104
ra 228,16,38912
yav 176,212,108
wl 3
yav 160,216,112
ra 232,17,38912
yav 176,216,116
wl 3
s_add_u32 m0, s28, 24576
s_mov_b32 s30, 49152
yav 160,220,120
ra 236,18,38912
yav 176,220,124
wl 3
wv 6
s_barrier
yav 160,224,128
ra 240,15,49152
dm 4,12,30,0
yav 176,224,132
wl 3
yav 160,228,136
ra 244,16,49152
yav 176,228,140
wl 3
yav 160,232,144
ra 248,17,49152
dm 5,12,30,1024
yav 176,232,148
wl 3
yav 160,236,152
ra 252,18,49152
yav 176,236,156
wl 3
v_mfma_f32_32x32x16_bf16 v[192:207], a[240:243], v[64:67], 0
ra 192,15,50176
dm 6,12,30,2048
v_mfma_f32_32x32x16_bf16 v[208:223], a[240:243], v[68:71], 0
wl 3
s_nop 3
v_sub_f32 v160, v160, v2
ex 160
v_sub_f32 v161, v161, v2
ex 161
yav 192,244,72
ra 196,16,50176
v_sub_f32 v162, v162, v2
ex 162
v_sub_f32 v163, v163, v2
yav 208,244,76
wl 3
ex 163
v_sub_f32 v164, v164, v2
ex 164
v_sub_f32 v165, v165, v2
yav 192,248,80
ra 200,17,50176
ex 165
cv 160,160,161
cv 162,162,163
v_sub_f32 v166, v166, v2
yav 208,248,84
wl 3
ex 166
v_sub_f32 v167, v167, v2
ex 167
cv 164,164,165
yav 192,252,88
ra 204,18,50176
v_sub_f32 v168, v168, v2
ex 168
v_sub_f32 v169, v169, v2
yav 208,252,92
wl 3
ex 169
cv 166,166,167
v_sub_f32 v170, v170, v2
ex 170
yav 192,192,96
ra 208,15,51200
v_sub_f32 v171, v171, v2
ex 171
cv 168,168,169
yav 208,192,100
wl 3
sw 160,164
v_sub_f32 v172, v172, v2
ex 172
v_sub_f32 v173, v173, v2
yav 192,196,104
ra 212,16,51200
ex 173
sw 162,166
cv 170,170,171
yav 208,196,108
wl 3
v_sub_f32 v174, v174, v2
ex 174
v_sub_f32 v175, v175, v2
ex 175
yav 192,200,112
ra 216,17,51200
aw 0,160
aw 4,164
cv 172,172,173
cv 174,174,175
aw 1,162
yav 208,200,116
wl 3
s_add_u32 m0, s28, 36864
s_mov_b32 s30, 61440
aw 5,166
sw 168,172
yav 192,204,120
ra 220,18,51200
sw 170,174
aw 2,168
aw 6,172
aw 3,170
yav 208,204,124
wl 3
wv 6
s_barrier
aw 7,174
v_sub_f32 v176, v176, v3
ex 176
yav 192,208,128
ra 224,15,0
dm 4,12,30,0
v_sub_f32 v177, v177, v3
ex 177
v_sub_f32 v178, v178, v3
yav 208,208,132
wl 3
ex 178
v_sub_f32 v179, v179, v3
ex 179
v_sub_f32 v180, v180, v3
yav 192,212,136
ra 228,16,0
ex 180
v_sub_f32 v181, v181, v3
ex 181
yav 208,212,140
wl 3
cv 176,176,177
cv 178,178,179
v_sub_f32 v182, v182, v3
ex 182
v_sub_f32 v183, v183, v3
yav 192,216,144
ra 232,17,0
dm 5,12,30,1024
ex 183
cv 180,180,181
v_sub_f32 v184, v184, v3
yav 208,216,148
wl 3
ex 184
v_sub_f32 v185, v185, v3
ex 185
cv 182,182,183
yav 192,220,152
ra 236,18,0
v_sub_f32 v186, v186, v3
ex 186
v_sub_f32 v187, v187, v3
yav 208,220,156
wl 3
ex 187
cv 184,184,185
sw 176,180
v_sub_f32 v188, v188, v3
ex 188
v_sub_f32 v189, v189, v3
ex 189
sw 178,182
cv 186,186,187
v_sub_f32 v190, v190, v3
ex 190
v_sub_f32 v191, v191, v3
ex 191
aw 8,176
aw 12,180
cv 188,188,189
cv 190,190,191
aw 9,178
aw 13,182
sw 184,188
sw 186,190
aw 10,184
aw 14,188
aw 11,186
aw 15,190
v_mfma_f32_32x32x16_bf16 v[160:175], a[224:227], v[64:67], 0
ra 240,15,1024
dm 6,12,30,2048
v_mfma_f32_32x32x16_bf16 v[176:191], a[224:227], v[68:71], 0
wl 3
v_sub_f32 v192, v192, v2
ex 192
v_sub_f32 v193, v193, v2
ex 193
yav 160,228,72
ra 244,16,1024
v_sub_f32 v194, v194, v2
ex 194
v_sub_f32 v195, v195, v2
yav 176,228,76
wl 3
ex 195
v_sub_f32 v196, v196, v2
ex 196
v_sub_f32 v197, v197, v2
yav 160,232,80
ra 248,17,1024
ex 197
cv 192,192,193
cv 194,194,195
v_sub_f32 v198, v198, v2
yav 176,232,84
wl 3
ex 198
v_sub_f32 v199, v199, v2
ex 199
cv 196,196,197
yav 160,236,88
ra 252,18,1024
v_sub_f32 v200, v200, v2
ex 200
v_sub_f32 v201, v201, v2
yav 176,236,92
wl 3
ex 201
cv 198,198,199
v_sub_f32 v202, v202, v2
ex 202
yav 160,240,96
ra 192,15,2048
v_sub_f32 v203, v203, v2
ex 203
cv 200,200,201
yav 176,240,100
wl 3
sw 192,196
v_sub_f32 v204, v204, v2
ex 204
v_sub_f32 v205, v205, v2
yav 160,244,104
ra 196,16,2048
ex 205
sw 194,198
cv 202,202,203
yav 176,244,108
wl 3
v_sub_f32 v206, v206, v2
ex 206
v_sub_f32 v207, v207, v2
ex 207
yav 160,248,112
ra 200,17,2048
aw 16,192
aw 20,196
cv 204,204,205
cv 206,206,207
aw 17,194
yav 176,248,116
wl 3
s_add_u32 m0, s28, 49152
s_mov_b32 s30, 73728
aw 21,198
sw 200,204
yav 160,252,120
ra 204,18,2048
sw 202,206
aw 18,200
aw 22,204
aw 19,202
yav 176,252,124
wl 3
wv 6
s_barrier
aw 23,206
v_sub_f32 v208, v208, v3
ex 208
yav 160,192,128
ra 208,15,12288
dm 4,12,30,0
v_sub_f32 v209, v209, v3
ex 209
v_sub_f32 v210, v210, v3
yav 176,192,132
wl 3
ex 210
v_sub_f32 v211, v211, v3
ex 211
v_sub_f32 v212, v212, v3
yav 160,196,136
ra 212,16,12288
ex 212
v_sub_f32 v213, v213, v3
ex 213
yav 176,196,140
wl 3
cv 208,208,209
cv 210,210,211
v_sub_f32 v214, v214, v3
ex 214
v_sub_f32 v215, v215, v3
yav 160,200,144
ra 216,17,12288
dm 5,12,30,1024
ex 215
cv 212,212,213
v_sub_f32 v216, v216, v3
yav 176,200,148
wl 3
ex 216
v_sub_f32 v217, v217, v3
ex 217
cv 214,214,215
yav 160,204,152
ra 220,18,12288
v_sub_f32 v218, v218, v3
ex 218
v_sub_f32 v219, v219, v3
yav 176,204,156
wl 3
ex 219
cv 216,216,217
sw 208,212
v_sub_f32 v220, v220, v3
ex 220
v_sub_f32 v221, v221, v3
ex 221
sw 210,214
cv 218,218,219
v_sub_f32 v222, v222, v3
ex 222
v_sub_f32 v223, v223, v3
ex 223
aw 24,208
aw 28,212
cv 220,220,221
cv 222,222,223
aw 25,210
aw 29,214
sw 216,220
sw 218,222
aw 26,216
aw 30,220
aw 27,218
aw 31,222
v_mfma_f32_32x32x16_bf16 v[192:207], a[208:211], v[64:67], 0
ra 224,15,13312
dm 6,12,30,2048
v_mfma_f32_32x32x16_bf16 v[208:223], a[208:211], v[68:71], 0
wl 3
v_sub_f32 v160, v160, v2
ex 160
v_sub_f32 v161, v161, v2
ex 161
yav 192,212,72
ra 228,16,13312
v_sub_f32 v162, v162, v2
ex 162
v_sub_f32 v163, v163, v2
yav 208,212,76
wl 3
ex 163
v_sub_f32 v164, v164, v2
ex 164
v_sub_f32 v165, v165, v2
yav 192,216,80
ra 232,17,13312
ex 165
cv 160,160,161
cv 162,162,163
v_sub_f32 v166, v166, v2
yav 208,216,84
wl 3
ex 166
v_sub_f32 v167, v167, v2
ex 167
cv 164,164,165
yav 192,220,88
ra 236,18,13312
v_sub_f32 v168, v168, v2
ex 168
v_sub_f32 v169, v169, v2
yav 208,220,92
wl 3
ex 169
cv 166,166,167
v_sub_f32 v170, v170, v2
ex 170
yav 192,224,96
ra 240,15,14336
v_sub_f32 v171, v171, v2
ex 171
cv 168,168,169
yav 208,224,100
wl 3
sw 160,164
v_sub_f32 v172, v172, v2
ex 172
v_sub_f32 v173, v173, v2
yav 192,228,104
ra 244,16,14336
ex 173
sw 162,166
cv 170,170,171
yav 208,228,108
wl 3
v_sub_f32 v174, v174, v2
ex 174
v_sub_f32 v175, v175, v2
ex 175
yav 192,232,112
ra 248,17,14336
aw 32,160
aw 36,164
cv 172,172,173
cv 174,174,175
aw 33,162
yav 208,232,116
wl 3
s_add_u32 m0, s28, 0
s_mov_b32 s30, 86016
aw 37,166
sw 168,172
yav 192,236,120
ra 252,18,14336
sw 170,174
aw 34,168
aw 38,172
aw 35,170
yav 208,236,124
wl 3
wv 6
s_barrier
aw 39,174
v_sub_f32 v176, v176, v3
ex 176
yav 192,240,128
ra 192,15,24576
dm 4,12,30,0
v_sub_f32 v177, v177, v3
ex 177
v_sub_f32 v178, v178, v3
yav 208,240,132
wl 3
ex 178
v_sub_f32 v179, v179, v3
ex 179
v_sub_f32 v180, v180, v3
yav 192,244,136
ra 196,16,24576
ex 180
v_sub_f32 v181, v181, v3
ex 181
yav 208,244,140
wl 3
cv 176,176,177
cv 178,178,179
v_sub_f32 v182, v182, v3
ex 182
v_sub_f32 v183, v183, v3
yav 192,248,144
ra 200,17,24576
dm 5,12,30,1024
ex 183
cv 180,180,181
v_sub_f32 v184, v184, v3
yav 208,248,148
wl 3
ex 184
v_sub_f32 v185, v185, v3
ex 185
cv 182,182,183
yav 192,252,152
ra 204,18,24576
v_sub_f32 v186, v186, v3
ex 186
v_sub_f32 v187, v187, v3
yav 208,252,156
wl 3
ex 187
cv 184,184,185
sw 176,180
v_sub_f32 v188, v188, v3
ex 188
v_sub_f32 v189, v189, v3
ex 189
sw 178,182
cv 186,186,187
v_sub_f32 v190, v190, v3
ex 190
v_sub_f32 v191, v191, v3
ex 191
aw 40,176
aw 44,180
cv 188,188,189
cv 190,190,191
aw 41,178
aw 45,182
sw 184,188
sw 186,190
aw 42,184
aw 46,188
aw 43,186
aw 47,190
v_mfma_f32_32x32x16_bf16 v[160:175], a[192:195], v[64:67], 0
ra 208,15,25600
dm 6,12,30,2048
v_mfma_f32_32x32x16_bf16 v[176:191], a[192:195], v[68:71], 0
wl 3
v_sub_f32 v192, v192, v2
ex 192
v_sub_f32 v193, v193, v2
ex 193
yav 160,196,72
ra 212,16,25600
v_sub_f32 v194, v194, v2
ex 194
v_sub_f32 v195, v195, v2
yav 176,196,76
wl 3
ex 195
v_sub_f32 v196, v196, v2
ex 196
v_sub_f32 v197, v197, v2
yav 160,200,80
ra 216,17,25600
ex 197
cv 192,192,193
cv 194,194,195
v_sub_f32 v198, v198, v2
yav 176,200,84
wl 3
ex 198
v_sub_f32 v199, v199, v2
ex 199
cv 196,196,197
yav 160,204,88
ra 220,18,25600
v_sub_f32 v200, v200, v2
ex 200
v_sub_f32 v201, v201, v2
yav 176,204,92
wl 3
ex 201
cv 198,198,199
v_sub_f32 v202, v202, v2
ex 202
yav 160,208,96
ra 224,15,26624
v_sub_f32 v203, v203, v2
ex 203
cv 200,200,201
yav 176,208,100
wl 3
sw 192,196
v_sub_f32 v204, v204, v2
ex 204
v_sub_f32 v205, v205, v2
yav 160,212,104
ra 228,16,26624
ex 205
sw 194,198
cv 202,202,203
yav 176,212,108
wl 3
v_sub_f32 v206, v206, v2
ex 206
v_sub_f32 v207, v207, v2
ex 207
yav 160,216,112
ra 232,17,26624
aw 48,192
aw 52,196
cv 204,204,205
cv 206,206,207
aw 49,194
yav 176,216,116
wl 3
s_add_u32 m0, s28, 12288
s_mov_b32 s30, 98304
aw 53,198
sw 200,204
yav 160,220,120
ra 236,18,26624
sw 202,206
aw 50,200
aw 54,204
aw 51,202
yav 176,220,124
wl 3
wv 6
s_barrier
aw 55,206
v_sub_f32 v208, v208, v3
ex 208
yav 160,224,128
ra 240,15,36864
dm 4,12,30,0
v_sub_f32 v209, v209, v3
ex 209
v_sub_f32 v210, v210, v3
yav 176,224,132
wl 3
ex 210
v_sub_f32 v211, v211, v3
ex 211
v_sub_f32 v212, v212, v3
yav 160,228,136
ra 244,16,36864
ex 212
v_sub_f32 v213, v213, v3
ex 213
yav 176,228,140
wl 3
cv 208,208,209
cv 210,210,211
v_sub_f32 v214, v214, v3
ex 214
v_sub_f32 v215, v215, v3
yav 160,232,144
ra 248,17,36864
dm 5,12,30,1024
ex 215
cv 212,212,213
v_sub_f32 v216, v216, v3
yav 176,232,148
wl 3
ex 216
v_sub_f32 v217, v217, v3
ex 217
cv 214,214,215
yav 160,236,152
ra 252,18,36864
v_sub_f32 v218, v218, v3
ex 218
v_sub_f32 v219, v219, v3
yav 176,236,156
wl 3
ex 219
cv 216,216,217
sw 208,212
v_sub_f32 v220, v220, v3
ex 220
v_sub_f32 v221, v221, v3
ex 221
sw 210,214
cv 218,218,219
v_sub_f32 v222, v222, v3
ex 222
v_sub_f32 v223, v223, v3
ex 223
aw 56,208
aw 60,212
cv 220,220,221
cv 222,222,223
aw 57,210
aw 61,214
sw 216,220
sw 218,222
aw 58,216
aw 62,220
aw 59,218
aw 63,222
v_mfma_f32_32x32x16_bf16 v[192:207], a[240:243], v[64:67], 0
ra 192,15,37888
dm 6,12,30,2048
v_mfma_f32_32x32x16_bf16 v[208:223], a[240:243], v[68:71], 0
wl 3
v_sub_f32 v160, v160, v2
ex 160
v_sub_f32 v161, v161, v2
ex 161
yav 192,244,72
ra 196,16,37888
v_sub_f32 v162, v162, v2
ex 162
v_sub_f32 v163, v163, v2
yav 208,244,76
wl 3
ex 163
v_sub_f32 v164, v164, v2
ex 164
v_sub_f32 v165, v165, v2
yav 192,248,80
ra 200,17,37888
ex 165
cv 160,160,161
cv 162,162,163
v_sub_f32 v166, v166, v2
yav 208,248,84
wl 3
ex 166
v_sub_f32 v167, v167, v2
ex 167
cv 164,164,165
yav 192,252,88
ra 204,18,37888
v_sub_f32 v168, v168, v2
ex 168
v_sub_f32 v169, v169, v2
yav 208,252,92
wl 3
ex 169
cv 166,166,167
v_sub_f32 v170, v170, v2
ex 170
yav 192,192,96
ra 208,15,38912
v_sub_f32 v171, v171, v2
ex 171
cv 168,168,169
yav 208,192,100
wl 3
sw 160,164
v_sub_f32 v172, v172, v2
ex 172
v_sub_f32 v173, v173, v2
yav 192,196,104
ra 212,16,38912
ex 173
sw 162,166
cv 170,170,171
yav 208,196,108
wl 3
v_sub_f32 v174, v174, v2
ex 174
v_sub_f32 v175, v175, v2
ex 175
yav 192,200,112
ra 216,17,38912
aw 64,160
aw 68,164
cv 172,172,173
cv 174,174,175
aw 65,162
yav 208,200,116
wl 3
s_add_u32 m0, s28, 24576
s_mov_b32 s30, 110592
aw 69,166
sw 168,172
yav 192,204,120
ra 220,18,38912
sw 170,174
aw 66,168
aw 70,172
aw 67,170
yav 208,204,124
wl 3
wv 6
s_barrier
aw 71,174
v_sub_f32 v176, v176, v3
ex 176
yav 192,208,128
ra 224,15,49152
dm 4,12,30,0
v_sub_f32 v177, v177, v3
ex 177
v_sub_f32 v178, v178, v3
yav 208,208,132
wl 3
ex 178
v_sub_f32 v179, v179, v3
ex 179
v_sub_f32 v180, v180, v3
yav 192,212,136
ra 228,16,49152
ex 180
v_sub_f32 v181, v181, v3
ex 181
yav 208,212,140
wl 3
cv 176,176,177
cv 178,178,179
v_sub_f32 v182, v182, v3
ex 182
v_sub_f32 v183, v183, v3
yav 192,216,144
ra 232,17,49152
dm 5,12,30,1024
ex 183
cv 180,180,181
v_sub_f32 v184, v184, v3
yav 208,216,148
wl 3
ex 184
v_sub_f32 v185, v185, v3
ex 185
cv 182,182,183
yav 192,220,152
ra 236,18,49152
v_sub_f32 v186, v186, v3
ex 186
v_sub_f32 v187, v187, v3
yav 208,220,156
wl 3
ex 187
cv 184,184,185
sw 176,180
v_sub_f32 v188, v188, v3
ex 188
v_sub_f32 v189, v189, v3
ex 189
sw 178,182
cv 186,186,187
v_sub_f32 v190, v190, v3
ex 190
v_sub_f32 v191, v191, v3
ex 191
aw 72,176
aw 76,180
cv 188,188,189
cv 190,190,191
aw 73,178
aw 77,182
sw 184,188
sw 186,190
aw 74,184
aw 78,188
aw 75,186
aw 79,190
v_mfma_f32_32x32x16_bf16 v[160:175], a[224:227], v[64:67], 0
ra 240,15,50176
dm 6,12,30,2048
v_mfma_f32_32x32x16_bf16 v[176:191], a[224:227], v[68:71], 0
wl 3
v_sub_f32 v192, v192, v2
ex 192
v_sub_f32 v193, v193, v2
ex 193
yav 160,228,72
ra 244,16,50176
v_sub_f32 v194, v194, v2
ex 194
v_sub_f32 v195, v195, v2
yav 176,228,76
wl 3
ex 195
v_sub_f32 v196, v196, v2
ex 196
v_sub_f32 v197, v197, v2
yav 160,232,80
ra 248,17,50176
ex 197
cv 192,192,193
cv 194,194,195
v_sub_f32 v198, v198, v2
yav 176,232,84
wl 3
ex 198
v_sub_f32 v199, v199, v2
ex 199
cv 196,196,197
yav 160,236,88
ra 252,18,50176
v_sub_f32 v200, v200, v2
ex 200
v_sub_f32 v201, v201, v2
yav 176,236,92
wl 3
ex 201
cv 198,198,199
v_sub_f32 v202, v202, v2
ex 202
yav 160,240,96
ra 192,15,51200
v_sub_f32 v203, v203, v2
ex 203
cv 200,200,201
yav 176,240,100
wl 3
sw 192,196
v_sub_f32 v204, v204, v2
ex 204
v_sub_f32 v205, v205, v2
yav 160,244,104
ra 196,16,51200
ex 205
sw 194,198
cv 202,202,203
yav 176,244,108
wl 3
v_sub_f32 v206, v206, v2
ex 206
v_sub_f32 v207, v207, v2
ex 207
yav 160,248,112
ra 200,17,51200
aw 80,192
aw 84,196
cv 204,204,205
cv 206,206,207
aw 81,194
yav 176,248,116
wl 3
s_add_u32 m0, s28, 36864
s_mov_b32 s30, 122880
aw 85,198
sw 200,204
yav 160,252,120
ra 204,18,51200
sw 202,206
aw 82,200
aw 86,204
aw 83,202
yav 176,252,124
wl 3
wv 6
s_barrier
aw 87,206
v_sub_f32 v208, v208, v3
ex 208
yav 160,192,128
ra 208,15,0
dm 4,12,30,0
v_sub_f32 v209, v209, v3
ex 209
v_sub_f32 v210, v210, v3
yav 176,192,132
wl 3
ex 210
v_sub_f32 v211, v211, v3
ex 211
v_sub_f32 v212, v212, v3
yav 160,196,136
ra 212,16,0
ex 212
v_sub_f32 v213, v213, v3
ex 213
yav 176,196,140
wl 3
cv 208,208,209
cv 210,210,211
v_sub_f32 v214, v214, v3
ex 214
v_sub_f32 v215, v215, v3
yav 160,200,144
ra 216,17,0
dm 5,12,30,1024
ex 215
cv 212,212,213
v_sub_f32 v216, v216, v3
yav 176,200,148
wl 3
ex 216
v_sub_f32 v217, v217, v3
ex 217
cv 214,214,215
yav 160,204,152
ra 220,18,0
v_sub_f32 v218, v218, v3
ex 218
v_sub_f32 v219, v219, v3
yav 176,204,156
wl 3
ex 219
cv 216,216,217
sw 208,212
v_sub_f32 v220, v220, v3
ex 220
v_sub_f32 v221, v221, v3
ex 221
sw 210,214
cv 218,218,219
v_sub_f32 v222, v222, v3
ex 222
v_sub_f32 v223, v223, v3
ex 223
aw 88,208
aw 92,212
cv 220,220,221
cv 222,222,223
aw 89,210
aw 93,214
sw 216,220
sw 218,222
aw 90,216
aw 94,220
aw 91,218
aw 95,222
v_mfma_f32_32x32x16_bf16 v[192:207], a[208:211], v[64:67], 0
ra 224,15,1024
dm 6,12,30,2048
v_mfma_f32_32x32x16_bf16 v[208:223], a[208:211], v[68:71], 0
wl 3
v_sub_f32 v160, v160, v2
ex 160
v_sub_f32 v161, v161, v2
ex 161
yav 192,212,72
ra 228,16,1024
v_sub_f32 v162, v162, v2
ex 162
v_sub_f32 v163, v163, v2
yav 208,212,76
wl 3
ex 163
v_sub_f32 v164, v164, v2
ex 164
v_sub_f32 v165, v165, v2
yav 192,216,80
ra 232,17,1024
ex 165
cv 160,160,161
cv 162,162,163
v_sub_f32 v166, v166, v2
yav 208,216,84
wl 3
ex 166
v_sub_f32 v167, v167, v2
ex 167
cv 164,164,165
yav 192,220,88
ra 236,18,1024
v_sub_f32 v168, v168, v2
ex 168
v_sub_f32 v169, v169, v2
yav 208,220,92
wl 3
ex 169
cv 166,166,167
v_sub_f32 v170, v170, v2
ex 170
yav 192,224,96
ra 240,15,2048
v_sub_f32 v171, v171, v2
ex 171
cv 168,168,169
yav 208,224,100
wl 3
sw 160,164
v_sub_f32 v172, v172, v2
ex 172
v_sub_f32 v173, v173, v2
yav 192,228,104
ra 244,16,2048
ex 173
sw 162,166
cv 170,170,171
yav 208,228,108
wl 3
v_sub_f32 v174, v174, v2
ex 174
v_sub_f32 v175, v175, v2
ex 175
yav 192,232,112
ra 248,17,2048
aw 96,160
aw 100,164
cv 172,172,173
cv 174,174,175
aw 97,162
yav 208,232,116
wl 3
s_add_u32 m0, s28, 49152
s_mov_b32 s30, 135168
aw 101,166
sw 168,172
yav 192,236,120
ra 252,18,2048
sw 170,174
aw 98,168
aw 102,172
aw 99,170
yav 208,236,124
wl 3
wv 6
s_barrier
aw 103,174
v_sub_f32 v176, v176, v3
ex 176
yav 192,240,128
ra 192,15,12288
dm 4,12,30,0
v_sub_f32 v177, v177, v3
ex 177
v_sub_f32 v178, v178, v3
yav 208,240,132
wl 3
ex 178
v_sub_f32 v179, v179, v3
ex 179
v_sub_f32 v180, v180, v3
yav 192,244,136
ra 196,16,12288
ex 180
v_sub_f32 v181, v181, v3
ex 181
yav 208,244,140
wl 3
cv 176,176,177
cv 178,178,179
v_sub_f32 v182, v182, v3
ex 182
v_sub_f32 v183, v183, v3
yav 192,248,144
ra 200,17,12288
dm 5,12,30,1024
ex 183
cv 180,180,181
v_sub_f32 v184, v184, v3
yav 208,248,148
wl 3
ex 184
v_sub_f32 v185, v185, v3
ex 185
cv 182,182,183
yav 192,252,152
ra 204,18,12288
v_sub_f32 v186, v186, v3
ex 186
v_sub_f32 v187, v187, v3
yav 208,252,156
wl 3
ex 187
cv 184,184,185
sw 176,180
v_sub_f32 v188, v188, v3
ex 188
v_sub_f32 v189, v189, v3
ex 189
sw 178,182
cv 186,186,187
v_sub_f32 v190, v190, v3
ex 190
v_sub_f32 v191, v191, v3
ex 191
aw 104,176
aw 108,180
cv 188,188,189
cv 190,190,191
aw 105,178
aw 109,182
sw 184,188
sw 186,190
aw 106,184
aw 110,188
aw 107,186
aw 111,190
v_mfma_f32_32x32x16_bf16 v[160:175], a[192:195], v[64:67], 0
ra 208,15,13312
dm 6,12,30,2048
v_mfma_f32_32x32x16_bf16 v[176:191], a[192:195], v[68:71], 0
wl 3
v_sub_f32 v192, v192, v2
ex 192
v_sub_f32 v193, v193, v2
ex 193
yav 160,196,72
ra 212,16,13312
v_sub_f32 v194, v194, v2
ex 194
v_sub_f32 v195, v195, v2
yav 176,196,76
wl 3
ex 195
v_sub_f32 v196, v196, v2
ex 196
v_sub_f32 v197, v197, v2
yav 160,200,80
ra 216,17,13312
ex 197
cv 192,192,193
cv 194,194,195
v_sub_f32 v198, v198, v2
yav 176,200,84
wl 3
ex 198
v_sub_f32 v199, v199, v2
ex 199
cv 196,196,197
yav 160,204,88
ra 220,18,13312
v_sub_f32 v200, v200, v2
ex 200
v_sub_f32 v201, v201, v2
yav 176,204,92
wl 3
ex 201
cv 198,198,199
v_sub_f32 v202, v202, v2
ex 202
yav 160,208,96
ra 224,15,14336
v_sub_f32 v203, v203, v2
ex 203
cv 200,200,201
yav 176,208,100
wl 3
sw 192,196
v_sub_f32 v204, v204, v2
ex 204
v_sub_f32 v205, v205, v2
yav 160,212,104
ra 228,16,14336
ex 205
sw 194,198
cv 202,202,203
yav 176,212,108
wl 3
v_sub_f32 v206, v206, v2
ex 206
v_sub_f32 v207, v207, v2
ex 207
yav 160,216,112
ra 232,17,14336
aw 112,192
aw 116,196
cv 204,204,205
cv 206,206,207
aw 113,194
yav 176,216,116
wl 3
s_add_u32 m0, s28, 0
s_mov_b32 s30, 147456
aw 117,198
sw 200,204
yav 160,220,120
ra 236,18,14336
sw 202,206
aw 114,200
aw 118,204
aw 115,202
yav 176,220,124
wl 3
wv 6
s_barrier
aw 119,206
v_sub_f32 v208, v208, v3
ex 208
yav 160,224,128
ra 240,15,24576
dm 4,12,30,0
v_sub_f32 v209, v209, v3
ex 209
v_sub_f32 v210, v210, v3
yav 176,224,132
wl 3
ex 210
v_sub_f32 v211, v211, v3
ex 211
v_sub_f32 v212, v212, v3
yav 160,228,136
ra 244,16,24576
ex 212
v_sub_f32 v213, v213, v3
ex 213
yav 176,228,140
wl 3
cv 208,208,209
cv 210,210,211
v_sub_f32 v214, v214, v3
ex 214
v_sub_f32 v215, v215, v3
yav 160,232,144
ra 248,17,24576
dm 5,12,30,1024
ex 215
cv 212,212,213
v_sub_f32 v216, v216, v3
yav 176,232,148
wl 3
ex 216
v_sub_f32 v217, v217, v3
ex 217
cv 214,214,215
yav 160,236,152
ra 252,18,24576
v_sub_f32 v218, v218, v3
ex 218
v_sub_f32 v219, v219, v3
yav 176,236,156
wl 3
ex 219
cv 216,216,217
sw 208,212
v_sub_f32 v220, v220, v3
ex 220
v_sub_f32 v221, v221, v3
ex 221
sw 210,214
cv 218,218,219
v_sub_f32 v222, v222, v3
ex 222
v_sub_f32 v223, v223, v3
ex 223
aw 120,208
aw 124,212
cv 220,220,221
cv 222,222,223
aw 121,210
aw 125,214
sw 216,220
sw 218,222
aw 122,216
aw 126,220
aw 123,218
aw 127,222
v_mfma_f32_32x32x16_bf16 v[192:207], a[240:243], v[64:67], 0
ra 192,15,25600
dm 6,12,30,2048
v_mfma_f32_32x32x16_bf16 v[208:223], a[240:243], v[68:71], 0
wl 3
v_sub_f32 v160, v160, v2
ex 160
v_sub_f32 v161, v161, v2
ex 161
yav 192,244,72
ra 196,16,25600
v_sub_f32 v162, v162, v2
ex 162
v_sub_f32 v163, v163, v2
yav 208,244,76
wl 3
ex 163
v_sub_f32 v164, v164, v2
ex 164
v_sub_f32 v165, v165, v2
yav 192,248,80
ra 200,17,25600
ex 165
cv 160,160,161
cv 162,162,163
v_sub_f32 v166, v166, v2
yav 208,248,84
wl 3
ex 166
v_sub_f32 v167, v167, v2
ex 167
cv 164,164,165
yav 192,252,88
ra 204,18,25600
v_sub_f32 v168, v168, v2
ex 168
v_sub_f32 v169, v169, v2
yav 208,252,92
wl 3
ex 169
cv 166,166,167
v_sub_f32 v170, v170, v2
ex 170
yav 192,192,96
ra 208,15,26624
v_sub_f32 v171, v171, v2
ex 171
cv 168,168,169
yav 208,192,100
wl 3
sw 160,164
v_sub_f32 v172, v172, v2
ex 172
v_sub_f32 v173, v173, v2
yav 192,196,104
ra 212,16,26624
ex 173
sw 162,166
cv 170,170,171
yav 208,196,108
wl 3
v_sub_f32 v174, v174, v2
ex 174
v_sub_f32 v175, v175, v2
ex 175
yav 192,200,112
ra 216,17,26624
aw 128,160
aw 132,164
cv 172,172,173
cv 174,174,175
aw 129,162
yav 208,200,116
wl 3
s_add_u32 m0, s28, 12288
s_mov_b32 s30, 159744
aw 133,166
sw 168,172
yav 192,204,120
ra 220,18,26624
sw 170,174
aw 130,168
aw 134,172
aw 131,170
yav 208,204,124
wl 3
wv 6
s_barrier
aw 135,174
v_sub_f32 v176, v176, v3
ex 176
yav 192,208,128
ra 224,15,36864
dm 4,12,30,0
v_sub_f32 v177, v177, v3
ex 177
v_sub_f32 v178, v178, v3
yav 208,208,132
wl 3
ex 178
v_sub_f32 v179, v179, v3
ex 179
v_sub_f32 v180, v180, v3
yav 192,212,136
ra 228,16,36864
ex 180
v_sub_f32 v181, v181, v3
ex 181
yav 208,212,140
wl 3
cv 176,176,177
cv 178,178,179
v_sub_f32 v182, v182, v3
ex 182
v_sub_f32 v183, v183, v3
yav 192,216,144
ra 232,17,36864
dm 5,12,30,1024
ex 183
cv 180,180,181
v_sub_f32 v184, v184, v3
yav 208,216,148
wl 3
ex 184
v_sub_f32 v185, v185, v3
ex 185
cv 182,182,183
yav 192,220,152
ra 236,18,36864
v_sub_f32 v186, v186, v3
ex 186
v_sub_f32 v187, v187, v3
yav 208,220,156
wl 3
ex 187
cv 184,184,185
sw 176,180
v_sub_f32 v188, v188, v3
ex 188
v_sub_f32 v189, v189, v3
ex 189
sw 178,182
cv 186,186,187
v_sub_f32 v190, v190, v3
ex 190
v_sub_f32 v191, v191, v3
ex 191
aw 136,176
aw 140,180
cv 188,188,189
cv 190,190,191
aw 137,178
aw 141,182
sw 184,188
sw 186,190
aw 138,184
aw 142,188
aw 139,186
aw 143,190
v_mfma_f32_32x32x16_bf16 v[160:175], a[224:227], v[64:67], 0
ra 240,15,37888
dm 6,12,30,2048
v_mfma_f32_32x32x16_bf16 v[176:191], a[224:227], v[68:71], 0
wl 3
v_sub_f32 v192, v192, v2
ex 192
v_sub_f32 v193, v193, v2
ex 193
yav 160,228,72
ra 244,16,37888
v_sub_f32 v194, v194, v2
ex 194
v_sub_f32 v195, v195, v2
yav 176,228,76
wl 3
ex 195
v_sub_f32 v196, v196, v2
ex 196
v_sub_f32 v197, v197, v2
yav 160,232,80
ra 248,17,37888
ex 197
cv 192,192,193
cv 194,194,195
v_sub_f32 v198, v198, v2
yav 176,232,84
wl 3
ex 198
v_sub_f32 v199, v199, v2
ex 199
cv 196,196,197
yav 160,236,88
ra 252,18,37888
v_sub_f32 v200, v200, v2
ex 200
v_sub_f32 v201, v201, v2
yav 176,236,92
wl 3
ex 201
cv 198,198,199
v_sub_f32 v202, v202, v2
ex 202
yav 160,240,96
ra 192,15,38912
v_sub_f32 v203, v203, v2
ex 203
cv 200,200,201
yav 176,240,100
wl 3
sw 192,196
v_sub_f32 v204, v204, v2
ex 204
v_sub_f32 v205, v205, v2
yav 160,244,104
ra 196,16,38912
ex 205
sw 194,198
cv 202,202,203
yav 176,244,108
wl 3
v_sub_f32 v206, v206, v2
ex 206
v_sub_f32 v207, v207, v2
ex 207
yav 160,248,112
ra 200,17,38912
aw 144,192
aw 148,196
cv 204,204,205
cv 206,206,207
aw 145,194
yav 176,248,116
wl 3
s_add_u32 m0, s28, 24576
s_mov_b32 s30, 172032
aw 149,198
sw 200,204
yav 160,252,120
ra 204,18,38912
sw 202,206
aw 146,200
aw 150,204
aw 147,202
yav 176,252,124
wl 3
wv 6
s_barrier
aw 151,206
v_sub_f32 v208, v208, v3
ex 208
yav 160,192,128
ra 208,15,49152
dm 4,12,30,0
v_sub_f32 v209, v209, v3
ex 209
v_sub_f32 v210, v210, v3
yav 176,192,132
wl 3
ex 210
v_sub_f32 v211, v211, v3
ex 211
v_sub_f32 v212, v212, v3
yav 160,196,136
ra 212,16,49152
ex 212
v_sub_f32 v213, v213, v3
ex 213
yav 176,196,140
wl 3
cv 208,208,209
cv 210,210,211
v_sub_f32 v214, v214, v3
ex 214
v_sub_f32 v215, v215, v3
yav 160,200,144
ra 216,17,49152
dm 5,12,30,1024
ex 215
cv 212,212,213
v_sub_f32 v216, v216, v3
yav 176,200,148
wl 3
ex 216
v_sub_f32 v217, v217, v3
ex 217
cv 214,214,215
yav 160,204,152
ra 220,18,49152
v_sub_f32 v218, v218, v3
ex 218
v_sub_f32 v219, v219, v3
yav 176,204,156
wl 3
ex 219
cv 216,216,217
sw 208,212
v_sub_f32 v220, v220, v3
ex 220
v_sub_f32 v221, v221, v3
ex 221
sw 210,214
cv 218,218,219
v_sub_f32 v222, v222, v3
ex 222
v_sub_f32 v223, v223, v3
ex 223
aw 152,208
aw 156,212
cv 220,220,221
cv 222,222,223
aw 153,210
aw 157,214
sw 216,220
sw 218,222
aw 154,216
aw 158,220
aw 155,218
aw 159,222
v_mfma_f32_32x32x16_bf16 v[192:207], a[208:211], v[64:67], 0
ra 224,15,50176
dm 6,12,30,2048
v_mfma_f32_32x32x16_bf16 v[208:223], a[208:211], v[68:71], 0
wl 3
v_sub_f32 v160, v160, v2
ex 160
v_sub_f32 v161, v161, v2
ex 161
yav 192,212,72
ra 228,16,50176
v_sub_f32 v162, v162, v2
ex 162
v_sub_f32 v163, v163, v2
yav 208,212,76
wl 3
ex 163
v_sub_f32 v164, v164, v2
ex 164
v_sub_f32 v165, v165, v2
yav 192,216,80
ra 232,17,50176
ex 165
cv 160,160,161
cv 162,162,163
v_sub_f32 v166, v166, v2
yav 208,216,84
wl 3
ex 166
v_sub_f32 v167, v167, v2
ex 167
cv 164,164,165
yav 192,220,88
ra 236,18,50176
v_sub_f32 v168, v168, v2
ex 168
v_sub_f32 v169, v169, v2
yav 208,220,92
wl 3
ex 169
cv 166,166,167
v_sub_f32 v170, v170, v2
ex 170
yav 192,224,96
ra 240,15,51200
v_sub_f32 v171, v171, v2
ex 171
cv 168,168,169
yav 208,224,100
wl 3
sw 160,164
v_sub_f32 v172, v172, v2
ex 172
v_sub_f32 v173, v173, v2
yav 192,228,104
ra 244,16,51200
ex 173
sw 162,166
cv 170,170,171
yav 208,228,108
wl 3
v_sub_f32 v174, v174, v2
ex 174
v_sub_f32 v175, v175, v2
ex 175
yav 192,232,112
ra 248,17,51200
aw 160,160
aw 164,164
cv 172,172,173
cv 174,174,175
aw 161,162
yav 208,232,116
wl 3
s_add_u32 m0, s28, 36864
s_mov_b32 s30, 184320
aw 165,166
sw 168,172
yav 192,236,120
ra 252,18,51200
sw 170,174
aw 162,168
aw 166,172
aw 163,170
yav 208,236,124
wl 3
wv 6
s_barrier
aw 167,174
v_sub_f32 v176, v176, v3
ex 176
yav 192,240,128
ra 192,15,0
dm 4,12,30,0
v_sub_f32 v177, v177, v3
ex 177
v_sub_f32 v178, v178, v3
yav 208,240,132
wl 3
ex 178
v_sub_f32 v179, v179, v3
ex 179
v_sub_f32 v180, v180, v3
yav 192,244,136
ra 196,16,0
ex 180
v_sub_f32 v181, v181, v3
ex 181
yav 208,244,140
wl 3
cv 176,176,177
cv 178,178,179
v_sub_f32 v182, v182, v3
ex 182
v_sub_f32 v183, v183, v3
yav 192,248,144
ra 200,17,0
dm 5,12,30,1024
ex 183
cv 180,180,181
v_sub_f32 v184, v184, v3
yav 208,248,148
wl 3
ex 184
v_sub_f32 v185, v185, v3
ex 185
cv 182,182,183
yav 192,252,152
ra 204,18,0
v_sub_f32 v186, v186, v3
ex 186
v_sub_f32 v187, v187, v3
yav 208,252,156
wl 3
ex 187
cv 184,184,185
sw 176,180
v_sub_f32 v188, v188, v3
ex 188
v_sub_f32 v189, v189, v3
ex 189
sw 178,182
cv 186,186,187
v_sub_f32 v190, v190, v3
ex 190
v_sub_f32 v191, v191, v3
ex 191
aw 168,176
aw 172,180
cv 188,188,189
cv 190,190,191
aw 169,178
aw 173,182
sw 184,188
sw 186,190
aw 170,184
aw 174,188
aw 171,186
aw 175,190
v_mfma_f32_32x32x16_bf16 v[160:175], a[192:195], v[64:67], 0
ra 208,15,1024
dm 6,12,30,2048
v_mfma_f32_32x32x16_bf16 v[176:191], a[192:195], v[68:71], 0
wl 3
s_add_u32 m0, s29, 0
s_mov_b32 s30, 0
v_sub_f32 v192, v192, v2
ex 192
v_sub_f32 v193, v193, v2
yav 160,196,72
ra 212,16,1024
ex 193
v_sub_f32 v194, v194, v2
ex 194
yav 176,196,76
wl 3
v_sub_f32 v195, v195, v2
ex 195
v_sub_f32 v196, v196, v2
ex 196
yav 160,200,80
ra 216,17,1024
dm 7,16,30,0
v_sub_f32 v197, v197, v2
ex 197
cv 192,192,193
yav 176,200,84
wl 3
cv 194,194,195
v_sub_f32 v198, v198, v2
ex 198
v_sub_f32 v199, v199, v2
yav 160,204,88
ra 220,18,1024
ex 199
cv 196,196,197
v_sub_f32 v200, v200, v2
yav 176,204,92
wl 3
ex 200
v_sub_f32 v201, v201, v2
ex 201
cv 198,198,199
yav 160,208,96
ra 224,15,2048
dm 8,16,30,1024
v_sub_f32 v202, v202, v2
ex 202
v_sub_f32 v203, v203, v2
yav 176,208,100
wl 3
ex 203
cv 200,200,201
sw 192,196
v_sub_f32 v204, v204, v2
yav 160,212,104
ra 228,16,2048
ex 204
v_sub_f32 v205, v205, v2
ex 205
yav 176,212,108
wl 3
sw 194,198
cv 202,202,203
v_sub_f32 v206, v206, v2
ex 206
yav 160,216,112
ra 232,17,2048
dm 9,16,30,2048
v_sub_f32 v207, v207, v2
ex 207
aw 176,192
yav 176,216,116
wl 3
aw 180,196
cv 204,204,205
cv 206,206,207
aw 177,194
aw 181,198
yav 160,220,120
ra 236,18,2048
sw 200,204
sw 202,206
aw 178,200
yav 176,220,124
wl 3
wv 9
s_barrier
aw 182,204
aw 179,202
aw 183,206
v_sub_f32 v208, v208, v3
yav 160,224,128
ra 240,15,12288
dm 10,16,30,3072
ex 208
v_sub_f32 v209, v209, v3
yav 176,224,132
wl 3
ex 209
v_sub_f32 v210, v210, v3
ex 210
v_sub_f32 v211, v211, v3
yav 160,228,136
ra 244,16,12288
ex 211
v_sub_f32 v212, v212, v3
ex 212
yav 176,228,140
wl 3
v_sub_f32 v213, v213, v3
ex 213
cv 208,208,209
cv 210,210,211
v_sub_f32 v214, v214, v3
yav 160,232,144
ra 248,17,12288
ex 214
v_sub_f32 v215, v215, v3
ex 215
yav 176,232,148
wl 3
cv 212,212,213
v_sub_f32 v216, v216, v3
ex 216
v_sub_f32 v217, v217, v3
yav 160,236,152
ra 252,18,12288
s_add_u32 m0, s29, 16384
s_mov_b32 s30, 49152
ex 217
cv 214,214,215
yav 176,236,156
wl 3
v_sub_f32 v218, v218, v3
ex 218
v_sub_f32 v219, v219, v3
ex 219
cv 216,216,217
sw 208,212
v_sub_f32 v220, v220, v3
ex 220
v_sub_f32 v221, v221, v3
ex 221
sw 210,214
cv 218,218,219
v_sub_f32 v222, v222, v3
ex 222
v_sub_f32 v223, v223, v3
ex 223
aw 184,208
aw 188,212
cv 220,220,221
cv 222,222,223
aw 185,210
aw 189,214
sw 216,220
sw 218,222
aw 186,216
aw 190,220
aw 187,218
aw 191,222
v_mfma_f32_32x32x16_bf16 v[192:207], a[240:243], v[64:67], 0
ra 192,15,13312
v_mfma_f32_32x32x16_bf16 v[208:223], a[240:243], v[68:71], 0
wl 3
dm 7,16,30,0
v_sub_f32 v160, v160, v2
ex 160
v_sub_f32 v161, v161, v2
yav 192,244,72
ra 196,16,13312
ex 161
v_sub_f32 v162, v162, v2
ex 162
yav 208,244,76
wl 3
v_sub_f32 v163, v163, v2
ex 163
v_sub_f32 v164, v164, v2
ex 164
yav 192,248,80
ra 200,17,13312
v_sub_f32 v165, v165, v2
ex 165
cv 28,160,161
cv 29,162,163
yav 208,248,84
wl 3
dm 8,16,30,1024
v_sub_f32 v166, v166, v2
ex 166
v_sub_f32 v167, v167, v2
yav 192,252,88
ra 204,18,13312
ex 167
cv 32,164,165
v_sub_f32 v168, v168, v2
yav 208,252,92
wl 3
ex 168
v_sub_f32 v169, v169, v2
ex 169
cv 33,166,167
yav 192,192,96
ra 208,15,14336
v_sub_f32 v170, v170, v2
ex 170
v_sub_f32 v171, v171, v2
yav 208,192,100
wl 3
dm 9,16,30,2048
ex 171
cv 30,168,169
sw 28,32
yav 192,196,104
ra 212,16,14336
v_sub_f32 v172, v172, v2
ex 172
v_sub_f32 v173, v173, v2
yav 208,196,108
wl 3
ex 173
sw 29,33
cv 31,170,171
v_sub_f32 v174, v174, v2
yav 192,200,112
ra 216,17,14336
ex 174
v_sub_f32 v175, v175, v2
ex 175
yav 208,200,116
wl 3
dm 10,16,30,3072
cv 34,172,173
cv 35,174,175
s_nop 0
sw 30,34
yav 192,204,120
ra 220,18,14336
sw 31,35
v_sub_f32 v176, v176, v3
ex 176
yav 208,204,124
wl 3
wv 11
s_barrier
v_sub_f32 v177, v177, v3
ex 177
v_sub_f32 v178, v178, v3
yav 192,208,128
ra 224,15,24576
ex 178
v_sub_f32 v179, v179, v3
ex 179
yav 208,208,132
wl 3
v_sub_f32 v180, v180, v3
ex 180
v_sub_f32 v181, v181, v3
ex 181
yav 192,212,136
ra 228,16,24576
cv 36,176,177
cv 37,178,179
v_sub_f32 v182, v182, v3
ex 182
yav 208,212,140
wl 3
v_sub_f32 v183, v183, v3
ex 183
cv 40,180,181
v_sub_f32 v184, v184, v3
yav 192,216,144
ra 232,17,24576
ex 184
v_sub_f32 v185, v185, v3
ex 185
yav 208,216,148
wl 3
cv 41,182,183
v_sub_f32 v186, v186, v3
ex 186
v_sub_f32 v187, v187, v3
yav 192,220,152
ra 236,18,24576
s_add_u32 m0, s29, 32768
s_mov_b32 s30, 98304
ex 187
cv 38,184,185
yav 208,220,156
wl 3
sw 36,40
v_sub_f32 v188, v188, v3
ex 188
v_sub_f32 v189, v189, v3
ex 189
sw 37,41
cv 39,186,187
v_sub_f32 v190, v190, v3
ex 190
v_sub_f32 v191, v191, v3
ex 191
cv 42,188,189
cv 43,190,191
s_nop 0
sw 38,42
sw 39,43
v_mfma_f32_32x32x16_bf16 v[160:175], a[224:227], v[64:67], 0
ra 240,15,25600
v_mfma_f32_32x32x16_bf16 v[176:191], a[224:227], v[68:71], 0
wl 3
dm 7,16,30,0
v_sub_f32 v192, v192, v2
ex 192
v_sub_f32 v193, v193, v2
yav 160,228,72
ra 244,16,25600
ex 193
v_sub_f32 v194, v194, v2
ex 194
yav 176,228,76
wl 3
v_sub_f32 v195, v195, v2
ex 195
v_sub_f32 v196, v196, v2
ex 196
yav 160,232,80
ra 248,17,25600
v_sub_f32 v197, v197, v2
ex 197
cv 44,192,193
cv 45,194,195
yav 176,232,84
wl 3
dm 8,16,30,1024
v_sub_f32 v198, v198, v2
ex 198
v_sub_f32 v199, v199, v2
yav 160,236,88
ra 252,18,25600
ex 199
cv 48,196,197
v_sub_f32 v200, v200, v2
yav 176,236,92
wl 3
ex 200
v_sub_f32 v201, v201, v2
ex 201
cv 49,198,199
yav 160,240,96
ra 192,15,26624
v_sub_f32 v202, v202, v2
ex 202
v_sub_f32 v203, v203, v2
yav 176,240,100
wl 3
dm 9,16,30,2048
ex 203
cv 46,200,201
sw 44,48
yav 160,244,104
ra 196,16,26624
v_sub_f32 v204, v204, v2
ex 204
v_sub_f32 v205, v205, v2
yav 176,244,108
wl 3
ex 205
sw 45,49
cv 47,202,203
v_sub_f32 v206, v206, v2
yav 160,248,112
ra 200,17,26624
ex 206
v_sub_f32 v207, v207, v2
ex 207
yav 176,248,116
wl 3
dm 10,16,30,3072
cv 50,204,205
cv 51,206,207
s_nop 0
sw 46,50
yav 160,252,120
ra 204,18,26624
sw 47,51
v_sub_f32 v208, v208, v3
ex 208
yav 176,252,124
wl 3
wv 12
s_barrier
v_sub_f32 v209, v209, v3
ex 209
v_sub_f32 v210, v210, v3
yav 160,192,128
ra 208,15,36864
ex 210
v_sub_f32 v211, v211, v3
ex 211
yav 176,192,132
wl 3
v_sub_f32 v212, v212, v3
ex 212
v_sub_f32 v213, v213, v3
ex 213
yav 160,196,136
ra 212,16,36864
cv 52,208,209
cv 53,210,211
v_sub_f32 v214, v214, v3
ex 214
yav 176,196,140
wl 3
v_sub_f32 v215, v215, v3
ex 215
cv 56,212,213
v_sub_f32 v216, v216, v3
yav 160,200,144
ra 216,17,36864
ex 216
v_sub_f32 v217, v217, v3
ex 217
yav 176,200,148
wl 3
cv 57,214,215
v_sub_f32 v218, v218, v3
ex 218
v_sub_f32 v219, v219, v3
yav 160,204,152
ra 220,18,36864
ex 219
cv 54,216,217
sw 52,56
yav 176,204,156
wl 3
v_sub_f32 v220, v220, v3
ex 220
v_sub_f32 v221, v221, v3
ex 221
sw 53,57
cv 55,218,219
v_sub_f32 v222, v222, v3
ex 222
v_sub_f32 v223, v223, v3
ex 223
cv 58,220,221
cv 59,222,223
s_nop 0
sw 54,58
sw 55,59
v_mfma_f32_32x32x16_bf16 v[192:207], a[208:211], v[64:67], 0
ra 224,15,37888
v_mfma_f32_32x32x16_bf16 v[208:223], a[208:211], v[68:71], 0
wl 3
v_sub_f32 v160, v160, v2
ex 160
v_sub_f32 v161, v161, v2
ex 161
yav 192,212,72
ra 228,16,37888
v_sub_f32 v162, v162, v2
ex 162
v_sub_f32 v163, v163, v2
yav 208,212,76
wl 3
ex 163
v_sub_f32 v164, v164, v2
ex 164
v_sub_f32 v165, v165, v2
yav 192,216,80
ra 232,17,37888
ex 165
cv 224,160,161
cv 225,162,163
v_sub_f32 v166, v166, v2
yav 208,216,84
wl 3
ex 166
v_sub_f32 v167, v167, v2
ex 167
cv 228,164,165
yav 192,220,88
ra 236,18,37888
v_sub_f32 v168, v168, v2
ex 168
v_sub_f32 v169, v169, v2
yav 208,220,92
wl 3
ex 169
cv 229,166,167
v_sub_f32 v170, v170, v2
ex 170
yav 192,224,96
ra 240,15,38912
v_sub_f32 v171, v171, v2
ex 171
cv 226,168,169
yav 208,224,100
wl 3
sw 224,228
v_sub_f32 v172, v172, v2
ex 172
v_sub_f32 v173, v173, v2
yav 192,228,104
ra 244,16,38912
ex 173
sw 225,229
cv 227,170,171
yav 208,228,108
wl 3
v_sub_f32 v174, v174, v2
ex 174
v_sub_f32 v175, v175, v2
ex 175
yav 192,232,112
ra 248,17,38912
cv 230,172,173
cv 231,174,175
s_nop 0
sw 226,230
yav 208,232,116
wl 3
sw 227,231
v_sub_f32 v176, v176, v3
ex 176
v_sub_f32 v177, v177, v3
yav 192,236,120
ra 252,18,38912
ex 177
v_sub_f32 v178, v178, v3
ex 178
yav 208,236,124
wl 3
wv 8
s_barrier
v_sub_f32 v179, v179, v3
ex 179
v_sub_f32 v180, v180, v3
yav 192,240,128
ta 192,19,0
ex 180
v_sub_f32 v181, v181, v3
ex 181
yav 208,240,132
wl 3
ta 194,19,2048
cv 232,176,177
cv 233,178,179
v_sub_f32 v182, v182, v3
ex 182
yav 192,244,136
ta 196,20,0
v_sub_f32 v183, v183, v3
ex 183
cv 236,180,181
v_sub_f32 v184, v184, v3
yav 208,244,140
wl 4
ta 198,20,2048
ex 184
v_sub_f32 v185, v185, v3
ex 185
yav 192,248,144
ta 200,21,0
cv 237,182,183
v_sub_f32 v186, v186, v3
ex 186
v_sub_f32 v187, v187, v3
yav 208,248,148
wl 5
ta 202,21,2048
ex 187
cv 234,184,185
sw 232,236
yav 192,252,152
ta 204,22,0
v_sub_f32 v188, v188, v3
ex 188
v_sub_f32 v189, v189, v3
yav 208,252,156
wl 5
ta 206,22,2048
ex 189
sw 233,237
cv 235,186,187
v_sub_f32 v190, v190, v3
ex 190
v_sub_f32 v191, v191, v3
ex 191
cv 238,188,189
cv 239,190,191
s_nop 0
sw 234,238
sw 235,239
v_mfma_f32_16x16x32_bf16 v[64:67], a[192:195], a[0:3], 0
ta 208,19,4096
v_mfma_f32_16x16x32_bf16 v[68:71], a[192:195], a[4:7], 0
ta 210,19,6144
v_sub_f32 v192, v192, v2
v_mfma_f32_16x16x32_bf16 v[72:75], a[192:195], a[8:11], 0
ex 192
v_mfma_f32_16x16x32_bf16 v[76:79], a[192:195], a[12:15], 0
wl 6
v_sub_f32 v193, v193, v2
v_mfma_f32_16x16x32_bf16 v[80:83], a[196:199], a[0:3], 0
ta 212,20,4096
v_mfma_f32_16x16x32_bf16 v[84:87], a[196:199], a[4:7], 0
ta 214,20,6144
v_mfma_f32_16x16x32_bf16 v[88:91], a[196:199], a[8:11], 0
ex 193
v_mfma_f32_16x16x32_bf16 v[92:95], a[196:199], a[12:15], 0
wl 6
v_sub_f32 v194, v194, v2
v_mfma_f32_16x16x32_bf16 v[96:99], a[200:203], a[0:3], 0
ta 216,21,4096
v_mfma_f32_16x16x32_bf16 v[100:103], a[200:203], a[4:7], 0
ta 218,21,6144
v_mfma_f32_16x16x32_bf16 v[104:107], a[200:203], a[8:11], 0
ex 194
v_mfma_f32_16x16x32_bf16 v[108:111], a[200:203], a[12:15], 0
wl 6
v_sub_f32 v195, v195, v2
v_mfma_f32_16x16x32_bf16 v[112:115], a[204:207], a[0:3], 0
ta 220,22,4096
v_mfma_f32_16x16x32_bf16 v[116:119], a[204:207], a[4:7], 0
ta 222,22,6144
v_mfma_f32_16x16x32_bf16 v[120:123], a[204:207], a[8:11], 0
ex 195
v_mfma_f32_16x16x32_bf16 v[124:127], a[204:207], a[12:15], 0
v_sub_f32 v196, v196, v2
v_mfma_f32_16x16x32_bf16 v[128:131], v[60:63], a[0:3], 0
ex 196
v_mfma_f32_16x16x32_bf16 v[132:135], v[60:63], a[4:7], 0
v_sub_f32 v197, v197, v2
v_mfma_f32_16x16x32_bf16 v[136:139], v[60:63], a[8:11], 0
ex 197
v_mfma_f32_16x16x32_bf16 v[140:143], v[60:63], a[12:15], 0
wl 6
cv 240,192,193
cv 241,194,195
xaa 64,208,16
ta 224,19,8192
v_sub_f32 v198, v198, v2
xaa 68,208,20
ta 226,19,10240
xaa 72,208,24
ex 198
xaa 76,208,28
wl 6
v_sub_f32 v199, v199, v2
xaa 80,212,16
ta 228,20,8192
xaa 84,212,20
ta 230,20,10240
xaa 88,212,24
ex 199
xaa 92,212,28
wl 6
cv 244,196,197
v_sub_f32 v200, v200, v2
xaa 96,216,16
ta 232,21,8192
xaa 100,216,20
ta 234,21,10240
xaa 104,216,24
ex 200
xaa 108,216,28
wl 6
v_sub_f32 v201, v201, v2
xaa 112,220,16
ta 236,22,8192
xaa 116,220,20
ta 238,22,10240
xaa 120,220,24
ex 201
xaa 124,220,28
cv 245,198,199
v_sub_f32 v202, v202, v2
xva 128,60,16
ex 202
xva 132,60,20
v_sub_f32 v203, v203, v2
xva 136,60,24
ex 203
xva 140,60,28
wl 6
cv 242,200,201
xaa 64,224,32
ta 240,19,12288
sw 240,244
v_sub_f32 v204, v204, v2
ex 204
v_sub_f32 v205, v205, v2
ex 205
sw 241,245
cv 243,202,203
v_sub_f32 v206, v206, v2
ex 206
v_sub_f32 v207, v207, v2
ex 207
cv 246,204,205
cv 247,206,207
s_nop 0
sw 242,246
sw 243,247
v_sub_f32 v208, v208, v3
ex 208
v_sub_f32 v209, v209, v3
ex 209
v_sub_f32 v210, v210, v3
ex 210
v_sub_f32 v211, v211, v3
ex 211
v_sub_f32 v212, v212, v3
ex 212
v_sub_f32 v213, v213, v3
ex 213
cv 248,208,209
cv 249,210,211
v_sub_f32 v214, v214, v3
ex 214
v_sub_f32 v215, v215, v3
ex 215
cv 252,212,213
v_sub_f32 v216, v216, v3
ex 216
v_sub_f32 v217, v217, v3
ex 217
cv 253,214,215
v_sub_f32 v218, v218, v3
ex 218
v_sub_f32 v219, v219, v3
ex 219
cv 250,216,217
sw 248,252
v_sub_f32 v220, v220, v3
ex 220
v_sub_f32 v221, v221, v3
ex 221
sw 249,253
cv 251,218,219
v_sub_f32 v222, v222, v3
ex 222
v_sub_f32 v223, v223, v3
ex 223
cv 254,220,221
cv 255,222,223
s_nop 0
sw 250,254
sw 251,255
xaa 68,224,36
ta 242,19,14336
xaa 72,224,40
xaa 76,224,44
wl 6
xaa 80,228,32
ta 244,20,12288
xaa 84,228,36
ta 246,20,14336
xaa 88,228,40
xaa 92,228,44
wl 6
xaa 96,232,32
ta 248,21,12288
xaa 100,232,36
ta 250,21,14336
xaa 104,232,40
xaa 108,232,44
wl 6
xaa 112,236,32
ta 252,22,12288
xaa 116,236,36
ta 254,22,14336
xaa 120,236,40
xaa 124,236,44
xva 128,60,32
xva 132,60,36
s_add_u32 m0, s29, 49152
s_mov_b32 s30, 147456
xva 136,60,40
xva 140,60,44
wl 6
wv 4
s_barrier
xaa 64,240,48
ta 192,19,16384
xaa 68,240,52
ta 194,19,18432
xaa 72,240,56
dm 7,16,30,0
xaa 76,240,60
wl 6
xaa 80,244,48
ta 196,20,16384
xaa 84,244,52
ta 198,20,18432
xaa 88,244,56
dm 8,16,30,1024
xaa 92,244,60
wl 6
xaa 96,248,48
ta 200,21,16384
xaa 100,248,52
ta 202,21,18432
xaa 104,248,56
dm 9,16,30,2048
xaa 108,248,60
wl 6
xaa 112,252,48
ta 204,22,16384
xaa 116,252,52
ta 206,22,18432
xaa 120,252,56
dm 10,16,30,3072
xaa 124,252,60
xva 128,60,48
xva 132,60,52
xva 136,60,56
xva 140,60,60
wl 6
xaa 64,192,64
ta 208,19,20480
xaa 68,192,68
ta 210,19,22528
xaa 72,192,72
xaa 76,192,76
wl 6
xaa 80,196,64
ta 212,20,20480
xaa 84,196,68
ta 214,20,22528
xaa 88,196,72
xaa 92,196,76
wl 6
xaa 96,200,64
ta 216,21,20480
xaa 100,200,68
ta 218,21,22528
xaa 104,200,72
xaa 108,200,76
wl 6
xaa 112,204,64
ta 220,22,20480
xaa 116,204,68
ta 222,22,22528
xaa 120,204,72
xaa 124,204,76
xva 128,60,64
xva 132,60,68
xva 136,60,72
xva 140,60,76
wl 6
xaa 64,208,80
ta 224,19,24576
xaa 68,208,84
ta 226,19,26624
xaa 72,208,88
xaa 76,208,92
wl 6
xaa 80,212,80
ta 228,20,24576
xaa 84,212,84
ta 230,20,26624
xaa 88,212,88
xaa 92,212,92
wl 6
xaa 96,216,80
ta 232,21,24576
xaa 100,216,84
ta 234,21,26624
xaa 104,216,88
xaa 108,216,92
wl 6
xaa 112,220,80
ta 236,22,24576
xaa 116,220,84
ta 238,22,26624
xaa 120,220,88
xaa 124,220,92
xva 128,60,80
xva 132,60,84
xva 136,60,88
xva 140,60,92
wl 6
xaa 64,224,96
ta 240,19,28672
xaa 68,224,100
ta 242,19,30720
xaa 72,224,104
xaa 76,224,108
wl 6
xaa 80,228,96
ta 244,20,28672
xaa 84,228,100
ta 246,20,30720
xaa 88,228,104
xaa 92,228,108
wl 6
xaa 96,232,96
ta 248,21,28672
xaa 100,232,100
ta 250,21,30720
xaa 104,232,104
xaa 108,232,108
wl 6
xaa 112,236,96
ta 252,22,28672
xaa 116,236,100
ta 254,22,30720
xaa 120,236,104
xaa 124,236,108
xva 128,60,96
xva 132,60,100
s_add_u32 m0, s29, 0
s_mov_b32 s30, 128
xva 136,60,104
xva 140,60,108
wl 6
wv 4
s_barrier
xaa 64,240,112
ta 192,19,32768
xaa 68,240,116
ta 194,19,34816
xaa 72,240,120
dm 7,16,30,0
xaa 76,240,124
wl 6
xaa 80,244,112
ta 196,20,32768
xaa 84,244,116
ta 198,20,34816
xaa 88,244,120
dm 8,16,30,1024
xaa 92,244,124
wl 6
xaa 96,248,112
ta 200,21,32768
xaa 100,248,116
ta 202,21,34816
xaa 104,248,120
dm 9,16,30,2048
xaa 108,248,124
wl 6
xaa 112,252,112
ta 204,22,32768
xaa 116,252,116
ta 206,22,34816
xaa 120,252,120
dm 10,16,30,3072
xaa 124,252,124
xva 128,60,112
xva 132,60,116
xva 136,60,120
xva 140,60,124
wl 6
xaa 64,192,128
ta 208,19,36864
xaa 68,192,132
ta 210,19,38912
xaa 72,192,136
xaa 76,192,140
wl 6
xaa 80,196,128
ta 212,20,36864
xaa 84,196,132
ta 214,20,38912
xaa 88,196,136
xaa 92,196,140
wl 6
xaa 96,200,128
ta 216,21,36864
xaa 100,200,132
ta 218,21,38912
xaa 104,200,136
xaa 108,200,140
wl 6
xaa 112,204,128
ta 220,22,36864
xaa 116,204,132
ta 222,22,38912
xaa 120,204,136
xaa 124,204,140
xva 128,60,128
xva 132,60,132
xva 136,60,136
xva 140,60,140
wl 6
xaa 64,208,144
ta 224,19,40960
xaa 68,208,148
ta 226,19,43008
xaa 72,208,152
xaa 76,208,156
wl 6
xaa 80,212,144
ta 228,20,40960
xaa 84,212,148
ta 230,20,43008
xaa 88,212,152
xaa 92,212,156
wl 6
xaa 96,216,144
ta 232,21,40960
xaa 100,216,148
ta 234,21,43008
xaa 104,216,152
xaa 108,216,156
wl 6
xaa 112,220,144
ta 236,22,40960
xaa 116,220,148
ta 238,22,43008
xaa 120,220,152
xaa 124,220,156
xva 128,60,144
xva 132,60,148
xva 136,60,152
xva 140,60,156
wl 6
xaa 64,224,160
ta 240,19,45056
xaa 68,224,164
ta 242,19,47104
xaa 72,224,168
xaa 76,224,172
wl 6
xaa 80,228,160
ta 244,20,45056
xaa 84,228,164
ta 246,20,47104
xaa 88,228,168
xaa 92,228,172
wl 6
xaa 96,232,160
ta 248,21,45056
xaa 100,232,164
ta 250,21,47104
xaa 104,232,168
xaa 108,232,172
wl 6
xaa 112,236,160
ta 252,22,45056
xaa 116,236,164
ta 254,22,47104
xaa 120,236,168
xaa 124,236,172
xva 128,60,160
xva 132,60,164
s_add_u32 m0, s29, 16384
s_mov_b32 s30, 49280
xva 136,60,168
xva 140,60,172
wl 6
wv 4
s_barrier
xaa 64,240,176
ta 192,19,49152
xaa 68,240,180
ta 194,19,51200
xaa 72,240,184
dm 7,16,30,0
xaa 76,240,188
wl 6
xaa 80,244,176
ta 196,20,49152
xaa 84,244,180
ta 198,20,51200
xaa 88,244,184
dm 8,16,30,1024
xaa 92,244,188
wl 6
xaa 96,248,176
ta 200,21,49152
xaa 100,248,180
ta 202,21,51200
xaa 104,248,184
dm 9,16,30,2048
xaa 108,248,188
wl 6
xaa 112,252,176
ta 204,22,49152
xaa 116,252,180
ta 206,22,51200
xaa 120,252,184
dm 10,16,30,3072
xaa 124,252,188
xva 128,60,176
xva 132,60,180
xva 136,60,184
xva 140,60,188
wl 6
xav 64,192,28
ta 208,19,53248
xav 68,192,32
ta 210,19,55296
xav 72,192,36
xav 76,192,40
wl 6
xav 80,196,28
ta 212,20,53248
xav 84,196,32
ta 214,20,55296
xav 88,196,36
xav 92,196,40
wl 6
xav 96,200,28
ta 216,21,53248
xav 100,200,32
ta 218,21,55296
xav 104,200,36
xav 108,200,40
wl 6
xav 112,204,28
ta 220,22,53248
xav 116,204,32
ta 222,22,55296
xav 120,204,36
xav 124,204,40
xvv 128,60,28
xvv 132,60,32
xvv 136,60,36
xvv 140,60,40
wl 6
xav 64,208,44
ta 224,19,57344
xav 68,208,48
ta 226,19,59392
xav 72,208,52
xav 76,208,56
wl 6
xav 80,212,44
ta 228,20,57344
xav 84,212,48
ta 230,20,59392
xav 88,212,52
xav 92,212,56
wl 6
xav 96,216,44
ta 232,21,57344
xav 100,216,48
ta 234,21,59392
xav 104,216,52
xav 108,216,56
wl 6
xav 112,220,44
ta 236,22,57344
xav 116,220,48
ta 238,22,59392
xav 120,220,52
xav 124,220,56
xvv 128,60,44
xvv 132,60,48
xvv 136,60,52
xvv 140,60,56
wl 6
xav 64,224,224
ta 240,19,61440
xav 68,224,228
ta 242,19,63488
xav 72,224,232
xav 76,224,236
wl 6
xav 80,228,224
ta 244,20,61440
xav 84,228,228
ta 246,20,63488
xav 88,228,232
xav 92,228,236
wl 6
xav 96,232,224
ta 248,21,61440
xav 100,232,228
ta 250,21,63488
xav 104,232,232
xav 108,232,236
wl 6
xav 112,236,224
ta 252,22,61440
xav 116,236,228
ta 254,22,63488
xav 120,236,232
xav 124,236,236
xvv 128,60,224
xvv 132,60,228
s_add_u32 m0, s29, 32768
s_mov_b32 s30, 98432
xvv 136,60,232
xvv 140,60,236
wl 6
wv 4
s_barrier
xav 64,240,240
ta 192,19,0
xav 68,240,244
ta 194,19,2048
xav 72,240,248
dm 7,16,30,0
xav 76,240,252
wl 6
xav 80,244,240
ta 196,20,0
xav 84,244,244
ta 198,20,2048
xav 88,244,248
dm 8,16,30,1024
xav 92,244,252
wl 6
xav 96,248,240
ta 200,21,0
xav 100,248,244
ta 202,21,2048
xav 104,248,248
dm 9,16,30,2048
xav 108,248,252
wl 6
xav 112,252,240
ta 204,22,0
xav 116,252,244
ta 206,22,2048
xav 120,252,248
dm 10,16,30,3072
xav 124,252,252
xvv 128,60,240
xvv 132,60,244
xvv 136,60,248
xvv 140,60,252
wl 6
v_mfma_f32_16x16x32_bf16 v[160:163], a[192:195], a[0:3], 0
ta 208,19,4096
v_mfma_f32_16x16x32_bf16 v[164:167], a[192:195], a[4:7], 0
ta 210,19,6144
v_mfma_f32_16x16x32_bf16 v[168:171], a[192:195], a[8:11], 0
v_mfma_f32_16x16x32_bf16 v[172:175], a[192:195], a[12:15], 0
wl 6
v_rcp_f32 v144, v128
v_mfma_f32_16x16x32_bf16 v[176:179], a[196:199], a[0:3], 0
ta 212,20,4096
v_mfma_f32_16x16x32_bf16 v[180:183], a[196:199], a[4:7], 0
ta 214,20,6144
v_mfma_f32_16x16x32_bf16 v[184:187], a[196:199], a[8:11], 0
v_rcp_f32 v145, v132
v_mfma_f32_16x16x32_bf16 v[188:191], a[196:199], a[12:15], 0
wl 6
v_rcp_f32 v146, v136
v_mfma_f32_16x16x32_bf16 v[192:195], a[200:203], a[0:3], 0
ta 216,21,4096
v_mfma_f32_16x16x32_bf16 v[196:199], a[200:203], a[4:7], 0
ta 218,21,6144
v_mfma_f32_16x16x32_bf16 v[200:203], a[200:203], a[8:11], 0
v_rcp_f32 v147, v140
v_mfma_f32_16x16x32_bf16 v[204:207], a[200:203], a[12:15], 0
wl 6
s_mov_b32 s31, 0
v_mfma_f32_16x16x32_bf16 v[208:211], a[204:207], a[0:3], 0
ta 220,22,4096
v_mfma_f32_16x16x32_bf16 v[212:215], a[204:207], a[4:7], 0
ta 222,22,6144
v_mul_f32 v64, v144, v64
v_mfma_f32_16x16x32_bf16 v[216:219], a[204:207], a[8:11], 0
v_mfma_f32_16x16x32_bf16 v[220:223], a[204:207], a[12:15], 0
wl 6
v_mul_f32 v65, v144, v65
xaa 160,208,16
ta 224,19,8192
xaa 164,208,20
ta 226,19,10240
xaa 168,208,24
v_mul_f32 v66, v144, v66
xaa 172,208,28
wl 6
xaa 176,212,16
ta 228,20,8192
v_mul_f32 v67, v144, v67
xaa 180,212,20
ta 230,20,10240
xaa 184,212,24
v_mul_f32 v80, v144, v80
xaa 188,212,28
wl 6
xaa 192,216,16
ta 232,21,8192
v_mul_f32 v81, v144, v81
xaa 196,216,20
ta 234,21,10240
xaa 200,216,24
v_mul_f32 v82, v144, v82
xaa 204,216,28
wl 6
xaa 208,220,16
ta 236,22,8192
v_mul_f32 v83, v144, v83
xaa 212,220,20
ta 238,22,10240
xaa 216,220,24
xaa 220,220,28
wl 6
cv 64,64,65
xaa 160,224,32
ta 240,19,12288
xaa 164,224,36
ta 242,19,14336
cv 65,66,67
xaa 168,224,40
xaa 172,224,44
wl 6
cv 66,80,81
xaa 176,228,32
ta 244,20,12288
xaa 180,228,36
ta 246,20,14336
cv 67,82,83
xaa 184,228,40
xaa 188,228,44
wl 6
buffer_store_dwordx4 v[64:67], v23, s[20:23], s31 offen sc1
xaa 192,232,32
ta 248,21,12288
xaa 196,232,36
ta 250,21,14336
v_mul_f32 v68, v145, v68
xaa 200,232,40
xaa 204,232,44
wl 6
v_mul_f32 v69, v145, v69
xaa 208,236,32
ta 252,22,12288
xaa 212,236,36
ta 254,22,14336
s_add_u32 m0, s29, 49152
xaa 216,236,40
s_mov_b32 s30, 147584
v_mul_f32 v70, v145, v70
xaa 220,236,44
wl 6
wv 5
s_barrier
xaa 160,240,48
ta 192,19,16384
v_mul_f32 v71, v145, v71
xaa 164,240,52
ta 194,19,18432
xaa 168,240,56
dm 7,16,30,0
v_mul_f32 v84, v145, v84
xaa 172,240,60
wl 6
xaa 176,244,48
ta 196,20,16384
v_mul_f32 v85, v145, v85
xaa 180,244,52
ta 198,20,18432
xaa 184,244,56
dm 8,16,30,1024
v_mul_f32 v86, v145, v86
xaa 188,244,60
wl 6
xaa 192,248,48
ta 200,21,16384
v_mul_f32 v87, v145, v87
xaa 196,248,52
ta 202,21,18432
xaa 200,248,56
dm 9,16,30,2048
xaa 204,248,60
wl 6
cv 68,68,69
xaa 208,252,48
ta 204,22,16384
xaa 212,252,52
ta 206,22,18432
cv 69,70,71
xaa 216,252,56
dm 10,16,30,3072
xaa 220,252,60
wl 6
cv 70,84,85
xaa 160,192,64
ta 208,19,20480
xaa 164,192,68
ta 210,19,22528
cv 71,86,87
xaa 168,192,72
xaa 172,192,76
wl 6
buffer_store_dwordx4 v[68:71], v24, s[20:23], s31 offen sc1
xaa 176,196,64
ta 212,20,20480
xaa 180,196,68
ta 214,20,22528
v_mul_f32 v72, v146, v72
xaa 184,196,72
xaa 188,196,76
wl 6
v_mul_f32 v73, v146, v73
xaa 192,200,64
ta 216,21,20480
xaa 196,200,68
ta 218,21,22528
xaa 200,200,72
v_mul_f32 v74, v146, v74
xaa 204,200,76
wl 6
xaa 208,204,64
ta 220,22,20480
v_mul_f32 v75, v146, v75
xaa 212,204,68
ta 222,22,22528
xaa 216,204,72
v_mul_f32 v88, v146, v88
xaa 220,204,76
wl 6
xaa 160,208,80
ta 224,19,24576
v_mul_f32 v89, v146, v89
xaa 164,208,84
ta 226,19,26624
xaa 168,208,88
v_mul_f32 v90, v146, v90
xaa 172,208,92
wl 6
xaa 176,212,80
ta 228,20,24576
v_mul_f32 v91, v146, v91
xaa 180,212,84
ta 230,20,26624
xaa 184,212,88
xaa 188,212,92
wl 6
cv 72,72,73
xaa 192,216,80
ta 232,21,24576
xaa 196,216,84
ta 234,21,26624
cv 73,74,75
xaa 200,216,88
xaa 204,216,92
wl 6
cv 74,88,89
xaa 208,220,80
ta 236,22,24576
xaa 212,220,84
ta 238,22,26624
cv 75,90,91
xaa 216,220,88
xaa 220,220,92
wl 6
buffer_store_dwordx4 v[72:75], v25, s[20:23], s31 offen sc1
xaa 160,224,96
ta 240,19,28672
xaa 164,224,100
ta 242,19,30720
v_mul_f32 v76, v147, v76
xaa 168,224,104
xaa 172,224,108
wl 6
v_mul_f32 v77, v147, v77
xaa 176,228,96
ta 244,20,28672
xaa 180,228,100
ta 246,20,30720
xaa 184,228,104
v_mul_f32 v78, v147, v78
xaa 188,228,108
wl 6
xaa 192,232,96
ta 248,21,28672
v_mul_f32 v79, v147, v79
xaa 196,232,100
ta 250,21,30720
xaa 200,232,104
v_mul_f32 v92, v147, v92
xaa 204,232,108
wl 6
xaa 208,236,96
ta 252,22,28672
v_mul_f32 v93, v147, v93
xaa 212,236,100
ta 254,22,30720
s_add_u32 m0, s29, 0
xaa 216,236,104
s_mov_b32 s30, 256
v_mul_f32 v94, v147, v94
xaa 220,236,108
wl 6
wv 7
s_barrier
xaa 160,240,112
ta 192,19,32768
v_mul_f32 v95, v147, v95
xaa 164,240,116
ta 194,19,34816
xaa 168,240,120
dm 7,16,30,0
xaa 172,240,124
wl 6
cv 76,76,77
xaa 176,244,112
ta 196,20,32768
xaa 180,244,116
ta 198,20,34816
cv 77,78,79
xaa 184,244,120
dm 8,16,30,1024
xaa 188,244,124
wl 6
cv 78,92,93
xaa 192,248,112
ta 200,21,32768
xaa 196,248,116
ta 202,21,34816
cv 79,94,95
xaa 200,248,120
dm 9,16,30,2048
xaa 204,248,124
wl 6
buffer_store_dwordx4 v[76:79], v26, s[20:23], s31 offen sc1
xaa 208,252,112
ta 204,22,32768
xaa 212,252,116
ta 206,22,34816
s_mov_b32 s31, 1024
xaa 216,252,120
dm 10,16,30,3072
xaa 220,252,124
wl 6
v_mul_f32 v96, v144, v96
xaa 160,192,128
ta 208,19,36864
xaa 164,192,132
ta 210,19,38912
xaa 168,192,136
v_mul_f32 v97, v144, v97
xaa 172,192,140
wl 6
xaa 176,196,128
ta 212,20,36864
v_mul_f32 v98, v144, v98
xaa 180,196,132
ta 214,20,38912
xaa 184,196,136
v_mul_f32 v99, v144, v99
xaa 188,196,140
wl 6
xaa 192,200,128
ta 216,21,36864
v_mul_f32 v112, v144, v112
xaa 196,200,132
ta 218,21,38912
xaa 200,200,136
v_mul_f32 v113, v144, v113
xaa 204,200,140
wl 6
xaa 208,204,128
ta 220,22,36864
v_mul_f32 v114, v144, v114
xaa 212,204,132
ta 222,22,38912
xaa 216,204,136
xaa 220,204,140
wl 6
v_mul_f32 v115, v144, v115
xaa 160,208,144
ta 224,19,40960
xaa 164,208,148
ta 226,19,43008
cv 96,96,97
xaa 168,208,152
xaa 172,208,156
wl 6
cv 97,98,99
xaa 176,212,144
ta 228,20,40960
xaa 180,212,148
ta 230,20,43008
cv 98,112,113
xaa 184,212,152
xaa 188,212,156
wl 6
cv 99,114,115
xaa 192,216,144
ta 232,21,40960
xaa 196,216,148
ta 234,21,43008
xaa 200,216,152
buffer_store_dwordx4 v[96:99], v23, s[20:23], s31 offen sc1
xaa 204,216,156
wl 6
v_mul_f32 v100, v145, v100
xaa 208,220,144
ta 236,22,40960
xaa 212,220,148
ta 238,22,43008
xaa 216,220,152
v_mul_f32 v101, v145, v101
xaa 220,220,156
wl 6
xaa 160,224,160
ta 240,19,45056
v_mul_f32 v102, v145, v102
xaa 164,224,164
ta 242,19,47104
xaa 168,224,168
v_mul_f32 v103, v145, v103
xaa 172,224,172
wl 6
xaa 176,228,160
ta 244,20,45056
v_mul_f32 v116, v145, v116
xaa 180,228,164
ta 246,20,47104
xaa 184,228,168
v_mul_f32 v117, v145, v117
xaa 188,228,172
wl 6
xaa 192,232,160
ta 248,21,45056
v_mul_f32 v118, v145, v118
xaa 196,232,164
ta 250,21,47104
xaa 200,232,168
xaa 204,232,172
wl 6
v_mul_f32 v119, v145, v119
xaa 208,236,160
ta 252,22,45056
xaa 212,236,164
ta 254,22,47104
s_add_u32 m0, s29, 16384
xaa 216,236,168
s_mov_b32 s30, 49408
cv 100,100,101
xaa 220,236,172
wl 6
wv 8
s_barrier
xaa 160,240,176
ta 192,19,49152
cv 101,102,103
xaa 164,240,180
ta 194,19,51200
cv 102,116,117
xaa 168,240,184
dm 7,16,30,0
xaa 172,240,188
wl 6
cv 103,118,119
xaa 176,244,176
ta 196,20,49152
xaa 180,244,180
ta 198,20,51200
xaa 184,244,184
dm 8,16,30,1024
xaa 188,244,188
wl 6
buffer_store_dwordx4 v[100:103], v24, s[20:23], s31 offen sc1
v_mul_f32 v104, v146, v104
xaa 192,248,176
ta 200,21,49152
xaa 196,248,180
ta 202,21,51200
xaa 200,248,184
dm 9,16,30,2048
v_mul_f32 v105, v146, v105
xaa 204,248,188
wl 6
xaa 208,252,176
ta 204,22,49152
v_mul_f32 v106, v146, v106
xaa 212,252,180
ta 206,22,51200
xaa 216,252,184
dm 10,16,30,3072
v_mul_f32 v107, v146, v107
xaa 220,252,188
wl 6
xav 160,192,28
ta 208,19,53248
v_mul_f32 v120, v146, v120
xav 164,192,32
ta 210,19,55296
xav 168,192,36
v_mul_f32 v121, v146, v121
xav 172,192,40
wl 6
xav 176,196,28
ta 212,20,53248
v_mul_f32 v122, v146, v122
xav 180,196,32
ta 214,20,55296
xav 184,196,36
xav 188,196,40
wl 6
v_mul_f32 v123, v146, v123
xav 192,200,28
ta 216,21,53248
xav 196,200,32
ta 218,21,55296
cv 104,104,105
xav 200,200,36
xav 204,200,40
wl 6
cv 105,106,107
xav 208,204,28
ta 220,22,53248
xav 212,204,32
ta 222,22,55296
cv 106,120,121
xav 216,204,36
xav 220,204,40
wl 6
cv 107,122,123
xav 160,208,44
ta 224,19,57344
xav 164,208,48
ta 226,19,59392
xav 168,208,52
buffer_store_dwordx4 v[104:107], v25, s[20:23], s31 offen sc1
xav 172,208,56
wl 6
v_mul_f32 v108, v147, v108
xav 176,212,44
ta 228,20,57344
xav 180,212,48
ta 230,20,59392
xav 184,212,52
v_mul_f32 v109, v147, v109
xav 188,212,56
wl 6
xav 192,216,44
ta 232,21,57344
v_mul_f32 v110, v147, v110
xav 196,216,48
ta 234,21,59392
xav 200,216,52
v_mul_f32 v111, v147, v111
xav 204,216,56
wl 6
xav 208,220,44
ta 236,22,57344
v_mul_f32 v124, v147, v124
xav 212,220,48
ta 238,22,59392
xav 216,220,52
v_mul_f32 v125, v147, v125
xav 220,220,56
wl 6
xav 160,224,224
ta 240,19,61440
v_mul_f32 v126, v147, v126
xav 164,224,228
ta 242,19,63488
xav 168,224,232
xav 172,224,236
wl 6
v_mul_f32 v127, v147, v127
xav 176,228,224
ta 244,20,61440
xav 180,228,228
ta 246,20,63488
cv 108,108,109
xav 184,228,232
xav 188,228,236
wl 6
cv 109,110,111
xav 192,232,224
ta 248,21,61440
xav 196,232,228
ta 250,21,63488
cv 110,124,125
xav 200,232,232
xav 204,232,236
wl 6
cv 111,126,127
xav 208,236,224
ta 252,22,61440
xav 212,236,228
ta 254,22,63488
s_add_u32 m0, s29, 32768
xav 216,236,232
s_mov_b32 s30, 98560
buffer_store_dwordx4 v[108:111], v26, s[20:23], s31 offen sc1
xav 220,236,236
wl 6
wv 8
s_barrier
xav 160,240,240
ta 192,19,0
xav 164,240,244
ta 194,19,2048
xav 168,240,248
dm 7,16,30,0
xav 172,240,252
wl 6
xav 176,244,240
ta 196,20,0
xav 180,244,244
ta 198,20,2048
xav 184,244,248
dm 8,16,30,1024
xav 188,244,252
wl 6
xav 192,248,240
ta 200,21,0
xav 196,248,244
ta 202,21,2048
xav 200,248,248
dm 9,16,30,2048
xav 204,248,252
wl 6
xav 208,252,240
ta 204,22,0
xav 212,252,244
ta 206,22,2048
xav 216,252,248
dm 10,16,30,3072
xav 220,252,252
wl 6
v_mfma_f32_16x16x32_bf16 v[64:67], a[192:195], a[0:3], 0
ta 208,19,4096
v_mfma_f32_16x16x32_bf16 v[68:71], a[192:195], a[4:7], 0
ta 210,19,6144
v_mfma_f32_16x16x32_bf16 v[72:75], a[192:195], a[8:11], 0
v_mfma_f32_16x16x32_bf16 v[76:79], a[192:195], a[12:15], 0
wl 6
s_mov_b32 s31, 2048
v_mfma_f32_16x16x32_bf16 v[80:83], a[196:199], a[0:3], 0
ta 212,20,4096
v_mul_f32 v160, v144, v160
v_mfma_f32_16x16x32_bf16 v[84:87], a[196:199], a[4:7], 0
ta 214,20,6144
v_mfma_f32_16x16x32_bf16 v[88:91], a[196:199], a[8:11], 0
v_mul_f32 v161, v144, v161
v_mfma_f32_16x16x32_bf16 v[92:95], a[196:199], a[12:15], 0
wl 6
v_mfma_f32_16x16x32_bf16 v[96:99], a[200:203], a[0:3], 0
ta 216,21,4096
v_mul_f32 v162, v144, v162
v_mfma_f32_16x16x32_bf16 v[100:103], a[200:203], a[4:7], 0
ta 218,21,6144
v_mul_f32 v163, v144, v163
v_mfma_f32_16x16x32_bf16 v[104:107], a[200:203], a[8:11], 0
v_mfma_f32_16x16x32_bf16 v[108:111], a[200:203], a[12:15], 0
wl 6
v_mul_f32 v176, v144, v176
v_mfma_f32_16x16x32_bf16 v[112:115], a[204:207], a[0:3], 0
ta 220,22,4096
v_mfma_f32_16x16x32_bf16 v[116:119], a[204:207], a[4:7], 0
ta 222,22,6144
v_mul_f32 v177, v144, v177
v_mfma_f32_16x16x32_bf16 v[120:123], a[204:207], a[8:11], 0
v_mul_f32 v178, v144, v178
v_mfma_f32_16x16x32_bf16 v[124:127], a[204:207], a[12:15], 0
wl 6
xaa 64,208,16
ta 224,19,8192
v_mul_f32 v179, v144, v179
xaa 68,208,20
ta 226,19,10240
xaa 72,208,24
cv 160,160,161
xaa 76,208,28
wl 6
xaa 80,212,16
ta 228,20,8192
cv 161,162,163
xaa 84,212,20
ta 230,20,10240
cv 162,176,177
xaa 88,212,24
xaa 92,212,28
wl 6
cv 163,178,179
xaa 96,216,16
ta 232,21,8192
xaa 100,216,20
ta 234,21,10240
xaa 104,216,24
buffer_store_dwordx4 v[160:163], v23, s[20:23], s31 offen sc1
v_mul_f32 v164, v145, v164
xaa 108,216,28
wl 6
xaa 112,220,16
ta 236,22,8192
v_mul_f32 v165, v145, v165
xaa 116,220,20
ta 238,22,10240
xaa 120,220,24
v_mul_f32 v166, v145, v166
xaa 124,220,28
wl 6
xaa 64,224,32
ta 240,19,12288
v_mul_f32 v167, v145, v167
xaa 68,224,36
ta 242,19,14336
v_mul_f32 v180, v145, v180
xaa 72,224,40
xaa 76,224,44
wl 6
v_mul_f32 v181, v145, v181
xaa 80,228,32
ta 244,20,12288
xaa 84,228,36
ta 246,20,14336
v_mul_f32 v182, v145, v182
xaa 88,228,40
v_mul_f32 v183, v145, v183
xaa 92,228,44
wl 6
xaa 96,232,32
ta 248,21,12288
cv 164,164,165
xaa 100,232,36
ta 250,21,14336
xaa 104,232,40
cv 165,166,167
xaa 108,232,44
wl 6
cv 166,180,181
xaa 112,236,32
ta 252,22,12288
xaa 116,236,36
ta 254,22,14336
s_add_u32 m0, s29, 49152
xaa 120,236,40
s_mov_b32 s30, 147712
cv 167,182,183
xaa 124,236,44
wl 6
wv 7
s_barrier
xaa 64,240,48
ta 192,19,16384
xaa 68,240,52
ta 194,19,18432
xaa 72,240,56
dm 7,16,30,0
xaa 76,240,60
wl 6
buffer_store_dwordx4 v[164:167], v24, s[20:23], s31 offen sc1
v_mul_f32 v168, v146, v168
xaa 80,244,48
ta 196,20,16384
v_mul_f32 v169, v146, v169
xaa 84,244,52
ta 198,20,18432
v_mul_f32 v170, v146, v170
xaa 88,244,56
dm 8,16,30,1024
v_mul_f32 v171, v146, v171
xaa 92,244,60
wl 6
v_mul_f32 v184, v146, v184
xaa 96,248,48
ta 200,21,16384
xaa 100,248,52
ta 202,21,18432
v_mul_f32 v185, v146, v185
xaa 104,248,56
dm 9,16,30,2048
xaa 108,248,60
wl 6
v_mul_f32 v186, v146, v186
xaa 112,252,48
ta 204,22,16384
xaa 116,252,52
ta 206,22,18432
v_mul_f32 v187, v146, v187
xaa 120,252,56
dm 10,16,30,3072
cv 168,168,169
xaa 124,252,60
wl 6
xaa 64,192,64
ta 208,19,20480
cv 169,170,171
xaa 68,192,68
ta 210,19,22528
xaa 72,192,72
cv 170,184,185
xaa 76,192,76
wl 6
cv 171,186,187
xaa 80,196,64
ta 212,20,20480
xaa 84,196,68
ta 214,20,22528
xaa 88,196,72
buffer_store_dwordx4 v[168:171], v25, s[20:23], s31 offen sc1
xaa 92,196,76
wl 6
v_mul_f32 v172, v147, v172
xaa 96,200,64
ta 216,21,20480
xaa 100,200,68
ta 218,21,22528
v_mul_f32 v173, v147, v173
xaa 104,200,72
v_mul_f32 v174, v147, v174
xaa 108,200,76
wl 6
xaa 112,204,64
ta 220,22,20480
v_mul_f32 v175, v147, v175
xaa 116,204,68
ta 222,22,22528
xaa 120,204,72
v_mul_f32 v188, v147, v188
xaa 124,204,76
wl 6
v_mul_f32 v189, v147, v189
xaa 64,208,80
ta 224,19,24576
xaa 68,208,84
ta 226,19,26624
v_mul_f32 v190, v147, v190
xaa 72,208,88
xaa 76,208,92
wl 6
v_mul_f32 v191, v147, v191
xaa 80,212,80
ta 228,20,24576
cv 172,172,173
xaa 84,212,84
ta 230,20,26624
xaa 88,212,88
cv 173,174,175
xaa 92,212,92
wl 6
xaa 96,216,80
ta 232,21,24576
cv 174,188,189
xaa 100,216,84
ta 234,21,26624
xaa 104,216,88
cv 175,190,191
xaa 108,216,92
wl 6
buffer_store_dwordx4 v[172:175], v26, s[20:23], s31 offen sc1
xaa 112,220,80
ta 236,22,24576
xaa 116,220,84
ta 238,22,26624
s_mov_b32 s31, 3072
xaa 120,220,88
xaa 124,220,92
wl 6
v_mul_f32 v192, v144, v192
xaa 64,224,96
ta 240,19,28672
v_mul_f32 v193, v144, v193
xaa 68,224,100
ta 242,19,30720
xaa 72,224,104
v_mul_f32 v194, v144, v194
xaa 76,224,108
wl 6
xaa 80,228,96
ta 244,20,28672
v_mul_f32 v195, v144, v195
xaa 84,228,100
ta 246,20,30720
xaa 88,228,104
v_mul_f32 v208, v144, v208
xaa 92,228,108
wl 6
v_mul_f32 v209, v144, v209
xaa 96,232,96
ta 248,21,28672
xaa 100,232,100
ta 250,21,30720
v_mul_f32 v210, v144, v210
xaa 104,232,104
xaa 108,232,108
wl 6
v_mul_f32 v211, v144, v211
xaa 112,236,96
ta 252,22,28672
cv 192,192,193
xaa 116,236,100
ta 254,22,30720
xaa 120,236,104
cv 193,194,195
xaa 124,236,108
wl 6
wv 8
s_barrier
xaa 64,240,112
ta 192,19,32768
cv 194,208,209
xaa 68,240,116
ta 194,19,34816
cv 195,210,211
xaa 72,240,120
xaa 76,240,124
wl 6
buffer_store_dwordx4 v[192:195], v23, s[20:23], s31 offen sc1
xaa 80,244,112
ta 196,20,32768
xaa 84,244,116
ta 198,20,34816
v_mul_f32 v196, v145, v196
xaa 88,244,120
xaa 92,244,124
wl 6
v_mul_f32 v197, v145, v197
xaa 96,248,112
ta 200,19,36864
v_mul_f32 v198, v145, v198
xaa 100,248,116
ta 202,19,38912
xaa 104,248,120
v_mul_f32 v199, v145, v199
xaa 108,248,124
wl 6
xaa 112,252,112
ta 204,20,36864
v_mul_f32 v212, v145, v212
xaa 116,252,116
ta 206,20,38912
v_mul_f32 v213, v145, v213
xaa 120,252,120
xaa 124,252,124
wl 6
v_mul_f32 v214, v145, v214
xaa 64,192,128
ta 208,19,40960
xaa 68,192,132
ta 210,19,43008
v_mul_f32 v215, v145, v215
xaa 72,192,136
xaa 76,192,140
wl 6
cv 196,196,197
xaa 80,196,128
ta 212,20,40960
cv 197,198,199
xaa 84,196,132
ta 214,20,43008
xaa 88,196,136
cv 198,212,213
xaa 92,196,140
wl 6
xaa 64,200,144
ta 216,19,45056
cv 199,214,215
xaa 68,200,148
ta 218,19,47104
xaa 72,200,152
buffer_store_dwordx4 v[196:199], v24, s[20:23], s31 offen sc1
xaa 76,200,156
wl 6
v_mul_f32 v200, v146, v200
xaa 80,204,144
ta 220,20,45056
xaa 84,204,148
ta 222,20,47104
v_mul_f32 v201, v146, v201
xaa 88,204,152
xaa 92,204,156
wl 6
wv 4
s_barrier
xaa 64,208,160
ta 224,19,49152
v_mul_f32 v202, v146, v202
xaa 68,208,164
ta 226,19,51200
v_mul_f32 v203, v146, v203
xaa 72,208,168
v_mul_f32 v216, v146, v216
xaa 76,208,172
wl 6
xaa 80,212,160
ta 228,20,49152
v_mul_f32 v217, v146, v217
xaa 84,212,164
ta 230,20,51200
v_mul_f32 v218, v146, v218
xaa 88,212,168
xaa 92,212,172
wl 6
v_mul_f32 v219, v146, v219
xaa 64,216,176
ta 232,19,53248
xaa 68,216,180
ta 234,19,55296
cv 200,200,201
xaa 72,216,184
cv 201,202,203
xaa 76,216,188
wl 6
xaa 80,220,176
ta 236,20,53248
cv 202,216,217
xaa 84,220,180
ta 238,20,55296
xaa 88,220,184
cv 203,218,219
xaa 92,220,188
wl 6
xav 64,224,28
ta 240,19,57344
xav 68,224,32
ta 242,19,59392
xav 72,224,36
buffer_store_dwordx4 v[200:203], v25, s[20:23], s31 offen sc1
v_mul_f32 v204, v147, v204
xav 76,224,40
wl 6
v_mul_f32 v205, v147, v205
xav 80,228,28
ta 244,20,57344
xav 84,228,32
ta 246,20,59392
v_mul_f32 v206, v147, v206
xav 88,228,36
v_mul_f32 v207, v147, v207
xav 92,228,40
wl 6
xav 64,232,44
ta 248,19,61440
v_mul_f32 v220, v147, v220
xav 68,232,48
ta 250,19,63488
xav 72,232,52
v_mul_f32 v221, v147, v221
xav 76,232,56
wl 6
xav 80,236,44
ta 252,20,61440
v_mul_f32 v222, v147, v222
xav 84,236,48
ta 254,20,63488
v_mul_f32 v223, v147, v223
xav 88,236,52
xav 92,236,56
wl 6
cv 204,204,205
xav 64,240,224
ta 192,21,32768
xav 68,240,228
ta 194,21,34816
cv 205,206,207
xav 72,240,232
cv 206,220,221
xav 76,240,236
wl 6
xav 80,244,224
ta 196,22,32768
cv 207,222,223
xav 84,244,228
ta 198,22,34816
xav 88,244,232
buffer_store_dwordx4 v[204:207], v26, s[20:23], s31 offen sc1
xav 92,244,236
wl 6
xav 64,248,240
ta 200,21,36864
xav 68,248,244
ta 202,21,38912
xav 72,248,248
xav 76,248,252
wl 6
xav 80,252,240
ta 204,22,36864
xav 84,252,244
ta 206,22,38912
xav 88,252,248
xav 92,252,252
wl 6
xaa 96,192,128
ta 208,21,40960
xaa 100,192,132
ta 210,21,43008
xaa 104,192,136
xaa 108,192,140
wl 6
s_mov_b32 s31, 4096
xaa 112,196,128
ta 212,22,40960
v_mul_f32 v64, v144, v64
xaa 116,196,132
ta 214,22,43008
v_mul_f32 v65, v144, v65
xaa 120,196,136
v_mul_f32 v66, v144, v66
xaa 124,196,140
wl 6
v_mul_f32 v67, v144, v67
xaa 96,200,144
ta 216,21,45056
v_mul_f32 v80, v144, v80
xaa 100,200,148
ta 218,21,47104
v_mul_f32 v81, v144, v81
xaa 104,200,152
v_mul_f32 v82, v144, v82
xaa 108,200,156
wl 6
v_mul_f32 v83, v144, v83
xaa 112,204,144
ta 220,22,45056
cv 64,64,65
xaa 116,204,148
ta 222,22,47104
cv 65,66,67
xaa 120,204,152
cv 66,80,81
xaa 124,204,156
wl 6
cv 67,82,83
xaa 96,208,160
ta 224,21,49152
xaa 100,208,164
ta 226,21,51200
xaa 104,208,168
buffer_store_dwordx4 v[64:67], v23, s[20:23], s31 offen sc1
v_mul_f32 v68, v145, v68
xaa 108,208,172
wl 6
v_mul_f32 v69, v145, v69
v_mul_f32 v70, v145, v70
xaa 112,212,160
ta 228,22,49152
v_mul_f32 v71, v145, v71
xaa 116,212,164
ta 230,22,51200
v_mul_f32 v84, v145, v84
xaa 120,212,168
v_mul_f32 v85, v145, v85
xaa 124,212,172
wl 6
v_mul_f32 v86, v145, v86
xaa 96,216,176
ta 232,21,53248
v_mul_f32 v87, v145, v87
xaa 100,216,180
ta 234,21,55296
cv 68,68,69
xaa 104,216,184
cv 69,70,71
xaa 108,216,188
wl 6
cv 70,84,85
xaa 112,220,176
ta 236,22,53248
cv 71,86,87
xaa 116,220,180
ta 238,22,55296
xaa 120,220,184
buffer_store_dwordx4 v[68:71], v24, s[20:23], s31 offen sc1
xaa 124,220,188
wl 6
v_mul_f32 v72, v146, v72
xav 96,224,28
ta 240,21,57344
v_mul_f32 v73, v146, v73
xav 100,224,32
ta 242,21,59392
v_mul_f32 v74, v146, v74
xav 104,224,36
v_mul_f32 v75, v146, v75
xav 108,224,40
wl 6
v_mul_f32 v88, v146, v88
xav 112,228,28
ta 244,22,57344
v_mul_f32 v89, v146, v89
xav 116,228,32
ta 246,22,59392
v_mul_f32 v90, v146, v90
xav 120,228,36
v_mul_f32 v91, v146, v91
xav 124,228,40
wl 6
cv 72,72,73
xav 96,232,44
ta 248,21,61440
cv 73,74,75
xav 100,232,48
ta 250,21,63488
cv 74,88,89
xav 104,232,52
cv 75,90,91
xav 108,232,56
wl 6
buffer_store_dwordx4 v[72:75], v25, s[20:23], s31 offen sc1
xav 112,236,44
ta 252,22,61440
v_mul_f32 v76, v147, v76
xav 116,236,48
ta 254,22,63488
v_mul_f32 v77, v147, v77
xav 120,236,52
v_mul_f32 v78, v147, v78
xav 124,236,56
wl 6
v_mul_f32 v79, v147, v79
xav 96,240,224
v_mul_f32 v92, v147, v92
xav 100,240,228
v_mul_f32 v93, v147, v93
xav 104,240,232
v_mul_f32 v94, v147, v94
xav 108,240,236
wl 4
v_mul_f32 v95, v147, v95
xav 112,244,224
cv 76,76,77
xav 116,244,228
cv 77,78,79
xav 120,244,232
cv 78,92,93
xav 124,244,236
wl 2
cv 79,94,95
xav 96,248,240
buffer_store_dwordx4 v[76:79], v26, s[20:23], s31 offen sc1
xav 100,248,244
xav 104,248,248
xav 108,248,252
wl 0
xav 112,252,240
xav 116,252,244
xav 120,252,248
xav 124,252,252
s_mov_b32 s31, 5120
v_mul_f32 v96, v144, v96
v_mul_f32 v97, v144, v97
v_mul_f32 v98, v144, v98
v_mul_f32 v99, v144, v99
v_mul_f32 v112, v144, v112
v_mul_f32 v113, v144, v113
v_mul_f32 v114, v144, v114
v_mul_f32 v115, v144, v115
cv 96,96,97
cv 97,98,99
cv 98,112,113
cv 99,114,115
buffer_store_dwordx4 v[96:99], v23, s[20:23], s31 offen sc1
v_mul_f32 v100, v145, v100
v_mul_f32 v101, v145, v101
v_mul_f32 v102, v145, v102
v_mul_f32 v103, v145, v103
v_mul_f32 v116, v145, v116
v_mul_f32 v117, v145, v117
v_mul_f32 v118, v145, v118
v_mul_f32 v119, v145, v119
cv 100,100,101
cv 101,102,103
cv 102,116,117
cv 103,118,119
buffer_store_dwordx4 v[100:103], v24, s[20:23], s31 offen sc1
v_mul_f32 v104, v146, v104
v_mul_f32 v105, v146, v105
v_mul_f32 v106, v146, v106
v_mul_f32 v107, v146, v107
v_mul_f32 v120, v146, v120
v_mul_f32 v121, v146, v121
v_mul_f32 v122, v146, v122
v_mul_f32 v123, v146, v123
cv 104,104,105
cv 105,106,107
cv 106,120,121
cv 107,122,123
buffer_store_dwordx4 v[104:107], v25, s[20:23], s31 offen sc1
v_mul_f32 v108, v147, v108
v_mul_f32 v109, v147, v109
v_mul_f32 v110, v147, v110
v_mul_f32 v111, v147, v111
v_mul_f32 v124, v147, v124
v_mul_f32 v125, v147, v125
v_mul_f32 v126, v147, v126
v_mul_f32 v127, v147, v127
cv 108,108,109
cv 109,110,111
cv 110,124,125
cv 111,126,127
buffer_store_dwordx4 v[108:111], v26, s[20:23], s31 offen sc1
wv 0
s_branch K2_DONE
.section .rodata,"a"
.p2align 6
.amdhsa_kernel k01_kernel
  .amdhsa_next_free_vgpr 256
  .amdhsa_next_free_sgpr 102
  .amdhsa_accum_offset 256
  .amdhsa_group_segment_fixed_size 0
  .amdhsa_kernarg_size 112
  .amdhsa_user_sgpr_count 2
  .amdhsa_user_sgpr_kernarg_segment_ptr 1
  .amdhsa_system_sgpr_workgroup_id_x 1
.end_amdhsa_kernel
.section .rodata,"a"
.p2align 6
.amdhsa_kernel k2_kernel
  .amdhsa_next_free_vgpr 512
  .amdhsa_next_free_sgpr 102
  .amdhsa_accum_offset 256
  .amdhsa_group_segment_fixed_size 0
  .amdhsa_kernarg_size 112
  .amdhsa_user_sgpr_count 2
  .amdhsa_user_sgpr_kernarg_segment_ptr 1
  .amdhsa_system_sgpr_workgroup_id_x 1
.end_amdhsa_kernel
```
